```python
import torch

def _softmax(x, axis=-1):
    return torch.softmax(x, dim=axis)
def _gelu(x):
    return torch.nn.functional.gelu(x, approximate="tanh")
def _silu(x):
    return torch.nn.functional.silu(x)
def _sigmoid(x):
    return torch.sigmoid(x)
def _layernorm(x, axis=-1, eps=1e-5):
    m = x.mean(dim=axis, keepdim=True)
    v = x.var(dim=axis, keepdim=True, unbiased=False)
    return (x - m) / torch.sqrt(v + eps)
def _scatter_add(tgt, idx, src, axis=0):
    return tgt.clone().index_add_(axis, idx, src)
def _segment_sum(src, seg, n):
    out = torch.zeros((n,) + src.shape[1:], dtype=src.dtype)
    return out.index_add_(0, seg, src)
def _pad(x, pw):
    flat = tuple(v for pair in reversed(pw) for v in pair)
    return torch.nn.functional.pad(x, flat)

kernel_name = 'gated_mix__sliding_block__mixer_s_mlp__prompt'

def setup_inputs():

    _w = (lambda a: (lambda t: t.to(torch.bfloat16) if t.is_floating_point() else t)(torch.as_tensor(a)))
    def _A_setup():
        B, S, D = 1, 2048, 512
        return {
            "x": _w((lambda *s: torch.randn(*s, dtype=torch.bfloat16) * 0.05)(B, S, D)),
            "wqkv": _w((lambda *s: torch.randn(*s, dtype=torch.bfloat16) * 1.6)(D, 3 * D)),
            "wo": _w((lambda *s: torch.randn(*s, dtype=torch.bfloat16) * 0.4)(D, D)),
        }
    _A_in = _A_setup()

    def _B_setup():
        B, S, D, F = 1, 2048, 512, 1792
        return {
            "x":  _w((lambda *s: torch.randn(*s, dtype=torch.bfloat16) * 0.05)(B, S, D)),
            "w1": _w((lambda *s: torch.randn(*s, dtype=torch.bfloat16) * 3.2)(D, D) * (D ** -0.5)),
            "w2": _w((lambda *s: torch.randn(*s, dtype=torch.bfloat16) * 3.2)(D, D) * (D ** -0.5)),
            "w3": _w((lambda *s: torch.randn(*s, dtype=torch.bfloat16) * 3.2)(D, F) * (D ** -0.5)),
            "w4": _w((lambda *s: torch.randn(*s, dtype=torch.bfloat16) * 3.2)(F, D) * (F ** -0.5)),
        }
    _B_in = _B_setup()

    return {
        "A_x": _A_in["x"],
        "A_wqkv": _A_in["wqkv"],
        "A_wo": _A_in["wo"],
        "B_x": _B_in["x"],
        "B_w1": _B_in["w1"],
        "B_w2": _B_in["w2"],
        "B_w3": _B_in["w3"],
        "B_w4": _B_in["w4"],
        "gate_w": _w((lambda *s: torch.randn(*s, dtype=torch.bfloat16) * 0.05)(512) * 16.0),
    }

def reference(A_x, A_wqkv, A_wo, B_x, B_w1, B_w2, B_w3, B_w4, gate_w):
    def _A_ref(x, wqkv, wo):
        B, S, D = x.shape
        H = 32; Dh = D // H; W = 256
        qkv = (lambda x, *d: x.permute(*d))((x @ wqkv).reshape(B, S, 3, H, Dh), 2, 0, 3, 1, 4)
        q, k, v = qkv[0], qkv[1], qkv[2]
        scores = torch.einsum("bhqd,bhkd->bhqk", q, k) * (Dh ** -0.5)
        idx = torch.arange(S)
        mask = (idx[:, None] - idx[None, :] >= 0) & (idx[:, None] - idx[None, :] < W)
        scores = torch.where(mask[None, None], scores, -1e9)
        p = _softmax(scores, axis=-1)
        o = torch.einsum("bhqk,bhkd->bhqd", p, v)
        return (lambda x, *d: x.permute(*d))(o, 0, 2, 1, 3).reshape(B, S, D) @ wo

    def _B_ref(x, w1, w2, w3, w4):
        B, S, D = x.shape
        h = _gelu(_layernorm(x, axis=-1) @ w1)
        c = D // 4
        g0 = _pad(h[:, :, 0*c:1*c], ((0, 0), (1, 0), (0, 0)))[:, :S, :]
        g1 = _pad(h[:, :, 1*c:2*c], ((0, 0), (0, 1), (0, 0)))[:, 1:, :]
        g2 = _pad(h[:, :, 2*c:3*c], ((0, 0), (2, 0), (0, 0)))[:, :S, :]
        g3 = _pad(h[:, :, 3*c:   ], ((0, 0), (0, 2), (0, 0)))[:, 2:, :]
        hs = torch.concatenate([g0, g1, g2, g3], axis=-1) @ w2
        x1 = x + hs
        h2 = _gelu(_layernorm(x1, axis=-1) @ w3) @ w4
        return x1 + h2

    x = A_x
    g = _sigmoid((x * gate_w).sum(-1, keepdims=True))
    a = _A_ref(x, A_wqkv, A_wo)
    b = _B_ref(x, B_w1, B_w2, B_w3, B_w4)
    return g * a + (1 - g) * b
```

```asm
; @launch grid=(256,1,1) block=(512,1,1) lds=163840
.amdgcn_target "amdgcn-amd-amdhsa--gfx950"
.text
.globl gated_mix__sliding_block__mixer_s_mlp__prompt_kernel
.p2align 8
.type gated_mix__sliding_block__mixer_s_mlp__prompt_kernel,@function
gated_mix__sliding_block__mixer_s_mlp__prompt_kernel:
    s_cmp_ge_u32 s2, 256
    s_cbranch_scc1 Lend
    s_load_dwordx16 s[8:23], s[0:1], 0
    s_load_dwordx8 s[24:31], s[0:1], 64
    s_getpc_b64 s[4:5]
Lpc:
    v_readfirstlane_b32 s3, v0
    v_lshlrev_b32 v25, 2, v0
    v_and_b32 v0, 63, v0
    s_lshr_b32 s33, s2, 3
    s_lshr_b32 s3, s3, 6
    s_lshl_b32 s6, s33, 3
    s_add_u32 s6, s6, s3
    s_lshl_b32 s6, s6, 8
    v_lshl_add_u32 v1, v0, 7, s6
    v_cmp_gt_u32 vcc, Lend-Lpc, v1
    s_nop 1
    s_and_b64 exec, vcc, 3
    s_cbranch_execz Lcp1
    global_load_dword v255, v1, s[4:5]
Lcp1:
    s_mov_b64 exec, -1
    v_add_u32 v25, 147456, v25
    v_mov_b32 v26, 0
    ds_write_b32 v25, v26
    s_and_b32 s32, s2, 7
    s_and_b32 s34, s33, 3
    s_and_b32 s6, s2, 1
    s_lshl_b32 s6, s6, 2
    s_add_u32 s34, s34, s6
    s_lshr_b32 s6, s33, 2
    s_and_b32 s35, s2, 6
    s_lshl_b32 s35, s35, 2
    s_add_u32 s35, s35, s6
    v_lshlrev_b32 v24, 2, v0
    v_add_u32 v24, 147456, v24
    s_mov_b32 s101, 4000000
    v_lshrrev_b32 v29, 4, v0
    v_lshl_add_u32 v29, v29, 8, v24
    s_and_b32 s6, s3, 6
    s_cmp_eq_u32 s6, 4
    s_cbranch_scc1 Ldma
    s_waitcnt lgkmcnt(0)
    s_barrier
    s_cmp_eq_u32 s3, 7
    s_cbranch_scc1 Lmisc
    s_cmp_eq_u32 s3, 6
    s_cbranch_scc1 Lsync
    s_branch Lcomp
Ldma:
    s_sub_u32 s84, s3, 4
    s_lshl_b32 s85, s84, 12
    v_lshrrev_b32 v20, 3, v0
    s_lshl_b32 s90, s84, 5
    v_add_u32 v20, s90, v20
    v_and_b32 v21, 7, v0
    v_lshrrev_b32 v22, 4, v0
    v_xor_b32 v22, v22, v21
    v_lshlrev_b32 v22, 4, v22
    v_lshl_add_u32 v4, v20, 10, v22
    v_xor_b32 v5, 64, v4
    v_add_u32 v5, 7168, v5
    v_add_u32 v6, 14336, v4
    v_add_u32 v7, 14336, v5
    v_bfe_u32 v22, v0, 4, 1
    v_lshlrev_b32 v22, 2, v22
    v_xor_b32 v22, v22, v21
    v_lshlrev_b32 v22, 4, v22
    v_mul_u32_u24 v8, 1024, v20
    v_add_u32 v8, v8, v22
    v_add_u32 v9, 7168, v8
    v_add_u32 v10, 14336, v8
    v_add_u32 v11, 21504, v8
    s_lshl_b32 s87, s35, 16
    s_lshl_b32 s88, s34, 7
    s_xor_b32 s90, s88, 128
    s_mul_i32 s95, s35, 0
    s_add_u32 s4, s4, Ltab-Lpc
    s_addc_u32 s5, s5, 0
    v_mov_b32 v28, 0
    s_lshl_b32 s91, s84, 8
    s_waitcnt lgkmcnt(0)
    s_barrier
    s_mov_b32 s40, s8
    s_and_b32 s41, s9, 0xffff
    s_mov_b32 s42, 2097152
    s_mov_b32 s43, 0x20000
    s_mov_b32 s44, s16
    s_and_b32 s45, s17, 0xffff
    s_mov_b32 s46, 524288
    s_mov_b32 s47, 0x20000
    s_add_u32 m0, s85, 0
    s_add_u32 s86, s87, 0
    buffer_load_dwordx4 v4, s[40:43], s86 offen offset:0 lds
    buffer_load_dwordx4 v5, s[40:43], s86 offen offset:1024 lds
    buffer_load_dwordx4 v6, s[40:43], s86 offen offset:2048 lds
    buffer_load_dwordx4 v7, s[40:43], s86 offen offset:3072 lds
    s_add_u32 m0, s85, 8192
    s_add_u32 s86, s90, 0
    buffer_load_dwordx4 v8, s[44:47], s86 offen offset:0 lds
    buffer_load_dwordx4 v9, s[44:47], s86 offen offset:1024 lds
    buffer_load_dwordx4 v10, s[44:47], s86 offen offset:2048 lds
    buffer_load_dwordx4 v11, s[44:47], s86 offen offset:3072 lds
    s_add_u32 m0, s91, 148476
    s_nop 0
    global_load_lds_dword v28, s[4:5] offset:4
    s_add_u32 m0, s85, 16384
    s_add_u32 s86, s87, 128
    buffer_load_dwordx4 v4, s[40:43], s86 offen offset:0 lds
    buffer_load_dwordx4 v5, s[40:43], s86 offen offset:1024 lds
    buffer_load_dwordx4 v6, s[40:43], s86 offen offset:2048 lds
    buffer_load_dwordx4 v7, s[40:43], s86 offen offset:3072 lds
    s_add_u32 m0, s85, 24576
    s_add_u32 s86, s90, 65536
    buffer_load_dwordx4 v8, s[44:47], s86 offen offset:0 lds
    buffer_load_dwordx4 v9, s[44:47], s86 offen offset:1024 lds
    buffer_load_dwordx4 v10, s[44:47], s86 offen offset:2048 lds
    buffer_load_dwordx4 v11, s[44:47], s86 offen offset:3072 lds
    s_add_u32 m0, s91, 148472
    s_nop 0
    global_load_lds_dword v28, s[4:5] offset:8
    s_add_u32 m0, s85, 32768
    s_add_u32 s86, s87, 256
    buffer_load_dwordx4 v4, s[40:43], s86 offen offset:0 lds
    buffer_load_dwordx4 v5, s[40:43], s86 offen offset:1024 lds
    buffer_load_dwordx4 v6, s[40:43], s86 offen offset:2048 lds
    buffer_load_dwordx4 v7, s[40:43], s86 offen offset:3072 lds
    s_add_u32 m0, s85, 40960
    s_add_u32 s86, s90, 131072
    buffer_load_dwordx4 v8, s[44:47], s86 offen offset:0 lds
    buffer_load_dwordx4 v9, s[44:47], s86 offen offset:1024 lds
    buffer_load_dwordx4 v10, s[44:47], s86 offen offset:2048 lds
    buffer_load_dwordx4 v11, s[44:47], s86 offen offset:3072 lds
    s_add_u32 m0, s91, 148468
    s_nop 0
    global_load_lds_dword v28, s[4:5] offset:12
    v_mul_u32_u24 v12, 3072, v20
    v_add_u32 v12, v12, v22
    v_add_u32 v13, 23552, v12
    v_add_u32 v14, 47104, v12
    v_add_u32 v15, 70656, v12
    v_mul_u32_u24 v16, 3584, v20
    v_add_u32 v16, v16, v22
    v_add_u32 v17, 27648, v16
    v_add_u32 v18, 55296, v16
    v_add_u32 v19, 82944, v16
    v_lshrrev_b32 v21, 5, v0
    v_lshlrev_b32 v21, 4, v21
    v_xor_b32 v32, v21, v8
    v_xor_b32 v33, v21, v9
    v_xor_b32 v34, v21, v10
    v_xor_b32 v35, v21, v11
    s_xor_b32 s92, s88, 512
    s_xor_b32 s93, s88, 1280
    s_xor_b32 s94, s88, 2688
    s_mov_b32 s48, s10
    s_and_b32 s49, s11, 0xffff
    s_mov_b32 s50, 1572864
    s_mov_b32 s51, 0x20000
    s_mov_b32 s52, s18
    s_and_b32 s53, s19, 0xffff
    s_mov_b32 s54, 524288
    s_mov_b32 s55, 0x20000
    s_mov_b32 s56, s20
    s_and_b32 s57, s21, 0xffff
    s_mov_b32 s58, 1835008
    s_mov_b32 s59, 0x20000
    s_mov_b32 s60, s12
    s_and_b32 s61, s13, 0xffff
    s_mov_b32 s62, 524288
    s_mov_b32 s63, 0x20000
    s_mov_b32 s64, s22
    s_and_b32 s65, s23, 0xffff
    s_mov_b32 s66, 1835008
    s_mov_b32 s67, 0x20000
    s_mov_b32 s71, 0x20000
    s_mov_b64 s[96:97], s[30:31]
    s_mov_b32 s72, s30
    s_and_b32 s73, s31, 0xffff
    s_mov_b32 s74, 29360128
    s_mov_b32 s75, 0x20000
    v_mov_b32 v36, -1
    v_mov_b32 v37, -1
    v_mov_b32 v38, -1
    v_mov_b32 v39, -1
    s_and_b32 s99, s33, 7
    s_lshr_b32 s6, s33, 3
    s_lshl_b32 s100, s32, 2
    s_add_u32 s100, s100, s6
    s_and_b32 s36, s2, 6
    s_lshl_b32 s36, s36, 1
    s_add_u32 s36, s36, s6
    s_cmp_lt_u32 s99, 7
    s_cselect_b32 s38, 1, 0
    s_min_u32 s37, s99, 6
    s_and_b32 s6, s2, 1
    s_mul_i32 s6, s6, 7
    s_add_u32 s37, s37, s6
    s_lshl_b32 s89, s37, 8
    s_mul_i32 s98, s36, 0
    s_add_u32 m0, s85, 49152
    s_add_u32 s86, s87, 384
    s_waitcnt vmcnt(12)
    buffer_load_dwordx4 v4, s[40:43], s86 offen offset:0 lds
    buffer_load_dwordx4 v5, s[40:43], s86 offen offset:1024 lds
    buffer_load_dwordx4 v6, s[40:43], s86 offen offset:2048 lds
    buffer_load_dwordx4 v7, s[40:43], s86 offen offset:3072 lds
    s_add_u32 m0, s85, 57344
    s_add_u32 s86, s90, 196608
    s_waitcnt vmcnt(12)
    buffer_load_dwordx4 v8, s[44:47], s86 offen offset:0 lds
    buffer_load_dwordx4 v9, s[44:47], s86 offen offset:1024 lds
    buffer_load_dwordx4 v10, s[44:47], s86 offen offset:2048 lds
    buffer_load_dwordx4 v11, s[44:47], s86 offen offset:3072 lds
    s_add_u32 m0, s91, 148464
    s_nop 0
    global_load_lds_dword v28, s[4:5] offset:16
    s_add_u32 m0, s85, 65536
    s_add_u32 s86, s87, 512
    s_waitcnt vmcnt(12)
    buffer_load_dwordx4 v4, s[40:43], s86 offen offset:0 lds
    buffer_load_dwordx4 v5, s[40:43], s86 offen offset:1024 lds
    buffer_load_dwordx4 v6, s[40:43], s86 offen offset:2048 lds
    buffer_load_dwordx4 v7, s[40:43], s86 offen offset:3072 lds
    s_add_u32 m0, s85, 73728
    s_add_u32 s86, s90, 262144
    s_waitcnt vmcnt(12)
    buffer_load_dwordx4 v8, s[44:47], s86 offen offset:0 lds
    buffer_load_dwordx4 v9, s[44:47], s86 offen offset:1024 lds
    buffer_load_dwordx4 v10, s[44:47], s86 offen offset:2048 lds
    buffer_load_dwordx4 v11, s[44:47], s86 offen offset:3072 lds
    s_add_u32 m0, s91, 148460
    s_nop 0
    global_load_lds_dword v28, s[4:5] offset:20
    s_add_u32 m0, s85, 81920
    s_add_u32 s86, s87, 640
    s_waitcnt vmcnt(12)
    buffer_load_dwordx4 v4, s[40:43], s86 offen offset:0 lds
    buffer_load_dwordx4 v5, s[40:43], s86 offen offset:1024 lds
    buffer_load_dwordx4 v6, s[40:43], s86 offen offset:2048 lds
    buffer_load_dwordx4 v7, s[40:43], s86 offen offset:3072 lds
    s_add_u32 m0, s85, 90112
    s_add_u32 s86, s90, 327680
    s_waitcnt vmcnt(12)
    buffer_load_dwordx4 v8, s[44:47], s86 offen offset:0 lds
    buffer_load_dwordx4 v9, s[44:47], s86 offen offset:1024 lds
    buffer_load_dwordx4 v10, s[44:47], s86 offen offset:2048 lds
    buffer_load_dwordx4 v11, s[44:47], s86 offen offset:3072 lds
    s_add_u32 m0, s91, 148456
    s_nop 0
    global_load_lds_dword v28, s[4:5] offset:24
    s_add_u32 m0, s85, 98304
    s_add_u32 s86, s87, 768
    s_waitcnt vmcnt(12)
    buffer_load_dwordx4 v4, s[40:43], s86 offen offset:0 lds
    buffer_load_dwordx4 v5, s[40:43], s86 offen offset:1024 lds
    buffer_load_dwordx4 v6, s[40:43], s86 offen offset:2048 lds
    buffer_load_dwordx4 v7, s[40:43], s86 offen offset:3072 lds
    s_add_u32 m0, s85, 106496
    s_add_u32 s86, s90, 393216
    s_waitcnt vmcnt(12)
    buffer_load_dwordx4 v8, s[44:47], s86 offen offset:0 lds
    buffer_load_dwordx4 v9, s[44:47], s86 offen offset:1024 lds
    buffer_load_dwordx4 v10, s[44:47], s86 offen offset:2048 lds
    buffer_load_dwordx4 v11, s[44:47], s86 offen offset:3072 lds
    s_add_u32 m0, s91, 148452
    s_nop 0
    global_load_lds_dword v28, s[4:5] offset:28
    s_add_u32 m0, s85, 114688
    s_add_u32 s86, s87, 896
    s_waitcnt vmcnt(12)
    buffer_load_dwordx4 v4, s[40:43], s86 offen offset:0 lds
    buffer_load_dwordx4 v5, s[40:43], s86 offen offset:1024 lds
    buffer_load_dwordx4 v6, s[40:43], s86 offen offset:2048 lds
    buffer_load_dwordx4 v7, s[40:43], s86 offen offset:3072 lds
    s_add_u32 m0, s85, 122880
    s_add_u32 s86, s90, 458752
    s_waitcnt vmcnt(12)
    buffer_load_dwordx4 v8, s[44:47], s86 offen offset:0 lds
    buffer_load_dwordx4 v9, s[44:47], s86 offen offset:1024 lds
    buffer_load_dwordx4 v10, s[44:47], s86 offen offset:2048 lds
    buffer_load_dwordx4 v11, s[44:47], s86 offen offset:3072 lds
    s_add_u32 m0, s91, 148448
    s_nop 0
    global_load_lds_dword v28, s[4:5] offset:32
    s_add_u32 m0, s85, 131072
    s_add_u32 s86, s92, 0
    s_waitcnt vmcnt(12)
    buffer_load_dwordx4 v12, s[48:51], s86 offen offset:0 lds
    buffer_load_dwordx4 v13, s[48:51], s86 offen offset:1024 lds
    buffer_load_dwordx4 v14, s[48:51], s86 offen offset:2048 lds
    buffer_load_dwordx4 v15, s[48:51], s86 offen offset:3072 lds
    s_add_u32 m0, s85, 139264
    s_add_u32 s86, s92, 196608
    s_waitcnt vmcnt(12)
    buffer_load_dwordx4 v12, s[48:51], s86 offen offset:0 lds
    buffer_load_dwordx4 v13, s[48:51], s86 offen offset:1024 lds
    buffer_load_dwordx4 v14, s[48:51], s86 offen offset:2048 lds
    buffer_load_dwordx4 v15, s[48:51], s86 offen offset:3072 lds
Lwa100:
    ds_read_b32 v27, v29 offset:0
    s_waitcnt lgkmcnt(0)
    v_cmp_gt_u32 vcc, 1, v27
    s_cbranch_vccz Lwd101
    s_sleep 1
    s_sub_u32 s101, s101, 1
    s_cbranch_scc0 Lwa100
    s_mov_b32 s101, 0
Lwd101:
    s_add_u32 m0, s85, 0
    s_add_u32 s86, s92, 393216
    s_waitcnt vmcnt(12)
    buffer_load_dwordx4 v12, s[48:51], s86 offen offset:0 lds
    buffer_load_dwordx4 v13, s[48:51], s86 offen offset:1024 lds
    buffer_load_dwordx4 v14, s[48:51], s86 offen offset:2048 lds
    buffer_load_dwordx4 v15, s[48:51], s86 offen offset:3072 lds
    s_add_u32 m0, s85, 8192
    s_add_u32 s86, s92, 589824
    s_waitcnt vmcnt(12)
    buffer_load_dwordx4 v12, s[48:51], s86 offen offset:0 lds
    buffer_load_dwordx4 v13, s[48:51], s86 offen offset:1024 lds
    buffer_load_dwordx4 v14, s[48:51], s86 offen offset:2048 lds
    buffer_load_dwordx4 v15, s[48:51], s86 offen offset:3072 lds
    s_add_u32 m0, s91, 148440
    s_nop 0
    global_load_lds_dword v28, s[4:5] offset:40
    s_add_u32 m0, s85, 16384
    s_add_u32 s86, s92, 786432
    s_waitcnt vmcnt(12)
    buffer_load_dwordx4 v12, s[48:51], s86 offen offset:0 lds
    buffer_load_dwordx4 v13, s[48:51], s86 offen offset:1024 lds
    buffer_load_dwordx4 v14, s[48:51], s86 offen offset:2048 lds
    buffer_load_dwordx4 v15, s[48:51], s86 offen offset:3072 lds
    s_add_u32 m0, s85, 24576
    s_add_u32 s86, s92, 983040
    s_waitcnt vmcnt(12)
    buffer_load_dwordx4 v12, s[48:51], s86 offen offset:0 lds
    buffer_load_dwordx4 v13, s[48:51], s86 offen offset:1024 lds
    buffer_load_dwordx4 v14, s[48:51], s86 offen offset:2048 lds
    buffer_load_dwordx4 v15, s[48:51], s86 offen offset:3072 lds
    s_add_u32 m0, s85, 32768
    s_add_u32 s86, s92, 1179648
    s_waitcnt vmcnt(12)
    buffer_load_dwordx4 v12, s[48:51], s86 offen offset:0 lds
    buffer_load_dwordx4 v13, s[48:51], s86 offen offset:1024 lds
    buffer_load_dwordx4 v14, s[48:51], s86 offen offset:2048 lds
    buffer_load_dwordx4 v15, s[48:51], s86 offen offset:3072 lds
    s_add_u32 m0, s85, 40960
    s_add_u32 s86, s92, 1376256
    s_waitcnt vmcnt(12)
    buffer_load_dwordx4 v12, s[48:51], s86 offen offset:0 lds
    buffer_load_dwordx4 v13, s[48:51], s86 offen offset:1024 lds
    buffer_load_dwordx4 v14, s[48:51], s86 offen offset:2048 lds
    buffer_load_dwordx4 v15, s[48:51], s86 offen offset:3072 lds
    s_add_u32 m0, s91, 148432
    s_nop 0
    global_load_lds_dword v28, s[4:5] offset:48
    s_add_u32 m0, s85, 49152
    s_add_u32 s86, s93, 0
    s_waitcnt vmcnt(12)
    buffer_load_dwordx4 v12, s[48:51], s86 offen offset:0 lds
    buffer_load_dwordx4 v13, s[48:51], s86 offen offset:1024 lds
    buffer_load_dwordx4 v14, s[48:51], s86 offen offset:2048 lds
    buffer_load_dwordx4 v15, s[48:51], s86 offen offset:3072 lds
    s_add_u32 m0, s85, 57344
    s_add_u32 s86, s93, 196608
    s_waitcnt vmcnt(12)
    buffer_load_dwordx4 v12, s[48:51], s86 offen offset:0 lds
    buffer_load_dwordx4 v13, s[48:51], s86 offen offset:1024 lds
    buffer_load_dwordx4 v14, s[48:51], s86 offen offset:2048 lds
    buffer_load_dwordx4 v15, s[48:51], s86 offen offset:3072 lds
    s_add_u32 s90, s87, s88
    s_add_u32 m0, s85, 155648
    s_add_u32 s86, s90, 0
    s_waitcnt vmcnt(12)
    buffer_load_dwordx4 v4, s[40:43], s86 offen offset:0 lds
    buffer_load_dwordx4 v5, s[40:43], s86 offen offset:1024 lds
    buffer_load_dwordx4 v6, s[40:43], s86 offen offset:2048 lds
    buffer_load_dwordx4 v7, s[40:43], s86 offen offset:3072 lds
Lwa102:
    ds_read_b32 v27, v29 offset:0
    s_waitcnt lgkmcnt(0)
    v_cmp_gt_u32 vcc, 2, v27
    s_cbranch_vccz Lwd103
    s_sleep 1
    s_sub_u32 s101, s101, 1
    s_cbranch_scc0 Lwa102
    s_mov_b32 s101, 0
Lwd103:
    s_add_u32 m0, s85, 65536
    s_add_u32 s86, s93, 393216
    s_waitcnt vmcnt(12)
    buffer_load_dwordx4 v12, s[48:51], s86 offen offset:0 lds
    buffer_load_dwordx4 v13, s[48:51], s86 offen offset:1024 lds
    buffer_load_dwordx4 v14, s[48:51], s86 offen offset:2048 lds
    buffer_load_dwordx4 v15, s[48:51], s86 offen offset:3072 lds
    s_add_u32 m0, s85, 73728
    s_add_u32 s86, s93, 589824
    s_waitcnt vmcnt(12)
    buffer_load_dwordx4 v12, s[48:51], s86 offen offset:0 lds
    buffer_load_dwordx4 v13, s[48:51], s86 offen offset:1024 lds
    buffer_load_dwordx4 v14, s[48:51], s86 offen offset:2048 lds
    buffer_load_dwordx4 v15, s[48:51], s86 offen offset:3072 lds
    s_add_u32 m0, s91, 148424
    s_nop 0
    global_load_lds_dword v28, s[4:5] offset:56
    s_add_u32 m0, s85, 81920
    s_add_u32 s86, s93, 786432
    s_waitcnt vmcnt(12)
    buffer_load_dwordx4 v12, s[48:51], s86 offen offset:0 lds
    buffer_load_dwordx4 v13, s[48:51], s86 offen offset:1024 lds
    buffer_load_dwordx4 v14, s[48:51], s86 offen offset:2048 lds
    buffer_load_dwordx4 v15, s[48:51], s86 offen offset:3072 lds
    s_add_u32 m0, s85, 90112
    s_add_u32 s86, s93, 983040
    s_waitcnt vmcnt(12)
    buffer_load_dwordx4 v12, s[48:51], s86 offen offset:0 lds
    buffer_load_dwordx4 v13, s[48:51], s86 offen offset:1024 lds
    buffer_load_dwordx4 v14, s[48:51], s86 offen offset:2048 lds
    buffer_load_dwordx4 v15, s[48:51], s86 offen offset:3072 lds
    s_add_u32 m0, s85, 98304
    s_add_u32 s86, s93, 1179648
    s_waitcnt vmcnt(12)
    buffer_load_dwordx4 v12, s[48:51], s86 offen offset:0 lds
    buffer_load_dwordx4 v13, s[48:51], s86 offen offset:1024 lds
    buffer_load_dwordx4 v14, s[48:51], s86 offen offset:2048 lds
    buffer_load_dwordx4 v15, s[48:51], s86 offen offset:3072 lds
    s_add_u32 m0, s85, 106496
    s_add_u32 s86, s93, 1376256
    s_waitcnt vmcnt(12)
    buffer_load_dwordx4 v12, s[48:51], s86 offen offset:0 lds
    buffer_load_dwordx4 v13, s[48:51], s86 offen offset:1024 lds
    buffer_load_dwordx4 v14, s[48:51], s86 offen offset:2048 lds
    buffer_load_dwordx4 v15, s[48:51], s86 offen offset:3072 lds
    s_add_u32 m0, s91, 148416
    s_nop 0
    global_load_lds_dword v28, s[4:5] offset:64
    s_add_u32 m0, s85, 114688
    s_add_u32 s86, s94, 0
    s_waitcnt vmcnt(12)
    buffer_load_dwordx4 v12, s[48:51], s86 offen offset:0 lds
    buffer_load_dwordx4 v13, s[48:51], s86 offen offset:1024 lds
    buffer_load_dwordx4 v14, s[48:51], s86 offen offset:2048 lds
    buffer_load_dwordx4 v15, s[48:51], s86 offen offset:3072 lds
    s_add_u32 m0, s85, 122880
    s_add_u32 s86, s94, 196608
    s_waitcnt vmcnt(12)
    buffer_load_dwordx4 v12, s[48:51], s86 offen offset:0 lds
    buffer_load_dwordx4 v13, s[48:51], s86 offen offset:1024 lds
    buffer_load_dwordx4 v14, s[48:51], s86 offen offset:2048 lds
    buffer_load_dwordx4 v15, s[48:51], s86 offen offset:3072 lds
Lwa104:
    ds_read_b32 v27, v29 offset:0
    s_waitcnt lgkmcnt(0)
    v_cmp_gt_u32 vcc, 3, v27
    s_cbranch_vccz Lwd105
    s_sleep 1
    s_sub_u32 s101, s101, 1
    s_cbranch_scc0 Lwa104
    s_mov_b32 s101, 0
Lwd105:
    s_add_u32 m0, s85, 131072
    s_add_u32 s86, s94, 393216
    s_waitcnt vmcnt(12)
    buffer_load_dwordx4 v12, s[48:51], s86 offen offset:0 lds
    buffer_load_dwordx4 v13, s[48:51], s86 offen offset:1024 lds
    buffer_load_dwordx4 v14, s[48:51], s86 offen offset:2048 lds
    buffer_load_dwordx4 v15, s[48:51], s86 offen offset:3072 lds
    s_add_u32 m0, s85, 139264
    s_add_u32 s86, s94, 589824
    s_waitcnt vmcnt(12)
    buffer_load_dwordx4 v12, s[48:51], s86 offen offset:0 lds
    buffer_load_dwordx4 v13, s[48:51], s86 offen offset:1024 lds
    buffer_load_dwordx4 v14, s[48:51], s86 offen offset:2048 lds
    buffer_load_dwordx4 v15, s[48:51], s86 offen offset:3072 lds
    s_add_u32 m0, s91, 148408
    s_nop 0
    global_load_lds_dword v28, s[4:5] offset:72
    s_add_u32 m0, s85, 0
    s_add_u32 s86, s94, 786432
    s_waitcnt vmcnt(12)
    buffer_load_dwordx4 v12, s[48:51], s86 offen offset:0 lds
    buffer_load_dwordx4 v13, s[48:51], s86 offen offset:1024 lds
    buffer_load_dwordx4 v14, s[48:51], s86 offen offset:2048 lds
    buffer_load_dwordx4 v15, s[48:51], s86 offen offset:3072 lds
    s_add_u32 m0, s85, 8192
    s_add_u32 s86, s94, 983040
    s_waitcnt vmcnt(12)
    buffer_load_dwordx4 v12, s[48:51], s86 offen offset:0 lds
    buffer_load_dwordx4 v13, s[48:51], s86 offen offset:1024 lds
    buffer_load_dwordx4 v14, s[48:51], s86 offen offset:2048 lds
    buffer_load_dwordx4 v15, s[48:51], s86 offen offset:3072 lds
    s_add_u32 m0, s91, 148404
    s_nop 0
    global_load_lds_dword v28, s[4:5] offset:76
    s_add_u32 m0, s85, 16384
    s_add_u32 s86, s94, 1179648
    s_waitcnt vmcnt(12)
    buffer_load_dwordx4 v12, s[48:51], s86 offen offset:0 lds
    buffer_load_dwordx4 v13, s[48:51], s86 offen offset:1024 lds
    buffer_load_dwordx4 v14, s[48:51], s86 offen offset:2048 lds
    buffer_load_dwordx4 v15, s[48:51], s86 offen offset:3072 lds
    s_add_u32 m0, s85, 24576
    s_add_u32 s86, s94, 1376256
    s_waitcnt vmcnt(12)
    buffer_load_dwordx4 v12, s[48:51], s86 offen offset:0 lds
    buffer_load_dwordx4 v13, s[48:51], s86 offen offset:1024 lds
    buffer_load_dwordx4 v14, s[48:51], s86 offen offset:2048 lds
    buffer_load_dwordx4 v15, s[48:51], s86 offen offset:3072 lds
    s_add_u32 m0, s91, 148400
    s_nop 0
    global_load_lds_dword v28, s[4:5] offset:80
    s_add_u32 m0, s85, 32768
    s_add_u32 s86, s88, 0
    s_waitcnt vmcnt(12)
    buffer_load_dwordx4 v32, s[52:55], s86 offen offset:0 lds
    buffer_load_dwordx4 v33, s[52:55], s86 offen offset:1024 lds
    buffer_load_dwordx4 v34, s[52:55], s86 offen offset:2048 lds
    buffer_load_dwordx4 v35, s[52:55], s86 offen offset:3072 lds
    s_add_u32 m0, s85, 40960
    s_add_u32 s86, s88, 65536
    s_waitcnt vmcnt(12)
    buffer_load_dwordx4 v32, s[52:55], s86 offen offset:0 lds
    buffer_load_dwordx4 v33, s[52:55], s86 offen offset:1024 lds
    buffer_load_dwordx4 v34, s[52:55], s86 offen offset:2048 lds
    buffer_load_dwordx4 v35, s[52:55], s86 offen offset:3072 lds
Lwa106:
    ds_read_b32 v27, v29 offset:0
    s_waitcnt lgkmcnt(0)
    v_cmp_gt_u32 vcc, 5, v27
    s_cbranch_vccz Lwd107
    s_sleep 1
    s_sub_u32 s101, s101, 1
    s_cbranch_scc0 Lwa106
    s_mov_b32 s101, 0
Lwd107:
    s_add_u32 m0, s85, 49152
    s_add_u32 s86, s88, 131072
    s_waitcnt vmcnt(12)
    buffer_load_dwordx4 v32, s[52:55], s86 offen offset:0 lds
    buffer_load_dwordx4 v33, s[52:55], s86 offen offset:1024 lds
    buffer_load_dwordx4 v34, s[52:55], s86 offen offset:2048 lds
    buffer_load_dwordx4 v35, s[52:55], s86 offen offset:3072 lds
    s_add_u32 m0, s85, 57344
    s_add_u32 s86, s88, 196608
    s_waitcnt vmcnt(12)
    buffer_load_dwordx4 v32, s[52:55], s86 offen offset:0 lds
    buffer_load_dwordx4 v33, s[52:55], s86 offen offset:1024 lds
    buffer_load_dwordx4 v34, s[52:55], s86 offen offset:2048 lds
    buffer_load_dwordx4 v35, s[52:55], s86 offen offset:3072 lds
    s_add_u32 m0, s91, 148392
    s_nop 0
    global_load_lds_dword v28, s[4:5] offset:88
    s_add_u32 m0, s85, 65536
    s_add_u32 s86, s88, 262144
    s_waitcnt vmcnt(12)
    buffer_load_dwordx4 v32, s[52:55], s86 offen offset:0 lds
    buffer_load_dwordx4 v33, s[52:55], s86 offen offset:1024 lds
    buffer_load_dwordx4 v34, s[52:55], s86 offen offset:2048 lds
    buffer_load_dwordx4 v35, s[52:55], s86 offen offset:3072 lds
    s_add_u32 m0, s85, 73728
    s_add_u32 s86, s88, 327680
    s_waitcnt vmcnt(12)
    buffer_load_dwordx4 v32, s[52:55], s86 offen offset:0 lds
    buffer_load_dwordx4 v33, s[52:55], s86 offen offset:1024 lds
    buffer_load_dwordx4 v34, s[52:55], s86 offen offset:2048 lds
    buffer_load_dwordx4 v35, s[52:55], s86 offen offset:3072 lds
    s_add_u32 m0, s85, 81920
    s_add_u32 s86, s88, 393216
    s_waitcnt vmcnt(12)
    buffer_load_dwordx4 v32, s[52:55], s86 offen offset:0 lds
    buffer_load_dwordx4 v33, s[52:55], s86 offen offset:1024 lds
    buffer_load_dwordx4 v34, s[52:55], s86 offen offset:2048 lds
    buffer_load_dwordx4 v35, s[52:55], s86 offen offset:3072 lds
    s_add_u32 m0, s85, 90112
    s_add_u32 s86, s88, 458752
    s_waitcnt vmcnt(12)
    buffer_load_dwordx4 v32, s[52:55], s86 offen offset:0 lds
    buffer_load_dwordx4 v33, s[52:55], s86 offen offset:1024 lds
    buffer_load_dwordx4 v34, s[52:55], s86 offen offset:2048 lds
    buffer_load_dwordx4 v35, s[52:55], s86 offen offset:3072 lds
    s_add_u32 m0, s91, 148384
    s_nop 0
    global_load_lds_dword v28, s[4:5] offset:96
    s_and_b32 s6, s2, 1
    s_lshl_b32 s6, s6, 3
    s_add_u32 s6, s6, s99
    s_lshl_b32 s6, s6, 6
    s_add_u32 s6, s6, 256
    s_load_dwordx16 s[40:55], s[4:5], s6
    v_lshl_add_u32 v1, v0, 4, s85
    v_add_u32 v2, 0x10000, v1
    v_add_u32 v25, s91, v24
    v_add_u32 v25, 1024, v25
    s_and_b32 s88, s99, 3
    s_lshl_b32 s88, s88, 8
    s_cmp_eq_u32 s38, 0
    s_cbranch_scc1 Lsp108
Lwa110:
    ds_read_b32 v27, v29 offset:0
    s_waitcnt lgkmcnt(0)
    v_cmp_gt_u32 vcc, 8, v27
    s_cbranch_vccz Lwd111
    s_sleep 1
    s_sub_u32 s101, s101, 1
    s_cbranch_scc0 Lwa110
    s_mov_b32 s101, 0
Lwd111:
    s_add_u32 m0, s85, 16384
    s_add_u32 s86, s89, 0
    s_waitcnt vmcnt(12)
    buffer_load_dwordx4 v16, s[56:59], s86 offen offset:0 lds
    buffer_load_dwordx4 v17, s[56:59], s86 offen offset:1024 lds
    buffer_load_dwordx4 v18, s[56:59], s86 offen offset:2048 lds
    buffer_load_dwordx4 v19, s[56:59], s86 offen offset:3072 lds
    s_add_u32 m0, s85, 24576
    s_add_u32 s86, s89, 229376
    s_waitcnt vmcnt(12)
    buffer_load_dwordx4 v16, s[56:59], s86 offen offset:0 lds
    buffer_load_dwordx4 v17, s[56:59], s86 offen offset:1024 lds
    buffer_load_dwordx4 v18, s[56:59], s86 offen offset:2048 lds
    buffer_load_dwordx4 v19, s[56:59], s86 offen offset:3072 lds
Lwa112:
    ds_read_b32 v27, v24 offset:1536
    s_waitcnt lgkmcnt(0)
    v_cmp_gt_u32 vcc, 3, v27
    s_cbranch_vccz Lwd113
    s_sleep 1
    s_sub_u32 s101, s101, 1
    s_cbranch_scc0 Lwa112
    s_mov_b32 s101, 0
Lwd113:
    v_lshlrev_b32 v20, 7, v0
    s_lshr_b32 s6, s2, 1
    s_lshl_b32 s6, s6, 1
    s_add_u32 s6, s6, s84
    s_and_b32 s7, s2, 1
    s_lshl_b32 s7, s7, 8
    s_add_u32 s6, s6, s7
    s_lshl_b32 s90, s6, 10
    s_mul_i32 s86, s6, 3584
    s_mov_b64 exec, 0xfffffff
    buffer_load_dword v40, v20, s[64:67], s86 offen
    s_mov_b64 exec, 0xff
    buffer_load_dword v41, v20, s[60:63], s90 offen
    s_mov_b64 exec, -1
    s_add_u32 m0, s85, 32768
    s_add_u32 s86, s89, 458752
    s_waitcnt vmcnt(12)
    buffer_load_dwordx4 v16, s[56:59], s86 offen offset:0 lds
    buffer_load_dwordx4 v17, s[56:59], s86 offen offset:1024 lds
    buffer_load_dwordx4 v18, s[56:59], s86 offen offset:2048 lds
    buffer_load_dwordx4 v19, s[56:59], s86 offen offset:3072 lds
    s_add_u32 m0, s85, 40960
    s_add_u32 s86, s89, 688128
    s_waitcnt vmcnt(12)
    buffer_load_dwordx4 v16, s[56:59], s86 offen offset:0 lds
    buffer_load_dwordx4 v17, s[56:59], s86 offen offset:1024 lds
    buffer_load_dwordx4 v18, s[56:59], s86 offen offset:2048 lds
    buffer_load_dwordx4 v19, s[56:59], s86 offen offset:3072 lds
    s_add_u32 m0, s85, 49152
    s_add_u32 s86, s89, 917504
    s_waitcnt vmcnt(12)
    buffer_load_dwordx4 v16, s[56:59], s86 offen offset:0 lds
    buffer_load_dwordx4 v17, s[56:59], s86 offen offset:1024 lds
    buffer_load_dwordx4 v18, s[56:59], s86 offen offset:2048 lds
    buffer_load_dwordx4 v19, s[56:59], s86 offen offset:3072 lds
    s_add_u32 m0, s85, 57344
    s_add_u32 s86, s89, 1146880
    s_waitcnt vmcnt(12)
    buffer_load_dwordx4 v16, s[56:59], s86 offen offset:0 lds
    buffer_load_dwordx4 v17, s[56:59], s86 offen offset:1024 lds
    buffer_load_dwordx4 v18, s[56:59], s86 offen offset:2048 lds
    buffer_load_dwordx4 v19, s[56:59], s86 offen offset:3072 lds
    s_add_u32 m0, s85, 65536
    s_add_u32 s86, s89, 1376256
    s_waitcnt vmcnt(12)
    buffer_load_dwordx4 v16, s[56:59], s86 offen offset:0 lds
    buffer_load_dwordx4 v17, s[56:59], s86 offen offset:1024 lds
    buffer_load_dwordx4 v18, s[56:59], s86 offen offset:2048 lds
    buffer_load_dwordx4 v19, s[56:59], s86 offen offset:3072 lds
    s_add_u32 m0, s85, 73728
    s_add_u32 s86, s89, 1605632
    s_waitcnt vmcnt(12)
    buffer_load_dwordx4 v16, s[56:59], s86 offen offset:0 lds
    buffer_load_dwordx4 v17, s[56:59], s86 offen offset:1024 lds
    buffer_load_dwordx4 v18, s[56:59], s86 offen offset:2048 lds
    buffer_load_dwordx4 v19, s[56:59], s86 offen offset:3072 lds
    s_add_u32 m0, s85, 81920
    s_add_u32 s86, s89, 128
    s_waitcnt vmcnt(12)
    buffer_load_dwordx4 v16, s[56:59], s86 offen offset:0 lds
    buffer_load_dwordx4 v17, s[56:59], s86 offen offset:1024 lds
    buffer_load_dwordx4 v18, s[56:59], s86 offen offset:2048 lds
    buffer_load_dwordx4 v19, s[56:59], s86 offen offset:3072 lds
    s_add_u32 m0, s85, 90112
    s_add_u32 s86, s89, 229504
    s_waitcnt vmcnt(12)
    buffer_load_dwordx4 v16, s[56:59], s86 offen offset:0 lds
    buffer_load_dwordx4 v17, s[56:59], s86 offen offset:1024 lds
    buffer_load_dwordx4 v18, s[56:59], s86 offen offset:2048 lds
    buffer_load_dwordx4 v19, s[56:59], s86 offen offset:3072 lds
    s_add_u32 m0, s85, 0
    s_add_u32 s86, s89, 458880
    s_waitcnt vmcnt(12)
    buffer_load_dwordx4 v16, s[56:59], s86 offen offset:0 lds
    buffer_load_dwordx4 v17, s[56:59], s86 offen offset:1024 lds
    buffer_load_dwordx4 v18, s[56:59], s86 offen offset:2048 lds
    buffer_load_dwordx4 v19, s[56:59], s86 offen offset:3072 lds
    s_add_u32 m0, s85, 8192
    s_add_u32 s86, s89, 688256
    s_waitcnt vmcnt(12)
    buffer_load_dwordx4 v16, s[56:59], s86 offen offset:0 lds
    buffer_load_dwordx4 v17, s[56:59], s86 offen offset:1024 lds
    buffer_load_dwordx4 v18, s[56:59], s86 offen offset:2048 lds
    buffer_load_dwordx4 v19, s[56:59], s86 offen offset:3072 lds
    s_add_u32 m0, s91, 148356
    s_nop 0
    global_load_lds_dword v28, s[4:5] offset:124
Lwa114:
    ds_read_b32 v27, v29 offset:0
    s_waitcnt lgkmcnt(0)
    v_cmp_gt_u32 vcc, 10, v27
    s_cbranch_vccz Lwd115
    s_sleep 1
    s_sub_u32 s101, s101, 1
    s_cbranch_scc0 Lwa114
    s_mov_b32 s101, 0
Lwd115:
    s_add_u32 m0, s85, 98304
    s_add_u32 s86, s89, 917632
    s_waitcnt vmcnt(12)
    buffer_load_dwordx4 v16, s[56:59], s86 offen offset:0 lds
    buffer_load_dwordx4 v17, s[56:59], s86 offen offset:1024 lds
    buffer_load_dwordx4 v18, s[56:59], s86 offen offset:2048 lds
    buffer_load_dwordx4 v19, s[56:59], s86 offen offset:3072 lds
    s_add_u32 m0, s85, 106496
    s_add_u32 s86, s89, 1147008
    s_waitcnt vmcnt(12)
    buffer_load_dwordx4 v16, s[56:59], s86 offen offset:0 lds
    buffer_load_dwordx4 v17, s[56:59], s86 offen offset:1024 lds
    buffer_load_dwordx4 v18, s[56:59], s86 offen offset:2048 lds
    buffer_load_dwordx4 v19, s[56:59], s86 offen offset:3072 lds
    s_add_u32 m0, s85, 114688
    s_add_u32 s86, s89, 1376384
    s_waitcnt vmcnt(12)
    buffer_load_dwordx4 v16, s[56:59], s86 offen offset:0 lds
    buffer_load_dwordx4 v17, s[56:59], s86 offen offset:1024 lds
    buffer_load_dwordx4 v18, s[56:59], s86 offen offset:2048 lds
    buffer_load_dwordx4 v19, s[56:59], s86 offen offset:3072 lds
    s_add_u32 m0, s85, 122880
    s_add_u32 s86, s89, 1605760
    s_waitcnt vmcnt(12)
    buffer_load_dwordx4 v16, s[56:59], s86 offen offset:0 lds
    buffer_load_dwordx4 v17, s[56:59], s86 offen offset:1024 lds
    buffer_load_dwordx4 v18, s[56:59], s86 offen offset:2048 lds
    buffer_load_dwordx4 v19, s[56:59], s86 offen offset:3072 lds
    s_add_u32 m0, s91, 148348
    s_nop 0
    global_load_lds_dword v28, s[4:5] offset:132
Lsj109:
    s_cmp_ge_u32 s44, 28
    s_cselect_b32 s68, s60, s64
    s_cselect_b32 s69, s61, s65
    s_cselect_b32 s70, s62, s66
    s_cselect_b32 s6, 28, 0
    s_sub_u32 s6, s44, s6
    s_lshl_b32 s6, s6, 16
    s_add_u32 s90, s6, s88
    s_add_u32 m0, s85, 131072
    s_add_u32 s86, s90, 0
    s_waitcnt vmcnt(12)
    buffer_load_dwordx4 v8, s[68:71], s86 offen offset:0 lds
    buffer_load_dwordx4 v9, s[68:71], s86 offen offset:1024 lds
    buffer_load_dwordx4 v10, s[68:71], s86 offen offset:2048 lds
    buffer_load_dwordx4 v11, s[68:71], s86 offen offset:3072 lds
    s_add_u32 m0, s85, 139264
    s_add_u32 s86, s90, 128
    s_waitcnt vmcnt(12)
    buffer_load_dwordx4 v8, s[68:71], s86 offen offset:0 lds
    buffer_load_dwordx4 v9, s[68:71], s86 offen offset:1024 lds
    buffer_load_dwordx4 v10, s[68:71], s86 offen offset:2048 lds
    buffer_load_dwordx4 v11, s[68:71], s86 offen offset:3072 lds
Lwa120:
    ds_read_b32 v27, v29 offset:0
    s_waitcnt lgkmcnt(0)
    v_cmp_gt_u32 vcc, 11, v27
    s_cbranch_vccz Lwd121
    s_sleep 1
    s_sub_u32 s101, s101, 1
    s_cbranch_scc0 Lwa120
    s_mov_b32 s101, 0
Lwd121:
    s_cmp_ge_u32 s40, 28
    s_cselect_b32 s68, s60, s64
    s_cselect_b32 s69, s61, s65
    s_cselect_b32 s70, s62, s66
    s_cselect_b32 s6, 28, 0
    s_sub_u32 s6, s40, s6
    s_lshl_b32 s6, s6, 16
    s_add_u32 s90, s6, s88
    s_add_u32 m0, s85, 16384
    s_add_u32 s86, s90, 0
    s_waitcnt vmcnt(12)
    buffer_load_dwordx4 v8, s[68:71], s86 offen offset:0 lds
    buffer_load_dwordx4 v9, s[68:71], s86 offen offset:1024 lds
    buffer_load_dwordx4 v10, s[68:71], s86 offen offset:2048 lds
    buffer_load_dwordx4 v11, s[68:71], s86 offen offset:3072 lds
    s_add_u32 m0, s85, 24576
    s_add_u32 s86, s90, 128
    s_waitcnt vmcnt(12)
    buffer_load_dwordx4 v8, s[68:71], s86 offen offset:0 lds
    buffer_load_dwordx4 v9, s[68:71], s86 offen offset:1024 lds
    buffer_load_dwordx4 v10, s[68:71], s86 offen offset:2048 lds
    buffer_load_dwordx4 v11, s[68:71], s86 offen offset:3072 lds
    s_cmp_ge_u32 s41, 28
    s_cselect_b32 s68, s60, s64
    s_cselect_b32 s69, s61, s65
    s_cselect_b32 s70, s62, s66
    s_cselect_b32 s6, 28, 0
    s_sub_u32 s6, s41, s6
    s_lshl_b32 s6, s6, 16
    s_add_u32 s90, s6, s88
    s_add_u32 m0, s85, 32768
    s_add_u32 s86, s90, 0
    s_waitcnt vmcnt(12)
    buffer_load_dwordx4 v8, s[68:71], s86 offen offset:0 lds
    buffer_load_dwordx4 v9, s[68:71], s86 offen offset:1024 lds
    buffer_load_dwordx4 v10, s[68:71], s86 offen offset:2048 lds
    buffer_load_dwordx4 v11, s[68:71], s86 offen offset:3072 lds
    s_add_u32 m0, s85, 40960
    s_add_u32 s86, s90, 128
    s_waitcnt vmcnt(12)
    buffer_load_dwordx4 v8, s[68:71], s86 offen offset:0 lds
    buffer_load_dwordx4 v9, s[68:71], s86 offen offset:1024 lds
    buffer_load_dwordx4 v10, s[68:71], s86 offen offset:2048 lds
    buffer_load_dwordx4 v11, s[68:71], s86 offen offset:3072 lds
    s_cmp_ge_u32 s42, 28
    s_cselect_b32 s68, s60, s64
    s_cselect_b32 s69, s61, s65
    s_cselect_b32 s70, s62, s66
    s_cselect_b32 s6, 28, 0
    s_sub_u32 s6, s42, s6
    s_lshl_b32 s6, s6, 16
    s_add_u32 s90, s6, s88
    s_add_u32 m0, s85, 49152
    s_add_u32 s86, s90, 0
    s_waitcnt vmcnt(12)
    buffer_load_dwordx4 v8, s[68:71], s86 offen offset:0 lds
    buffer_load_dwordx4 v9, s[68:71], s86 offen offset:1024 lds
    buffer_load_dwordx4 v10, s[68:71], s86 offen offset:2048 lds
    buffer_load_dwordx4 v11, s[68:71], s86 offen offset:3072 lds
    s_add_u32 m0, s85, 57344
    s_add_u32 s86, s90, 128
    s_waitcnt vmcnt(12)
    buffer_load_dwordx4 v8, s[68:71], s86 offen offset:0 lds
    buffer_load_dwordx4 v9, s[68:71], s86 offen offset:1024 lds
    buffer_load_dwordx4 v10, s[68:71], s86 offen offset:2048 lds
    buffer_load_dwordx4 v11, s[68:71], s86 offen offset:3072 lds
    s_cmp_ge_u32 s43, 28
    s_cselect_b32 s68, s60, s64
    s_cselect_b32 s69, s61, s65
    s_cselect_b32 s70, s62, s66
    s_cselect_b32 s6, 28, 0
    s_sub_u32 s6, s43, s6
    s_lshl_b32 s6, s6, 16
    s_add_u32 s90, s6, s88
    s_add_u32 m0, s85, 65536
    s_add_u32 s86, s90, 0
    s_waitcnt vmcnt(12)
    buffer_load_dwordx4 v8, s[68:71], s86 offen offset:0 lds
    buffer_load_dwordx4 v9, s[68:71], s86 offen offset:1024 lds
    buffer_load_dwordx4 v10, s[68:71], s86 offen offset:2048 lds
    buffer_load_dwordx4 v11, s[68:71], s86 offen offset:3072 lds
    s_add_u32 m0, s85, 73728
    s_add_u32 s86, s90, 128
    s_waitcnt vmcnt(12)
    buffer_load_dwordx4 v8, s[68:71], s86 offen offset:0 lds
    buffer_load_dwordx4 v9, s[68:71], s86 offen offset:1024 lds
    buffer_load_dwordx4 v10, s[68:71], s86 offen offset:2048 lds
    buffer_load_dwordx4 v11, s[68:71], s86 offen offset:3072 lds
    s_add_u32 m0, s91, 148344
    s_nop 0
    global_load_lds_dword v28, s[4:5] offset:136
Lwa122:
    ds_read_b32 v27, v29 offset:0
    s_waitcnt lgkmcnt(0)
    v_cmp_gt_u32 vcc, 12, v27
    s_cbranch_vccz Lwd123
    s_sleep 1
    s_sub_u32 s101, s101, 1
    s_cbranch_scc0 Lwa122
    s_mov_b32 s101, 0
Lwd123:
    s_cmp_ge_u32 s45, 28
    s_cselect_b32 s68, s60, s64
    s_cselect_b32 s69, s61, s65
    s_cselect_b32 s70, s62, s66
    s_cselect_b32 s6, 28, 0
    s_sub_u32 s6, s45, s6
    s_lshl_b32 s6, s6, 16
    s_add_u32 s90, s6, s88
    s_add_u32 m0, s85, 81920
    s_add_u32 s86, s90, 0
    s_waitcnt vmcnt(12)
    buffer_load_dwordx4 v8, s[68:71], s86 offen offset:0 lds
    buffer_load_dwordx4 v9, s[68:71], s86 offen offset:1024 lds
    buffer_load_dwordx4 v10, s[68:71], s86 offen offset:2048 lds
    buffer_load_dwordx4 v11, s[68:71], s86 offen offset:3072 lds
    s_add_u32 m0, s85, 90112
    s_add_u32 s86, s90, 128
    s_waitcnt vmcnt(12)
    buffer_load_dwordx4 v8, s[68:71], s86 offen offset:0 lds
    buffer_load_dwordx4 v9, s[68:71], s86 offen offset:1024 lds
    buffer_load_dwordx4 v10, s[68:71], s86 offen offset:2048 lds
    buffer_load_dwordx4 v11, s[68:71], s86 offen offset:3072 lds
    s_add_u32 m0, s91, 148340
    s_nop 0
    global_load_lds_dword v28, s[4:5] offset:140
    s_cmp_ge_u32 s48, 28
    s_cselect_b32 s68, s60, s64
    s_cselect_b32 s69, s61, s65
    s_cselect_b32 s70, s62, s66
    s_cselect_b32 s6, 28, 0
    s_sub_u32 s6, s48, s6
    s_lshl_b32 s6, s6, 16
    s_add_u32 s90, s6, s88
    s_add_u32 m0, s85, 0
    s_add_u32 s86, s90, 0
    s_waitcnt vmcnt(12)
    buffer_load_dwordx4 v8, s[68:71], s86 offen offset:0 lds
    buffer_load_dwordx4 v9, s[68:71], s86 offen offset:1024 lds
    buffer_load_dwordx4 v10, s[68:71], s86 offen offset:2048 lds
    buffer_load_dwordx4 v11, s[68:71], s86 offen offset:3072 lds
    s_add_u32 m0, s85, 8192
    s_add_u32 s86, s90, 128
    s_waitcnt vmcnt(12)
    buffer_load_dwordx4 v8, s[68:71], s86 offen offset:0 lds
    buffer_load_dwordx4 v9, s[68:71], s86 offen offset:1024 lds
    buffer_load_dwordx4 v10, s[68:71], s86 offen offset:2048 lds
    buffer_load_dwordx4 v11, s[68:71], s86 offen offset:3072 lds
Lwa124:
    ds_read_b32 v27, v29 offset:0
    s_waitcnt lgkmcnt(0)
    v_cmp_gt_u32 vcc, 13, v27
    s_cbranch_vccz Lwd125
    s_sleep 1
    s_sub_u32 s101, s101, 1
    s_cbranch_scc0 Lwa124
    s_mov_b32 s101, 0
Lwd125:
    s_cmp_ge_u32 s46, 28
    s_cselect_b32 s68, s60, s64
    s_cselect_b32 s69, s61, s65
    s_cselect_b32 s70, s62, s66
    s_cselect_b32 s6, 28, 0
    s_sub_u32 s6, s46, s6
    s_lshl_b32 s6, s6, 16
    s_add_u32 s90, s6, s88
    s_add_u32 m0, s85, 98304
    s_add_u32 s86, s90, 0
    s_waitcnt vmcnt(12)
    buffer_load_dwordx4 v8, s[68:71], s86 offen offset:0 lds
    buffer_load_dwordx4 v9, s[68:71], s86 offen offset:1024 lds
    buffer_load_dwordx4 v10, s[68:71], s86 offen offset:2048 lds
    buffer_load_dwordx4 v11, s[68:71], s86 offen offset:3072 lds
    s_add_u32 m0, s85, 106496
    s_add_u32 s86, s90, 128
    s_waitcnt vmcnt(12)
    buffer_load_dwordx4 v8, s[68:71], s86 offen offset:0 lds
    buffer_load_dwordx4 v9, s[68:71], s86 offen offset:1024 lds
    buffer_load_dwordx4 v10, s[68:71], s86 offen offset:2048 lds
    buffer_load_dwordx4 v11, s[68:71], s86 offen offset:3072 lds
    s_cmp_ge_u32 s47, 28
    s_cselect_b32 s68, s60, s64
    s_cselect_b32 s69, s61, s65
    s_cselect_b32 s70, s62, s66
    s_cselect_b32 s6, 28, 0
    s_sub_u32 s6, s47, s6
    s_lshl_b32 s6, s6, 16
    s_add_u32 s90, s6, s88
    s_add_u32 m0, s85, 114688
    s_add_u32 s86, s90, 0
    s_waitcnt vmcnt(12)
    buffer_load_dwordx4 v8, s[68:71], s86 offen offset:0 lds
    buffer_load_dwordx4 v9, s[68:71], s86 offen offset:1024 lds
    buffer_load_dwordx4 v10, s[68:71], s86 offen offset:2048 lds
    buffer_load_dwordx4 v11, s[68:71], s86 offen offset:3072 lds
    s_add_u32 m0, s85, 122880
    s_add_u32 s86, s90, 128
    s_waitcnt vmcnt(12)
    buffer_load_dwordx4 v8, s[68:71], s86 offen offset:0 lds
    buffer_load_dwordx4 v9, s[68:71], s86 offen offset:1024 lds
    buffer_load_dwordx4 v10, s[68:71], s86 offen offset:2048 lds
    buffer_load_dwordx4 v11, s[68:71], s86 offen offset:3072 lds
    s_add_u32 m0, s91, 148328
    s_nop 0
    global_load_lds_dword v28, s[4:5] offset:152
    s_waitcnt vmcnt(0)
    s_endpgm
Lmisc:
    s_mov_b32 s44, s8
    s_and_b32 s45, s9, 0xffff
    s_mov_b32 s46, 2097152
    s_mov_b32 s47, 0x20000
    s_lshl_b32 s6, s35, 3
    s_add_u32 s60, s6, s34
    s_lshl_b32 s6, s60, 13
    v_lshlrev_b32 v4, 4, v0
    s_add_u32 s7, s6, 4096
    buffer_load_dwordx4 v[32:35], v4, s[44:47], s6 offen offset:0
    buffer_load_dwordx4 v[36:39], v4, s[44:47], s6 offen offset:1024
    buffer_load_dwordx4 v[40:43], v4, s[44:47], s6 offen offset:2048
    buffer_load_dwordx4 v[44:47], v4, s[44:47], s6 offen offset:3072
    buffer_load_dwordx4 v[48:51], v4, s[44:47], s7 offen offset:0
    buffer_load_dwordx4 v[52:55], v4, s[44:47], s7 offen offset:1024
    buffer_load_dwordx4 v[56:59], v4, s[44:47], s7 offen offset:2048
    buffer_load_dwordx4 v[60:63], v4, s[44:47], s7 offen offset:3072
    s_and_b32 s6, s2, 6
    s_lshl_b32 s6, s6, 4
    s_add_u32 s59, s6, s33
    s_mul_i32 s61, s59, 4682
    s_lshr_b32 s61, s61, 16
    s_mul_i32 s6, s61, 14
    s_sub_u32 s62, s59, s6
    s_and_b32 s6, s2, 1
    s_mul_i32 s6, s6, 14
    s_add_u32 s62, s62, s6
    s_lshr_b32 s39, s59, 5
    s_cmp_eq_u32 s39, 0
    s_cselect_b32 s40, s16, s10
    s_cselect_b32 s41, s17, s11
    s_mov_b32 s7, 1572864
    s_cselect_b32 s42, 524288, s7
    s_movk_i32 s7, 3072
    s_cselect_b32 s58, 1024, s7
    s_cselect_b32 s57, 0, 1
    s_and_b32 s41, s41, 0xffff
    s_mov_b32 s43, 0x20000
    v_lshrrev_b32 v1, 2, v0
    v_mul_u32_u24 v1, s58, v1
    v_and_b32 v2, 3, v0
    v_lshl_add_u32 v1, v2, 7, v1
    s_and_b32 s6, s59, 31
    s_lshl_b32 s6, s6, 4
    s_mul_i32 s6, s6, s58
    s_sub_u32 s7, s39, s57
    s_lshl_b32 s7, s7, 10
    s_add_u32 s6, s6, s7
    s_xor_b32 s7, s39, s2
    s_and_b32 s7, s7, 1
    s_lshl_b32 s7, s7, 9
    s_add_u32 s6, s6, s7
    buffer_load_dword v254, v1, s[40:43], s6 offen
    s_mov_b32 s48, s24
    s_and_b32 s49, s25, 0xffff
    s_mov_b32 s50, 1024
    s_mov_b32 s51, 0x20000
    buffer_load_dwordx4 v[64:67], v4, s[48:51], 0 offen
    s_mov_b32 s52, s20
    s_and_b32 s53, s21, 0xffff
    s_mov_b32 s54, 1835008
    s_mov_b32 s55, 0x20000
    s_mov_b32 s72, s30
    s_and_b32 s73, s31, 0xffff
    s_mov_b32 s74, 29360128
    s_mov_b32 s75, 0x20000
    s_and_b32 s99, s33, 7
    s_lshr_b32 s6, s33, 3
    s_lshl_b32 s100, s32, 2
    s_add_u32 s100, s100, s6
    s_and_b32 s36, s2, 6
    s_lshl_b32 s36, s36, 1
    s_add_u32 s36, s36, s6
    s_cmp_lt_u32 s99, 7
    s_cselect_b32 s38, 1, 0
    s_min_u32 s37, s99, 6
    s_and_b32 s6, s2, 1
    s_mul_i32 s6, s6, 7
    s_add_u32 s37, s37, s6
    v_lshrrev_b32 v2, 3, v0
    v_and_b32 v3, 7, v0
    v_lshlrev_b32 v3, 4, v3
    v_mul_u32_u24 v5, 3584, v2
    v_add_u32 v5, v5, v3
    v_add_u32 v25, 1792, v24
    s_mov_b32 s44, s10
    s_and_b32 s45, s11, 0xffff
    s_mov_b32 s46, 1572864
    s_mov_b32 s47, 0x20000
    s_bitcmp1_b32 s2, 0
    s_cselect_b32 s40, s10, s18
    s_cselect_b32 s41, s11, s19
    s_mov_b32 s7, 524288
    s_cselect_b32 s42, 1572864, s7
    s_movk_i32 s7, 1024
    s_cselect_b32 s68, 3072, s7
    s_cselect_b32 s69, 0, s7
    s_cselect_b32 s67, 2048, 0
    s_and_b32 s41, s41, 0xffff
    s_mov_b32 s43, 0x20000
    s_lshl_b32 s6, s33, 4
    v_add_u32 v20, s6, v0
    v_mul_u32_u24 v21, s68, v20
    v_mul_u32_u24 v20, 3072, v20
    s_mov_b32 s63, 1
    s_lshl_b32 s6, s35, 2
    s_lshl_b32 s6, s6, 7
    s_add_u32 s8, s30, s6
    s_addc_u32 s9, s31, 0
    s_bitcmp1_b32 s34, 1
    s_cselect_b32 s6, 31, 1
    s_add_u32 s6, s6, s35
    s_and_b32 s6, s6, 31
    s_lshl_b32 s6, s6, 2
    s_lshl_b32 s6, s6, 7
    s_add_u32 s10, s30, s6
    s_addc_u32 s11, s31, 0
    s_lshr_b32 s7, s35, 2
    s_lshl_b32 s7, s7, 4
    s_add_u32 s58, s7, 16
    s_and_b32 s58, s58, 0x70
    s_xor_b32 s39, s34, 4
    s_lshl_b32 s39, s39, 1
    s_add_u32 s6, s7, s39
    s_lshl_b32 s6, s6, 7
    s_add_u32 s12, s30, s6
    s_addc_u32 s13, s31, 0
    s_xor_b32 s39, s34, 2
    s_lshl_b32 s39, s39, 1
    s_add_u32 s6, s7, s39
    s_lshl_b32 s6, s6, 7
    s_add_u32 s14, s30, s6
    s_addc_u32 s15, s31, 0
    s_add_u32 s6, s58, s39
    s_lshl_b32 s6, s6, 7
    s_add_u32 s16, s30, s6
    s_addc_u32 s17, s31, 0
    s_xor_b32 s39, s34, 5
    s_lshl_b32 s39, s39, 1
    s_add_u32 s6, s7, s39
    s_lshl_b32 s6, s6, 7
    s_add_u32 s18, s30, s6
    s_addc_u32 s19, s31, 0
    s_add_u32 s6, s58, s39
    s_lshl_b32 s6, s6, 7
    s_add_u32 s20, s30, s6
    s_addc_u32 s21, s31, 0
    s_lshr_b32 s6, s35, 1
    s_lshl_b32 s6, s6, 3
    s_lshl_b32 s6, s6, 7
    s_add_u32 s22, s30, s6
    s_addc_u32 s23, s31, 0
    s_and_b32 s6, s32, 3
    s_cselect_b32 s6, 2, 0
    s_and_b32 s7, s32, 4
    s_add_u32 s6, s6, s7
    s_lshl_b32 s7, s99, 4
    s_add_u32 s6, s6, s7
    s_lshl_b32 s6, s6, 7
    s_add_u32 s24, s30, s6
    s_addc_u32 s25, s31, 0
    s_and_b32 s39, s2, 1
    s_lshl_b32 s39, s39, 1
    s_lshr_b32 s6, s99, 2
    s_add_u32 s39, s39, s6
    s_lshl_b32 s7, s36, 3
    s_lshl_b32 s6, s39, 1
    s_add_u32 s6, s6, s7
    s_lshl_b32 s6, s6, 7
    s_add_u32 s26, s30, s6
    s_addc_u32 s27, s31, 0
    v_mov_b32 v72, 0
    v_mov_b32 v73, 0
    v_mov_b32 v74, 0
    v_mov_b32 v75, 0
    v_mov_b32 v76, 0
    v_mov_b32 v77, 0
    v_mov_b32 v78, 0
    v_mov_b32 v79, 0
    s_waitcnt vmcnt(0)
    v_dot2c_f32_bf16 v72, v32, v64
    v_dot2c_f32_bf16 v73, v36, v64
    v_dot2c_f32_bf16 v74, v40, v64
    v_dot2c_f32_bf16 v75, v44, v64
    v_dot2c_f32_bf16 v76, v48, v64
    v_dot2c_f32_bf16 v77, v52, v64
    v_dot2c_f32_bf16 v78, v56, v64
    v_dot2c_f32_bf16 v79, v60, v64
    v_dot2c_f32_bf16 v72, v33, v65
    v_dot2c_f32_bf16 v73, v37, v65
    v_dot2c_f32_bf16 v74, v41, v65
    v_dot2c_f32_bf16 v75, v45, v65
    v_dot2c_f32_bf16 v76, v49, v65
    v_dot2c_f32_bf16 v77, v53, v65
    v_dot2c_f32_bf16 v78, v57, v65
    v_dot2c_f32_bf16 v79, v61, v65
    v_dot2c_f32_bf16 v72, v34, v66
    v_dot2c_f32_bf16 v73, v38, v66
    v_dot2c_f32_bf16 v74, v42, v66
    v_dot2c_f32_bf16 v75, v46, v66
    v_dot2c_f32_bf16 v76, v50, v66
    v_dot2c_f32_bf16 v77, v54, v66
    v_dot2c_f32_bf16 v78, v58, v66
    v_dot2c_f32_bf16 v79, v62, v66
    v_dot2c_f32_bf16 v72, v35, v67
    v_dot2c_f32_bf16 v73, v39, v67
    v_dot2c_f32_bf16 v74, v43, v67
    v_dot2c_f32_bf16 v75, v47, v67
    v_dot2c_f32_bf16 v76, v51, v67
    v_dot2c_f32_bf16 v77, v55, v67
    v_dot2c_f32_bf16 v78, v59, v67
    v_dot2c_f32_bf16 v79, v63, v67
    v_permlane32_swap_b32 v72, v76
    v_permlane32_swap_b32 v73, v77
    v_permlane32_swap_b32 v74, v78
    v_permlane32_swap_b32 v75, v79
    v_add_f32 v72, v72, v76
    v_add_f32 v73, v73, v77
    v_add_f32 v74, v74, v78
    v_add_f32 v75, v75, v79
    s_nop 0
    v_permlane16_swap_b32 v72, v74
    v_permlane16_swap_b32 v73, v75
    v_add_f32 v72, v72, v74
    v_add_f32 v73, v73, v75
    s_nop 0
    v_add_f32_dpp v72, v72, v72 row_ror:8 row_mask:0xf bank_mask:0xf
    v_add_f32_dpp v73, v73, v73 row_ror:8 row_mask:0xf bank_mask:0xf
    s_mov_b32 vcc_lo, 0xff00ff00
    s_mov_b32 vcc_hi, 0xff00ff00
    v_cndmask_b32 v6, v72, v73, vcc
    s_nop 1
    v_add_f32_dpp v6, v6, v6 quad_perm:[1,0,3,2] row_mask:0xf bank_mask:0xf
    s_nop 1
    v_add_f32_dpp v6, v6, v6 quad_perm:[2,3,0,1] row_mask:0xf bank_mask:0xf
    s_nop 1
    v_add_f32_dpp v6, v6, v6 row_half_mirror row_mask:0xf bank_mask:0xf
    v_mul_f32 v6, 0xbfb8aa3b, v6
    v_exp_f32 v6, v6
    s_nop 0
    v_add_f32 v6, 1.0, v6
    v_rcp_f32 v6, v6
    v_lshlrev_b32 v7, 2, v2
    s_lshl_b32 s6, s60, 5
    s_add_u32 s6, s6, 40960
    s_mov_b32 s7, 0x01010101
    s_mov_b32 exec_lo, s7
    s_mov_b32 exec_hi, s7
    buffer_store_dword v6, v7, s[72:75], s6 offen sc1
    s_mov_b64 exec, -1
    v_lshrrev_b32 v10, 1, v0
    v_lshlrev_b32 v10, 9, v10
    v_and_b32 v8, 1, v0
    v_lshl_add_u32 v10, v8, 6, v10
    v_add_u32 v10, 131072, v10
    s_cmp_eq_u32 s99, 0
    s_cselect_b32 vcc_lo, 0, -1
    s_mov_b32 vcc_hi, -1
    v_mov_b32 v8, 0x3f803f80
    v_cndmask_b32 v12, 0, v8, vcc
    v_cndmask_b32 v13, 0, v8, vcc
    v_cndmask_b32 v14, 0, v8, vcc
    v_cndmask_b32 v15, 0, v8, vcc
Lwa126:
    ds_read_b32 v27, v24 offset:1152
    s_waitcnt lgkmcnt(0)
    v_cmp_gt_u32 vcc, 3, v27
    s_cbranch_vccz Lwd127
    s_sleep 2
    s_sub_u32 s101, s101, 1
    s_cbranch_scc0 Lwa126
    s_mov_b32 s101, 0
Lwd127:
    s_mov_b64 exec, 0xffff
    buffer_load_dword v250, v20, s[44:47], s69 offen offset:384
    buffer_load_dword v251, v21, s[40:43], s67 offen offset:384
    s_mov_b64 exec, -1
    s_waitcnt vmcnt(0)
Lwa128:
    ds_read_b32 v27, v29 offset:0
    s_waitcnt lgkmcnt(0)
    v_cmp_gt_u32 vcc, 3, v27
    s_cbranch_vccz Lwd129
    s_sleep 8
    s_sub_u32 s101, s101, 1
    s_cbranch_scc0 Lwa128
    s_mov_b32 s101, 0
Lwd129:
    s_mov_b32 s5, 400000
    s_load_dword s4, s[28:29], 0
Lpc130:
    s_waitcnt lgkmcnt(0)
    s_cmp_ge_u32 s4, 18
    s_cbranch_scc1 Lpd131
    s_sub_u32 s5, s5, 1
    s_cbranch_scc1 Lpd131
    s_sleep 12
    s_load_dword s4, s[28:29], 0 glc
    s_branch Lpc130
Lpd131:
Lwa132:
    ds_read_b32 v27, v29 offset:0
    s_waitcnt lgkmcnt(0)
    v_cmp_gt_u32 vcc, 4, v27
    s_cbranch_vccz Lwd133
    s_sub_u32 s101, s101, 1
    s_cbranch_scc0 Lwa132
    s_mov_b32 s101, 0
Lwd133:
    s_atomic_add s63, s[8:9], 16
    s_atomic_add s63, s[8:9], 144
    s_atomic_add s63, s[8:9], 272
    s_atomic_add s63, s[8:9], 400
    s_atomic_add s63, s[10:11], 16
    s_atomic_add s63, s[10:11], 144
    s_atomic_add s63, s[10:11], 272
    s_atomic_add s63, s[10:11], 400
    s_mul_i32 s6, s61, 229376
    s_lshl_b32 s7, s62, 7
    s_add_u32 s6, s6, s7
    buffer_load_dwordx4 v[96:99], v5, s[52:55], s6 offen
    s_add_u32 s6, s6, 28672
    buffer_load_dwordx4 v[100:103], v5, s[52:55], s6 offen
    s_add_u32 s6, s6, 28672
    buffer_load_dwordx4 v[104:107], v5, s[52:55], s6 offen
    s_add_u32 s6, s6, 28672
    buffer_load_dwordx4 v[108:111], v5, s[52:55], s6 offen
    s_add_u32 s6, s6, 28672
    buffer_load_dwordx4 v[112:115], v5, s[52:55], s6 offen
    s_add_u32 s6, s6, 28672
    buffer_load_dwordx4 v[116:119], v5, s[52:55], s6 offen
    s_add_u32 s6, s6, 28672
    buffer_load_dwordx4 v[120:123], v5, s[52:55], s6 offen
    s_add_u32 s6, s6, 28672
    buffer_load_dwordx4 v[124:127], v5, s[52:55], s6 offen
Lwa134:
    ds_read_b32 v27, v29 offset:0
    s_waitcnt lgkmcnt(0)
    v_cmp_gt_u32 vcc, 6, v27
    s_cbranch_vccz Lwd135
    s_sub_u32 s101, s101, 1
    s_cbranch_scc0 Lwa134
    s_mov_b32 s101, 0
Lwd135:
    s_atomic_add s63, s[12:13], 0
    s_atomic_add s63, s[12:13], 128
    s_atomic_add s63, s[14:15], 0
    s_atomic_add s63, s[14:15], 128
    s_atomic_add s63, s[16:17], 0
    s_atomic_add s63, s[16:17], 128
    ds_write_b128 v10, v[12:15]
    v_mov_b32 v26, 1
    ds_write_b32 v25, v26
    v_mov_b32 v8, 0x3f80
    v_mov_b32 v9, 0x3f800000
    v_mov_b32 v128, 0
    v_mov_b32 v129, 0
    v_mov_b32 v130, 0
    v_mov_b32 v131, 0
    v_mov_b32 v132, 0
    v_mov_b32 v133, 0
    v_mov_b32 v134, 0
    v_mov_b32 v135, 0
    s_waitcnt vmcnt(7)
    v_dot2c_f32_bf16 v128, v96, v8
    v_dot2c_f32_bf16 v129, v96, v9
    v_dot2c_f32_bf16 v130, v97, v8
    v_dot2c_f32_bf16 v131, v97, v9
    v_dot2c_f32_bf16 v132, v98, v8
    v_dot2c_f32_bf16 v133, v98, v9
    v_dot2c_f32_bf16 v134, v99, v8
    v_dot2c_f32_bf16 v135, v99, v9
    s_waitcnt vmcnt(6)
    v_dot2c_f32_bf16 v128, v100, v8
    v_dot2c_f32_bf16 v129, v100, v9
    v_dot2c_f32_bf16 v130, v101, v8
    v_dot2c_f32_bf16 v131, v101, v9
    v_dot2c_f32_bf16 v132, v102, v8
    v_dot2c_f32_bf16 v133, v102, v9
    v_dot2c_f32_bf16 v134, v103, v8
    v_dot2c_f32_bf16 v135, v103, v9
    s_waitcnt vmcnt(5)
    v_dot2c_f32_bf16 v128, v104, v8
    v_dot2c_f32_bf16 v129, v104, v9
    v_dot2c_f32_bf16 v130, v105, v8
    v_dot2c_f32_bf16 v131, v105, v9
    v_dot2c_f32_bf16 v132, v106, v8
    v_dot2c_f32_bf16 v133, v106, v9
    v_dot2c_f32_bf16 v134, v107, v8
    v_dot2c_f32_bf16 v135, v107, v9
    s_waitcnt vmcnt(4)
    v_dot2c_f32_bf16 v128, v108, v8
    v_dot2c_f32_bf16 v129, v108, v9
    v_dot2c_f32_bf16 v130, v109, v8
    v_dot2c_f32_bf16 v131, v109, v9
    v_dot2c_f32_bf16 v132, v110, v8
    v_dot2c_f32_bf16 v133, v110, v9
    v_dot2c_f32_bf16 v134, v111, v8
    v_dot2c_f32_bf16 v135, v111, v9
    s_waitcnt vmcnt(3)
    v_dot2c_f32_bf16 v128, v112, v8
    v_dot2c_f32_bf16 v129, v112, v9
    v_dot2c_f32_bf16 v130, v113, v8
    v_dot2c_f32_bf16 v131, v113, v9
    v_dot2c_f32_bf16 v132, v114, v8
    v_dot2c_f32_bf16 v133, v114, v9
    v_dot2c_f32_bf16 v134, v115, v8
    v_dot2c_f32_bf16 v135, v115, v9
    s_waitcnt vmcnt(2)
    v_dot2c_f32_bf16 v128, v116, v8
    v_dot2c_f32_bf16 v129, v116, v9
    v_dot2c_f32_bf16 v130, v117, v8
    v_dot2c_f32_bf16 v131, v117, v9
    v_dot2c_f32_bf16 v132, v118, v8
    v_dot2c_f32_bf16 v133, v118, v9
    v_dot2c_f32_bf16 v134, v119, v8
    v_dot2c_f32_bf16 v135, v119, v9
    s_waitcnt vmcnt(1)
    v_dot2c_f32_bf16 v128, v120, v8
    v_dot2c_f32_bf16 v129, v120, v9
    v_dot2c_f32_bf16 v130, v121, v8
    v_dot2c_f32_bf16 v131, v121, v9
    v_dot2c_f32_bf16 v132, v122, v8
    v_dot2c_f32_bf16 v133, v122, v9
    v_dot2c_f32_bf16 v134, v123, v8
    v_dot2c_f32_bf16 v135, v123, v9
    s_waitcnt vmcnt(0)
    v_dot2c_f32_bf16 v128, v124, v8
    v_dot2c_f32_bf16 v129, v124, v9
    v_dot2c_f32_bf16 v130, v125, v8
    v_dot2c_f32_bf16 v131, v125, v9
    v_dot2c_f32_bf16 v132, v126, v8
    v_dot2c_f32_bf16 v133, v126, v9
    v_dot2c_f32_bf16 v134, v127, v8
    v_dot2c_f32_bf16 v135, v127, v9
Lwa136:
    ds_read_b32 v27, v29 offset:0
    s_waitcnt lgkmcnt(0)
    v_cmp_gt_u32 vcc, 7, v27
    s_cbranch_vccz Lwd137
    s_sub_u32 s101, s101, 1
    s_cbranch_scc0 Lwa136
    s_mov_b32 s101, 0
Lwd137:
    s_atomic_add s63, s[18:19], 24
    s_atomic_add s63, s[18:19], 152
    s_atomic_add s63, s[20:21], 24
    s_atomic_add s63, s[20:21], 152
    v_permlane32_swap_b32 v128, v132
    v_permlane32_swap_b32 v129, v133
    v_permlane32_swap_b32 v130, v134
    v_permlane32_swap_b32 v131, v135
    v_add_f32 v128, v128, v132
    v_add_f32 v129, v129, v133
    v_add_f32 v130, v130, v134
    v_add_f32 v131, v131, v135
    s_nop 0
    v_permlane16_swap_b32 v128, v130
    v_permlane16_swap_b32 v129, v131
    v_add_f32 v128, v128, v130
    v_add_f32 v129, v129, v131
    s_nop 0
    v_add_f32_dpp v128, v128, v128 row_ror:8 row_mask:0xf bank_mask:0xf
    v_add_f32_dpp v129, v129, v129 row_ror:8 row_mask:0xf bank_mask:0xf
    s_mov_b32 vcc_lo, 0xff00ff00
    s_mov_b32 vcc_hi, 0xff00ff00
    v_cndmask_b32 v11, v128, v129, vcc
    v_lshlrev_b32 v7, 1, v3
    v_lshl_add_u32 v7, v2, 2, v7
    s_mul_i32 s6, s61, 7168
    s_lshl_b32 s7, s62, 8
    s_add_u32 s6, s6, s7
    s_add_u32 s6, s6, 49152
    s_cmp_lt_u32 s59, 112
    s_cselect_b32 s71, 1, 0
    s_cselect_b32 s6, s6, 1073741824
    buffer_store_dword v11, v7, s[72:75], s6 offen sc1
    s_lshr_b32 s70, s62, 1
    s_lshl_b32 s70, s70, 7
    s_add_u32 s70, s70, 16384
    s_waitcnt vmcnt(0)
    s_atomic_add s71, s[30:31], s70
Lwa138:
    ds_read_b32 v27, v29 offset:0
    s_waitcnt lgkmcnt(0)
    v_cmp_gt_u32 vcc, 9, v27
    s_cbranch_vccz Lwd139
    s_sub_u32 s101, s101, 1
    s_cbranch_scc0 Lwa138
    s_mov_b32 s101, 0
Lwd139:
    s_atomic_add s63, s[22:23], 4
    s_atomic_add s63, s[22:23], 132
    s_atomic_add s63, s[22:23], 260
    s_atomic_add s63, s[22:23], 388
    s_atomic_add s63, s[22:23], 516
    s_atomic_add s63, s[22:23], 644
    s_atomic_add s63, s[22:23], 772
    s_atomic_add s63, s[22:23], 900
Lwa140:
    ds_read_b32 v27, v24 offset:1536
    s_waitcnt lgkmcnt(0)
    v_cmp_gt_u32 vcc, 5, v27
    s_cbranch_vccz Lwd141
    s_sleep 8
    s_sub_u32 s101, s101, 1
    s_cbranch_scc0 Lwa140
    s_mov_b32 s101, 0
Lwd141:
    s_lshl_b32 s6, s37, 7
    s_add_u32 s6, s6, 16384
    s_mov_b32 s5, 400000
    s_load_dword s4, s[30:31], s6
Lpc142:
    s_waitcnt lgkmcnt(0)
    s_cmp_ge_u32 s4, 16
    s_cbranch_scc1 Lpd143
    s_sub_u32 s5, s5, 1
    s_cbranch_scc1 Lpd143
    s_sleep 12
    s_load_dword s4, s[30:31], s6 glc
    s_branch Lpc142
Lpd143:
    v_lshlrev_b32 v7, 3, v0
    s_lshl_b32 s6, s37, 9
    s_add_u32 s6, s6, 49152
    buffer_load_dwordx2 v[32:33], v7, s[72:75], s6 offen sc1
    s_add_u32 s6, s6, 7168
    buffer_load_dwordx2 v[34:35], v7, s[72:75], s6 offen sc1
    s_add_u32 s6, s6, 7168
    buffer_load_dwordx2 v[36:37], v7, s[72:75], s6 offen sc1
    s_add_u32 s6, s6, 7168
    buffer_load_dwordx2 v[38:39], v7, s[72:75], s6 offen sc1
    s_add_u32 s6, s6, 7168
    buffer_load_dwordx2 v[40:41], v7, s[72:75], s6 offen sc1
    s_add_u32 s6, s6, 7168
    buffer_load_dwordx2 v[42:43], v7, s[72:75], s6 offen sc1
    s_add_u32 s6, s6, 7168
    buffer_load_dwordx2 v[44:45], v7, s[72:75], s6 offen sc1
    s_add_u32 s6, s6, 7168
    buffer_load_dwordx2 v[46:47], v7, s[72:75], s6 offen sc1
    s_waitcnt vmcnt(6)
    v_add_f32 v32, v32, v34
    v_add_f32 v33, v33, v35
    s_waitcnt vmcnt(5)
    v_add_f32 v32, v32, v36
    v_add_f32 v33, v33, v37
    s_waitcnt vmcnt(4)
    v_add_f32 v32, v32, v38
    v_add_f32 v33, v33, v39
    s_waitcnt vmcnt(3)
    v_add_f32 v32, v32, v40
    v_add_f32 v33, v33, v41
    s_waitcnt vmcnt(2)
    v_add_f32 v32, v32, v42
    v_add_f32 v33, v33, v43
    s_waitcnt vmcnt(1)
    v_add_f32 v32, v32, v44
    v_add_f32 v33, v33, v45
    s_waitcnt vmcnt(0)
    v_add_f32 v32, v32, v46
    v_add_f32 v33, v33, v47
    v_add_u32 v8, 149504, v7
    ds_write_b64 v8, v[32:33]
    v_mov_b32 v26, 2
    ds_write_b32 v25, v26
Lwa144:
    ds_read_b32 v27, v29 offset:0
    s_waitcnt lgkmcnt(0)
    v_cmp_gt_u32 vcc, 10, v27
    s_cbranch_vccz Lwd145
    s_sleep 2
    s_sub_u32 s101, s101, 1
    s_cbranch_scc0 Lwa144
    s_mov_b32 s101, 0
Lwd145:
    s_atomic_add s63, s[24:25], 20
    s_atomic_add s63, s[24:25], 148
    s_atomic_add s63, s[24:25], 1044
    s_atomic_add s63, s[24:25], 1172
Lwa146:
    ds_read_b32 v27, v29 offset:0
    s_waitcnt lgkmcnt(0)
    v_cmp_gt_u32 vcc, 11, v27
    s_cbranch_vccz Lwd147
    s_sleep 8
    s_sub_u32 s101, s101, 1
    s_cbranch_scc0 Lwa146
    s_mov_b32 s101, 0
Lwd147:
Lwa148:
    ds_read_b32 v27, v29 offset:0
    s_waitcnt lgkmcnt(0)
    v_cmp_gt_u32 vcc, 12, v27
    s_cbranch_vccz Lwd149
    s_sleep 1
    s_sub_u32 s101, s101, 1
    s_cbranch_scc0 Lwa148
    s_mov_b32 s101, 0
Lwd149:
    s_atomic_add s63, s[26:27], 8
    s_atomic_add s63, s[26:27], 136
    s_cmp_eq_u32 s38, 0
    s_cbranch_scc1 Lnb150
Lwa151:
    ds_read_b32 v27, v29 offset:0
    s_waitcnt lgkmcnt(0)
    v_cmp_gt_u32 vcc, 13, v27
    s_cbranch_vccz Lwd152
    s_sub_u32 s101, s101, 1
    s_cbranch_scc0 Lwa151
    s_mov_b32 s101, 0
Lwd152:
Lnb150:
    s_atomic_add s63, s[26:27], 12
    s_atomic_add s63, s[26:27], 140
    s_endpgm
Lsync:
    s_mov_b32 s72, s30
    s_and_b32 s73, s31, 0xffff
    s_mov_b32 s74, 29360128
    s_mov_b32 s75, 0x20000
    v_lshlrev_b32 v1, 4, v0
    v_mov_b32 v4, 0
    v_mov_b32 v5, 0
    v_mov_b32 v6, 0
    v_mov_b32 v7, 0
    s_cmp_ge_u32 s2, 18
    s_cbranch_scc1 Lnz153
    s_lshl_b32 s7, s2, 10
    buffer_store_dwordx4 v[4:7], v1, s[72:75], s7 offen sc1
Lnz153:
    s_load_dword s55, s[8:9], 0
    s_load_dword s55, s[16:17], 0
    s_waitcnt lgkmcnt(0)
    s_lshl_b32 s6, s2, 11
    s_add_u32 s56, s18, s6
    s_addc_u32 s57, s19, 0
    s_load_dword s55, s[56:57], 0
    s_load_dword s55, s[56:57], 64
    s_load_dword s55, s[56:57], 128
    s_load_dword s55, s[56:57], 192
    s_load_dword s55, s[56:57], 256
    s_load_dword s55, s[56:57], 320
    s_load_dword s55, s[56:57], 384
    s_load_dword s55, s[56:57], 448
    s_load_dword s55, s[56:57], 512
    s_load_dword s55, s[56:57], 576
    s_load_dword s55, s[56:57], 640
    s_load_dword s55, s[56:57], 704
    s_load_dword s55, s[56:57], 768
    s_load_dword s55, s[56:57], 832
    s_load_dword s55, s[56:57], 896
    s_load_dword s55, s[56:57], 960
    s_load_dword s55, s[56:57], 1024
    s_load_dword s55, s[56:57], 1088
    s_load_dword s55, s[56:57], 1152
    s_load_dword s55, s[56:57], 1216
    s_load_dword s55, s[56:57], 1280
    s_load_dword s55, s[56:57], 1344
    s_load_dword s55, s[56:57], 1408
    s_load_dword s55, s[56:57], 1472
    s_load_dword s55, s[56:57], 1536
    s_load_dword s55, s[56:57], 1600
    s_load_dword s55, s[56:57], 1664
    s_load_dword s55, s[56:57], 1728
    s_load_dword s55, s[56:57], 1792
    s_load_dword s55, s[56:57], 1856
    s_load_dword s55, s[56:57], 1920
    s_load_dword s55, s[56:57], 1984
    s_cmp_ge_u32 s2, 18
    s_cbranch_scc1 Lnz154
    s_mov_b32 s60, 1
    s_waitcnt vmcnt(0)
    s_atomic_add s60, s[28:29], 0
Lnz154:
    s_mul_i32 s6, s2, 7168
    s_add_u32 s58, s20, s6
    s_addc_u32 s59, s21, 0
    s_load_dword s55, s[58:59], 0
    s_load_dword s55, s[58:59], 64
    s_load_dword s55, s[58:59], 128
    s_load_dword s55, s[58:59], 192
    s_load_dword s55, s[58:59], 256
    s_load_dword s55, s[58:59], 320
    s_load_dword s55, s[58:59], 384
    s_load_dword s55, s[58:59], 448
    s_load_dword s55, s[58:59], 512
    s_load_dword s55, s[58:59], 576
    s_load_dword s55, s[58:59], 640
    s_load_dword s55, s[58:59], 704
    s_load_dword s55, s[58:59], 768
    s_load_dword s55, s[58:59], 832
    s_load_dword s55, s[58:59], 896
    s_load_dword s55, s[58:59], 960
    s_load_dword s55, s[58:59], 1024
    s_load_dword s55, s[58:59], 1088
    s_load_dword s55, s[58:59], 1152
    s_load_dword s55, s[58:59], 1216
    s_load_dword s55, s[58:59], 1280
    s_load_dword s55, s[58:59], 1344
    s_load_dword s55, s[58:59], 1408
    s_load_dword s55, s[58:59], 1472
    s_load_dword s55, s[58:59], 1536
    s_load_dword s55, s[58:59], 1600
    s_load_dword s55, s[58:59], 1664
    s_load_dword s55, s[58:59], 1728
    s_load_dword s55, s[58:59], 1792
    s_load_dword s55, s[58:59], 1856
    s_load_dword s55, s[58:59], 1920
    s_load_dword s55, s[58:59], 1984
    s_load_dword s55, s[58:59], 2048
    s_load_dword s55, s[58:59], 2112
    s_load_dword s55, s[58:59], 2176
    s_load_dword s55, s[58:59], 2240
    s_load_dword s55, s[58:59], 2304
    s_load_dword s55, s[58:59], 2368
    s_load_dword s55, s[58:59], 2432
    s_load_dword s55, s[58:59], 2496
    s_load_dword s55, s[58:59], 2560
    s_load_dword s55, s[58:59], 2624
    s_load_dword s55, s[58:59], 2688
    s_load_dword s55, s[58:59], 2752
    s_load_dword s55, s[58:59], 2816
    s_load_dword s55, s[58:59], 2880
    s_load_dword s55, s[58:59], 2944
    s_load_dword s55, s[58:59], 3008
    s_load_dword s55, s[58:59], 3072
    s_load_dword s55, s[58:59], 3136
    s_load_dword s55, s[58:59], 3200
    s_load_dword s55, s[58:59], 3264
    s_load_dword s55, s[58:59], 3328
    s_load_dword s55, s[58:59], 3392
    s_load_dword s55, s[58:59], 3456
    s_load_dword s55, s[58:59], 3520
    s_load_dword s55, s[58:59], 3584
    s_load_dword s55, s[58:59], 3648
    s_load_dword s55, s[58:59], 3712
    s_load_dword s55, s[58:59], 3776
    s_load_dword s55, s[58:59], 3840
    s_load_dword s55, s[58:59], 3904
    s_load_dword s55, s[58:59], 3968
    s_load_dword s55, s[58:59], 4032
    s_load_dword s55, s[58:59], 4096
    s_load_dword s55, s[58:59], 4160
    s_load_dword s55, s[58:59], 4224
    s_load_dword s55, s[58:59], 4288
    s_load_dword s55, s[58:59], 4352
    s_load_dword s55, s[58:59], 4416
    s_load_dword s55, s[58:59], 4480
    s_load_dword s55, s[58:59], 4544
    s_load_dword s55, s[58:59], 4608
    s_load_dword s55, s[58:59], 4672
    s_load_dword s55, s[58:59], 4736
    s_load_dword s55, s[58:59], 4800
    s_load_dword s55, s[58:59], 4864
    s_load_dword s55, s[58:59], 4928
    s_load_dword s55, s[58:59], 4992
    s_load_dword s55, s[58:59], 5056
    s_load_dword s55, s[58:59], 5120
    s_load_dword s55, s[58:59], 5184
    s_load_dword s55, s[58:59], 5248
    s_load_dword s55, s[58:59], 5312
    s_load_dword s55, s[58:59], 5376
    s_load_dword s55, s[58:59], 5440
    s_load_dword s55, s[58:59], 5504
    s_load_dword s55, s[58:59], 5568
    s_load_dword s55, s[58:59], 5632
    s_load_dword s55, s[58:59], 5696
    s_load_dword s55, s[58:59], 5760
    s_load_dword s55, s[58:59], 5824
    s_load_dword s55, s[58:59], 5888
    s_load_dword s55, s[58:59], 5952
    s_load_dword s55, s[58:59], 6016
    s_load_dword s55, s[58:59], 6080
    s_load_dword s55, s[58:59], 6144
    s_load_dword s55, s[58:59], 6208
    s_load_dword s55, s[58:59], 6272
    s_load_dword s55, s[58:59], 6336
    s_load_dword s55, s[58:59], 6400
    s_load_dword s55, s[58:59], 6464
    s_load_dword s55, s[58:59], 6528
    s_load_dword s55, s[58:59], 6592
    s_load_dword s55, s[58:59], 6656
    s_load_dword s55, s[58:59], 6720
    s_load_dword s55, s[58:59], 6784
    s_load_dword s55, s[58:59], 6848
    s_load_dword s55, s[58:59], 6912
    s_load_dword s55, s[58:59], 6976
    s_load_dword s55, s[58:59], 7040
    s_load_dword s55, s[58:59], 7104
    s_and_b32 s99, s33, 7
    s_lshr_b32 s6, s33, 3
    s_lshl_b32 s100, s32, 2
    s_add_u32 s100, s100, s6
    s_and_b32 s36, s2, 6
    s_lshl_b32 s36, s36, 1
    s_add_u32 s36, s36, s6
    s_cmp_lt_u32 s99, 7
    s_cselect_b32 s38, 1, 0
    s_min_u32 s37, s99, 6
    s_and_b32 s6, s2, 1
    s_mul_i32 s6, s6, 7
    s_add_u32 s37, s37, s6
    v_add_u32 v25, 1536, v24
    s_add_u32 s4, s4, Ltab-Lpc
    s_addc_u32 s5, s5, 0
    v_mov_b32 v28, 0
    s_and_b32 s6, s2, 1
    s_lshl_b32 s6, s6, 3
    s_add_u32 s39, s6, s99
    s_lshr_b32 s6, s34, 1
    s_lshl_b32 s7, s35, 2
    s_add_u32 s6, s6, s7
    s_lshl_b32 s6, s6, 7
    s_add_u32 s40, s30, s6
    s_addc_u32 s41, s31, 0
    s_lshr_b32 s6, s100, 1
    s_lshl_b32 s7, s99, 4
    s_add_u32 s6, s6, s7
    s_lshl_b32 s6, s6, 7
    s_add_u32 s48, s30, s6
    s_addc_u32 s49, s31, 0
    s_lshr_b32 s6, s39, 1
    s_lshl_b32 s7, s36, 3
    s_add_u32 s6, s6, s7
    s_lshl_b32 s6, s6, 7
    s_add_u32 s50, s30, s6
    s_addc_u32 s51, s31, 0
    s_cmp_lt_u32 s99, 4
    s_cselect_b32 s61, 4, 12
    s_and_b32 s62, s99, 1
    s_lshl_b32 s62, s62, 2
    s_add_u32 s62, s62, 32
    v_lshlrev_b32 v1, 4, v0
    v_lshrrev_b32 v3, 5, v0
    v_lshlrev_b32 v3, 9, v3
    v_mov_b32 v2, 0x40000000
    v_add_u32 v12, 4096, v1
    s_cmp_eq_u32 s99, 0
    s_cselect_b64 vcc, -1, 0
    s_cselect_b32 s44, 0, 4096
    s_cselect_b32 s45, 0, 8192
    v_add_u32 v8, 4096, v3
    v_cndmask_b32 v8, v12, v8, vcc
    v_add_u32 v9, 3072, v3
    v_cndmask_b32 v9, v12, v9, vcc
    v_add_u32 v10, 2048, v3
    v_cndmask_b32 v10, v12, v10, vcc
    v_add_u32 v11, 1024, v3
    v_cndmask_b32 v11, v12, v11, vcc
    v_cndmask_b32 v2, v12, v2, vcc
    s_lshl_b32 s43, s100, 16
    s_lshl_b32 s42, s99, 13
    s_add_u32 s43, s43, s42
    s_sub_u32 s42, s43, s45
    s_waitcnt lgkmcnt(0)
    s_mov_b32 s65, 400000
    s_load_dword s64, s[28:29], 0
Lpc155:
    s_waitcnt lgkmcnt(0)
    s_cmp_ge_u32 s64, 18
    s_cbranch_scc1 Lpd156
    s_sub_u32 s65, s65, 1
    s_cbranch_scc1 Lpd156
    s_sleep 12
    s_load_dword s64, s[28:29], 0 glc
    s_branch Lpc155
Lpd156:
Lwa157:
    ds_read_b32 v27, v29 offset:0
    s_waitcnt lgkmcnt(0)
    v_cmp_gt_u32 vcc, 3, v27
    s_cbranch_vccz Lwd158
    s_sleep 4
    s_sub_u32 s101, s101, 1
    s_cbranch_scc0 Lwa157
    s_mov_b32 s101, 0
Lwd158:
    s_mov_b32 s65, 400000
    s_mov_b32 s8, 0
    s_load_dword s8, s[40:41], 16 glc
Lpc159:
    s_waitcnt lgkmcnt(0)
    s_max_u32 s64, s8, s8
    s_cmp_ge_u32 s64, 16
    s_cbranch_scc1 Lpd160
    s_load_dword s8, s[40:41], 16 glc
    s_sub_u32 s65, s65, 1
    s_cbranch_scc0 Lpc159
Lpd160:
    v_mov_b32 v26, 1
    ds_write_b32 v25, v26
Lwa161:
    ds_read_b32 v27, v29 offset:0
    s_waitcnt lgkmcnt(0)
    v_cmp_gt_u32 vcc, 6, v27
    s_cbranch_vccz Lwd162
    s_sleep 1
    s_sub_u32 s101, s101, 1
    s_cbranch_scc0 Lwa161
    s_mov_b32 s101, 0
Lwd162:
    s_mov_b32 s65, 400000
    s_mov_b32 s9, 0
    s_load_dword s9, s[48:49], 0 glc
Lpc163:
    s_waitcnt lgkmcnt(0)
    s_max_u32 s64, s9, s9
    s_cmp_ge_u32 s64, 12
    s_cbranch_scc1 Lpd164
    s_load_dword s9, s[48:49], 0 glc
    s_sub_u32 s65, s65, 1
    s_cbranch_scc0 Lpc163
Lpd164:
    s_mov_b32 m0, 155648
    s_add_u32 s46, s43, 7340032
    buffer_load_dwordx4 v1, s[72:75], s46 offen offset:0 sc1 lds
    buffer_load_dwordx4 v1, s[72:75], s46 offen offset:1024 sc1 lds
    buffer_load_dwordx4 v1, s[72:75], s46 offen offset:2048 sc1 lds
    buffer_load_dwordx4 v1, s[72:75], s46 offen offset:3072 sc1 lds
    s_mov_b32 m0, 159744
    s_add_u32 s46, s43, 7344128
    buffer_load_dwordx4 v1, s[72:75], s46 offen offset:0 sc1 lds
    buffer_load_dwordx4 v1, s[72:75], s46 offen offset:1024 sc1 lds
    buffer_load_dwordx4 v1, s[72:75], s46 offen offset:2048 sc1 lds
    buffer_load_dwordx4 v1, s[72:75], s46 offen offset:3072 sc1 lds
    s_add_u32 s46, s42, 9433088
    s_mov_b32 m0, 98304
    s_nop 0
    buffer_load_dwordx4 v8, s[72:75], s46 offen offset:0 sc1 lds
    buffer_load_dwordx4 v9, s[72:75], s46 offen offset:1024 sc1 lds
    buffer_load_dwordx4 v10, s[72:75], s46 offen offset:2048 sc1 lds
    buffer_load_dwordx4 v11, s[72:75], s46 offen offset:3072 sc1 lds
    s_mov_b32 m0, 102400
    s_add_u32 s46, s46, s44
    buffer_load_dwordx4 v8, s[72:75], s46 offen offset:0 sc1 lds
    buffer_load_dwordx4 v9, s[72:75], s46 offen offset:1024 sc1 lds
    buffer_load_dwordx4 v10, s[72:75], s46 offen offset:2048 sc1 lds
    buffer_load_dwordx4 v11, s[72:75], s46 offen offset:3072 sc1 lds
    s_mov_b32 m0, 106496
    s_add_u32 s46, s43, 9437184
    buffer_load_dwordx4 v1, s[72:75], s46 offen offset:0 sc1 lds
    buffer_load_dwordx4 v1, s[72:75], s46 offen offset:1024 sc1 lds
    buffer_load_dwordx4 v1, s[72:75], s46 offen offset:2048 sc1 lds
    buffer_load_dwordx4 v1, s[72:75], s46 offen offset:3072 sc1 lds
    s_mov_b32 m0, 110592
    s_add_u32 s46, s43, 9441280
    buffer_load_dwordx4 v1, s[72:75], s46 offen offset:0 sc1 lds
    buffer_load_dwordx4 v1, s[72:75], s46 offen offset:1024 sc1 lds
    buffer_load_dwordx4 v1, s[72:75], s46 offen offset:2048 sc1 lds
    buffer_load_dwordx4 v1, s[72:75], s46 offen offset:3072 sc1 lds
    s_mov_b32 m0, 148984
    s_nop 0
    global_load_lds_dword v28, s[4:5] offset:8
Lwa165:
    ds_read_b32 v27, v24 offset:1792
    s_waitcnt lgkmcnt(0)
    v_cmp_gt_u32 vcc, 1, v27
    s_cbranch_vccz Lwd166
    s_sleep 1
    s_sub_u32 s101, s101, 1
    s_cbranch_scc0 Lwa165
    s_mov_b32 s101, 0
Lwd166:
    s_mov_b32 s65, 400000
    s_mov_b32 s10, 0
    s_load_dword s10, s[48:49], 24 glc
Lpc167:
    s_waitcnt lgkmcnt(0)
    s_max_u32 s64, s10, s10
    s_cmp_ge_u32 s64, 8
    s_cbranch_scc1 Lpd168
    s_load_dword s10, s[48:49], 24 glc
    s_sub_u32 s65, s65, 1
    s_cbranch_scc0 Lpc167
Lpd168:
    s_add_u32 s46, s42, 11530240
    s_mov_b32 m0, 114688
    s_nop 0
    buffer_load_dwordx4 v2, s[72:75], s46 offen offset:0 sc1 lds
    buffer_load_dwordx4 v2, s[72:75], s46 offen offset:1024 sc1 lds
    buffer_load_dwordx4 v2, s[72:75], s46 offen offset:2048 sc1 lds
    buffer_load_dwordx4 v2, s[72:75], s46 offen offset:3072 sc1 lds
    s_mov_b32 m0, 118784
    s_add_u32 s46, s46, s44
    buffer_load_dwordx4 v2, s[72:75], s46 offen offset:0 sc1 lds
    buffer_load_dwordx4 v2, s[72:75], s46 offen offset:1024 sc1 lds
    buffer_load_dwordx4 v2, s[72:75], s46 offen offset:2048 sc1 lds
    buffer_load_dwordx4 v2, s[72:75], s46 offen offset:3072 sc1 lds
    s_mov_b32 m0, 148980
    s_nop 0
    global_load_lds_dword v28, s[4:5] offset:12
    s_mov_b32 m0, 122880
    s_add_u32 s46, s43, 11534336
    buffer_load_dwordx4 v1, s[72:75], s46 offen offset:0 sc1 lds
    buffer_load_dwordx4 v1, s[72:75], s46 offen offset:1024 sc1 lds
    buffer_load_dwordx4 v1, s[72:75], s46 offen offset:2048 sc1 lds
    buffer_load_dwordx4 v1, s[72:75], s46 offen offset:3072 sc1 lds
    s_mov_b32 m0, 126976
    s_add_u32 s46, s43, 11538432
    buffer_load_dwordx4 v1, s[72:75], s46 offen offset:0 sc1 lds
    buffer_load_dwordx4 v1, s[72:75], s46 offen offset:1024 sc1 lds
    buffer_load_dwordx4 v1, s[72:75], s46 offen offset:2048 sc1 lds
    buffer_load_dwordx4 v1, s[72:75], s46 offen offset:3072 sc1 lds
    s_mov_b32 m0, 148976
    s_nop 0
    global_load_lds_dword v28, s[4:5] offset:16
    s_waitcnt vmcnt(0)
    s_mov_b32 s65, 400000
    s_mov_b32 s11, 0
    s_load_dword s11, s[50:51], 4 glc
Lpc169:
    s_waitcnt lgkmcnt(0)
    s_max_u32 s64, s11, s11
    s_cmp_ge_u32 s64, 16
    s_cbranch_scc1 Lpd170
    s_load_dword s11, s[50:51], 4 glc
    s_sub_u32 s65, s65, 1
    s_cbranch_scc0 Lpc169
Lpd170:
    v_mov_b32 v26, 5
    ds_write_b32 v25, v26
    s_mov_b32 s65, 400000
    s_mov_b32 s12, 0
    s_load_dword s12, s[50:51], 20 glc
Lpc171:
    s_waitcnt lgkmcnt(0)
    s_max_u32 s64, s12, s12
    s_cmp_ge_u32 s64, s61
    s_cbranch_scc1 Lpd172
    s_load_dword s12, s[50:51], 20 glc
    s_sub_u32 s65, s65, 1
    s_cbranch_scc0 Lpc171
Lpd172:
    v_mov_b32 v26, 6
    ds_write_b32 v25, v26
    s_mov_b32 s65, 400000
    s_mov_b32 s13, 0
    s_load_dword s13, s[50:51], 8 glc
Lpc173:
    s_waitcnt lgkmcnt(0)
    s_max_u32 s64, s13, s13
    s_cmp_ge_u32 s64, 4
    s_cbranch_scc1 Lpd174
    s_load_dword s13, s[50:51], 8 glc
    s_sub_u32 s65, s65, 1
    s_cbranch_scc0 Lpc173
Lpd174:
    v_mov_b32 v26, 7
    ds_write_b32 v25, v26
    s_mov_b32 s65, 400000
    s_mov_b32 s14, 0
    s_load_dword s14, s[50:51], 12 glc
Lpc175:
    s_waitcnt lgkmcnt(0)
    s_max_u32 s64, s14, s14
    s_cmp_ge_u32 s64, 4
    s_cbranch_scc1 Lpd176
    s_load_dword s14, s[50:51], 12 glc
    s_sub_u32 s65, s65, 1
    s_cbranch_scc0 Lpc175
Lpd176:
    v_mov_b32 v26, 8
    ds_write_b32 v25, v26
    s_lshl_b32 s6, s36, 4
    s_and_b32 s7, s99, 3
    s_add_u32 s6, s6, s7
    s_lshl_b32 s6, s6, 2
    s_lshr_b32 s7, s39, 2
    s_add_u32 s6, s6, s7
    s_mul_i32 s43, s6, 6144
Lwa177:
    ds_read_b32 v27, v29 offset:0
    s_waitcnt lgkmcnt(0)
    v_cmp_gt_u32 vcc, 14, v27
    s_cbranch_vccz Lwd178
    s_sleep 2
    s_sub_u32 s101, s101, 1
    s_cbranch_scc0 Lwa177
    s_mov_b32 s101, 0
Lwd178:
    s_mov_b32 s65, 400000
    s_mov_b32 s15, 0
    s_load_dword s15, s[50:51], s62 glc
Lpc179:
    s_waitcnt lgkmcnt(0)
    s_max_u32 s64, s15, s15
    s_cmp_ge_u32 s64, 8
    s_cbranch_scc1 Lpd180
    s_load_dword s15, s[50:51], s62 glc
    s_sub_u32 s65, s65, 1
    s_cbranch_scc0 Lpc179
Lpd180:
    s_add_u32 s62, s62, 8
    s_mov_b32 m0, 16384
    s_add_u32 s46, s43, 23068672
    buffer_load_dwordx4 v1, s[72:75], s46 offen offset:0 sc1 lds
    buffer_load_dwordx4 v1, s[72:75], s46 offen offset:1024 sc1 lds
    buffer_load_dwordx4 v1, s[72:75], s46 offen offset:2048 sc1 lds
    buffer_load_dwordx4 v1, s[72:75], s46 offen offset:3072 sc1 lds
    s_mov_b32 m0, 22528
    s_add_u32 s46, s43, 23166976
    buffer_load_dwordx4 v1, s[72:75], s46 offen offset:0 sc1 lds
    buffer_load_dwordx4 v1, s[72:75], s46 offen offset:1024 sc1 lds
    buffer_load_dwordx4 v1, s[72:75], s46 offen offset:2048 sc1 lds
    buffer_load_dwordx4 v1, s[72:75], s46 offen offset:3072 sc1 lds
    s_mov_b32 m0, 28672
    s_add_u32 s46, s43, 23265280
    buffer_load_dwordx4 v1, s[72:75], s46 offen offset:0 sc1 lds
    buffer_load_dwordx4 v1, s[72:75], s46 offen offset:1024 sc1 lds
    buffer_load_dwordx4 v1, s[72:75], s46 offen offset:2048 sc1 lds
    buffer_load_dwordx4 v1, s[72:75], s46 offen offset:3072 sc1 lds
    s_mov_b32 m0, 34816
    s_add_u32 s46, s43, 23363584
    buffer_load_dwordx4 v1, s[72:75], s46 offen offset:0 sc1 lds
    buffer_load_dwordx4 v1, s[72:75], s46 offen offset:1024 sc1 lds
    buffer_load_dwordx4 v1, s[72:75], s46 offen offset:2048 sc1 lds
    buffer_load_dwordx4 v1, s[72:75], s46 offen offset:3072 sc1 lds
    s_mov_b32 m0, 148956
    s_nop 0
    global_load_lds_dword v28, s[4:5] offset:36
    s_mov_b32 s65, 400000
    s_mov_b32 s16, 0
    s_load_dword s16, s[50:51], s62 glc
Lpc181:
    s_waitcnt lgkmcnt(0)
    s_max_u32 s64, s16, s16
    s_cmp_ge_u32 s64, 4
    s_cbranch_scc1 Lpd182
    s_load_dword s16, s[50:51], s62 glc
    s_sub_u32 s65, s65, 1
    s_cbranch_scc0 Lpc181
Lpd182:
    s_mov_b32 m0, 20480
    s_add_u32 s46, s43, 23072768
    buffer_load_dwordx4 v1, s[72:75], s46 offen offset:0 sc1 lds
    buffer_load_dwordx4 v1, s[72:75], s46 offen offset:1024 sc1 lds
    s_mov_b32 m0, 26624
    s_add_u32 s46, s43, 23171072
    buffer_load_dwordx4 v1, s[72:75], s46 offen offset:0 sc1 lds
    buffer_load_dwordx4 v1, s[72:75], s46 offen offset:1024 sc1 lds
    s_mov_b32 m0, 32768
    s_add_u32 s46, s43, 23269376
    buffer_load_dwordx4 v1, s[72:75], s46 offen offset:0 sc1 lds
    buffer_load_dwordx4 v1, s[72:75], s46 offen offset:1024 sc1 lds
    s_mov_b32 m0, 38912
    s_add_u32 s46, s43, 23367680
    buffer_load_dwordx4 v1, s[72:75], s46 offen offset:0 sc1 lds
    buffer_load_dwordx4 v1, s[72:75], s46 offen offset:1024 sc1 lds
    s_mov_b32 m0, 148952
    s_nop 0
    global_load_lds_dword v28, s[4:5] offset:40
    s_waitcnt vmcnt(0)
    s_endpgm
Lcomp:
    s_mov_b32 s72, s30
    s_and_b32 s73, s31, 0xffff
    s_mov_b32 s74, 29360128
    s_mov_b32 s75, 0x20000
    s_mov_b32 s76, s26
    s_and_b32 s77, s27, 0xffff
    s_mov_b32 s78, 2097152
    s_mov_b32 s79, 0x20000
    s_add_u32 s4, s4, Ltab-Lpc
    s_addc_u32 s5, s5, 0
    s_and_b32 s84, s3, 1
    s_lshr_b32 s85, s3, 1
    s_lshl_b32 s86, s35, 1
    s_add_u32 s86, s86, s84
    v_lshlrev_b32 v1, 4, v0
    v_lshrrev_b32 v15, 5, v0
    v_and_b32 v8, 31, v0
    s_lshl_b32 s87, s3, 8
    v_add_u32 v25, s87, v24
    v_mov_b32 v26, 1
    v_bfe_u32 v9, v0, 2, 2
    v_and_b32 v10, 3, v0
    v_bfe_u32 v11, v0, 4, 1
    v_bfe_u32 v12, v0, 3, 1
    v_lshlrev_b32 v14, 7, v9
    v_lshl_add_u32 v14, v10, 3, v14
    v_lshl_add_u32 v14, v11, 5, v14
    v_lshl_add_u32 v14, v12, 6, v14
    s_lshl_b32 s87, s85, 6
    v_xor_b32 v2, s87, v14
    v_lshl_add_u32 v2, v15, 10, v2
    v_add_u32 v3, 0x10000, v2
    v_add_u32 v4, 0x20000, v2
    s_lshl_b32 s87, s84, 5
    v_add_u32 v9, s87, v8
    s_lshl_b32 s87, s3, 9
    s_add_u32 s87, s87, 151552
    v_lshl_add_u32 v7, v0, 2, s87
    s_mul_i32 s87, s84, 1536
    s_add_u32 s87, s87, 151552
    v_lshl_add_u32 v5, v0, 2, s87
    s_lshl_b32 s87, s84, 9
    s_sub_u32 s87, 152576, s87
    v_lshl_add_u32 v126, v0, 2, s87
    s_lshl_b32 s87, s85, 9
    s_add_u32 s87, s87, 152320
    v_lshl_add_u32 v6, v15, 4, s87
    v_lshlrev_b32 v9, 7, v9
    v_bfe_u32 v10, v0, 1, 3
    v_xor_b32 v12, v10, v15
    v_lshl_add_u32 v92, v12, 4, v9
    v_xor_b32 v93, 32, v92
    v_xor_b32 v94, 64, v92
    v_xor_b32 v95, 96, v92
    v_mov_b32 v88, 0x3f803f80
    s_lshr_b32 s87, s34, 2
    s_add_u32 s87, s87, 1
    s_sub_u32 s88, 0, s87
    s_bitcmp1_b32 s34, 1
    s_cselect_b32 s87, s88, s87
    s_lshl_b32 s88, s86, 5
    s_add_u32 s87, s87, s88
    v_add_u32 v9, s87, v8
    s_movk_i32 s87, 2048
    v_cmp_gt_u32 s[90:91], s87, v9
    v_bfe_u32 v10, v9, 5, 6
    v_and_b32 v9, 31, v9
    v_lshlrev_b32 v124, 15, v10
    v_lshl_add_u32 v124, v9, 4, v124
    v_lshl_add_u32 v124, v15, 9, v124
    v_and_b32 v9, 15, v0
    v_lshlrev_b32 v125, 16, v11
    v_lshl_add_u32 v125, v9, 4, v125
    v_lshl_add_u32 v125, v15, 8, v125
    s_lshl_b32 s87, s3, 4
    v_add_u32 v12, s87, v9
    v_bfe_u32 v13, v0, 1, 3
    v_lshlrev_b32 v127, 1, v15
    v_xor_b32 v127, v127, v13
    v_lshlrev_b32 v127, 4, v127
    v_lshl_add_u32 v127, v12, 7, v127
    v_lshl_add_u32 v127, v11, 3, v127
    v_add_u32 v127, 155648, v127
    v_lshlrev_b32 v9, 2, v15
    v_sub_u32 v9, v8, v9
    v_cmp_le_i32 s[40:41], 0, v9
    v_cmp_le_i32 s[42:43], 1, v9
    v_cmp_le_i32 s[44:45], 2, v9
    v_cmp_le_i32 s[46:47], 3, v9
    v_cmp_le_i32 s[48:49], 8, v9
    v_cmp_le_i32 s[50:51], 9, v9
    v_cmp_le_i32 s[52:53], 10, v9
    v_cmp_le_i32 s[54:55], 11, v9
    v_cmp_le_i32 s[56:57], 16, v9
    v_cmp_le_i32 s[58:59], 17, v9
    v_cmp_le_i32 s[60:61], 18, v9
    v_cmp_le_i32 s[62:63], 19, v9
    v_cmp_le_i32 s[64:65], 24, v9
    v_cmp_le_i32 s[66:67], 25, v9
    v_cmp_le_i32 s[68:69], 26, v9
    v_cmp_le_i32 s[70:71], 27, v9
    s_and_b32 s99, s33, 7
    s_lshr_b32 s6, s33, 3
    s_lshl_b32 s100, s32, 2
    s_add_u32 s100, s100, s6
    s_and_b32 s36, s2, 6
    s_lshl_b32 s36, s36, 1
    s_add_u32 s36, s36, s6
    s_cmp_lt_u32 s99, 7
    s_cselect_b32 s38, 1, 0
    s_min_u32 s37, s99, 6
    s_and_b32 s6, s2, 1
    s_mul_i32 s6, s6, 7
    s_add_u32 s37, s37, s6
    s_lshl_b32 s89, s34, 1
    s_add_u32 s89, s89, s85
    s_lshl_b32 s89, s89, 1
    s_lshl_b32 s96, s89, 16
    s_lshl_b32 s87, s86, 10
    s_add_u32 s96, s96, s87
    v_mov_b32 v64, 0
    v_mov_b32 v65, 0
    s_add_u32 s6, s3, 1
    s_bitcmp1_b32 s6, 1
    s_cbranch_scc1 Lhc2
    ds_read_b32 v31, v24 offset:1152
    s_waitcnt lgkmcnt(0)
    v_cmp_gt_u32 vcc, 1, v31
    s_cbranch_vccnz Lst4
Lbk5:
    ds_read_b128 v[128:131], v92 offset:0
    ds_read_b64_tr_b16 v[96:97], v2 offset:8192
    ds_read_b64_tr_b16 v[98:99], v2 offset:8704
    ds_read_b128 v[132:135], v93 offset:0
    ds_read_b64_tr_b16 v[100:101], v2 offset:10240
    ds_read_b64_tr_b16 v[102:103], v2 offset:10752
    ds_read_b128 v[136:139], v94 offset:0
    ds_read_b64_tr_b16 v[104:105], v2 offset:12288
    ds_read_b64_tr_b16 v[106:107], v2 offset:12800
    ds_read_b128 v[140:143], v95 offset:0
    ds_read_b64_tr_b16 v[108:109], v2 offset:14336
    ds_read_b64_tr_b16 v[110:111], v2 offset:14848
    ds_read_b32 v27, v24 offset:1152
    s_waitcnt lgkmcnt(0)
    v_cmp_gt_u32 vcc, 2, v27
    v_mfma_f32_32x32x16_bf16 v[32:47], v[96:99], v[128:131], 0
    s_cbranch_vccnz Lst6
Lbk7:
    ds_read_b128 v[144:147], v92 offset:16384
    ds_read_b64_tr_b16 v[96:97], v2 offset:24576
    ds_read_b64_tr_b16 v[98:99], v2 offset:25088
    v_dot2c_f32_bf16 v65, v128, v128
    v_dot2c_f32_bf16 v65, v129, v129
    v_dot2c_f32_bf16 v65, v130, v130
    v_dot2c_f32_bf16 v65, v131, v131
    v_dot2c_f32_bf16 v64, v128, v88
    v_dot2c_f32_bf16 v64, v129, v88
    v_dot2c_f32_bf16 v65, v132, v132
    v_dot2c_f32_bf16 v65, v133, v133
    v_dot2c_f32_bf16 v65, v134, v134
    v_dot2c_f32_bf16 v65, v135, v135
    v_dot2c_f32_bf16 v64, v132, v88
    v_dot2c_f32_bf16 v64, v133, v88
    v_mfma_f32_32x32x16_bf16 v[32:47], v[100:103], v[132:135], v[32:47]
    ds_read_b128 v[148:151], v93 offset:16384
    ds_read_b64_tr_b16 v[100:101], v2 offset:26624
    ds_read_b64_tr_b16 v[102:103], v2 offset:27136
    v_mfma_f32_32x32x16_bf16 v[32:47], v[104:107], v[136:139], v[32:47]
    ds_read_b32 v27, v24 offset:1152
    ds_read_b128 v[152:155], v94 offset:16384
    ds_read_b64_tr_b16 v[104:105], v2 offset:28672
    ds_read_b64_tr_b16 v[106:107], v2 offset:29184
    v_dot2c_f32_bf16 v65, v136, v136
    v_dot2c_f32_bf16 v65, v137, v137
    v_dot2c_f32_bf16 v65, v138, v138
    v_dot2c_f32_bf16 v65, v139, v139
    v_dot2c_f32_bf16 v64, v136, v88
    v_dot2c_f32_bf16 v64, v137, v88
    v_dot2c_f32_bf16 v65, v140, v140
    v_dot2c_f32_bf16 v65, v141, v141
    v_dot2c_f32_bf16 v65, v142, v142
    v_dot2c_f32_bf16 v65, v143, v143
    v_dot2c_f32_bf16 v64, v140, v88
    v_dot2c_f32_bf16 v64, v141, v88
    v_mfma_f32_32x32x16_bf16 v[32:47], v[108:111], v[140:143], v[32:47]
    ds_read_b128 v[156:159], v95 offset:16384
    ds_read_b64_tr_b16 v[108:109], v2 offset:30720
    ds_read_b64_tr_b16 v[110:111], v2 offset:31232
    s_waitcnt lgkmcnt(6)
    v_cmp_gt_u32 vcc, 3, v27
    v_mfma_f32_32x32x16_bf16 v[32:47], v[96:99], v[144:147], v[32:47]
    s_cbranch_vccnz Lst8
Lbk9:
    ds_read_b128 v[160:163], v92 offset:32768
    ds_read_b64_tr_b16 v[96:97], v2 offset:40960
    ds_read_b64_tr_b16 v[98:99], v2 offset:41472
    v_dot2c_f32_bf16 v65, v144, v144
    v_dot2c_f32_bf16 v65, v145, v145
    v_dot2c_f32_bf16 v65, v146, v146
    v_dot2c_f32_bf16 v65, v147, v147
    v_dot2c_f32_bf16 v64, v144, v88
    v_dot2c_f32_bf16 v64, v145, v88
    v_dot2c_f32_bf16 v65, v148, v148
    v_dot2c_f32_bf16 v65, v149, v149
    v_dot2c_f32_bf16 v65, v150, v150
    v_dot2c_f32_bf16 v65, v151, v151
    v_dot2c_f32_bf16 v64, v148, v88
    v_dot2c_f32_bf16 v64, v149, v88
    v_mfma_f32_32x32x16_bf16 v[32:47], v[100:103], v[148:151], v[32:47]
    ds_read_b128 v[164:167], v93 offset:32768
    ds_read_b64_tr_b16 v[100:101], v2 offset:43008
    ds_read_b64_tr_b16 v[102:103], v2 offset:43520
    s_waitcnt lgkmcnt(9)
    v_mfma_f32_32x32x16_bf16 v[32:47], v[104:107], v[152:155], v[32:47]
    ds_read_b32 v27, v24 offset:1152
    ds_read_b128 v[168:171], v94 offset:32768
    ds_read_b64_tr_b16 v[104:105], v2 offset:45056
    ds_read_b64_tr_b16 v[106:107], v2 offset:45568
    v_dot2c_f32_bf16 v65, v152, v152
    v_dot2c_f32_bf16 v65, v153, v153
    v_dot2c_f32_bf16 v65, v154, v154
    v_dot2c_f32_bf16 v65, v155, v155
    v_dot2c_f32_bf16 v64, v152, v88
    v_dot2c_f32_bf16 v64, v153, v88
    s_waitcnt lgkmcnt(12)
    v_dot2c_f32_bf16 v65, v156, v156
    v_dot2c_f32_bf16 v65, v157, v157
    v_dot2c_f32_bf16 v65, v158, v158
    v_dot2c_f32_bf16 v65, v159, v159
    v_dot2c_f32_bf16 v64, v156, v88
    v_dot2c_f32_bf16 v64, v157, v88
    s_waitcnt lgkmcnt(10)
    v_mfma_f32_32x32x16_bf16 v[32:47], v[108:111], v[156:159], v[32:47]
    ds_read_b128 v[172:175], v95 offset:32768
    ds_read_b64_tr_b16 v[108:109], v2 offset:47104
    ds_read_b64_tr_b16 v[110:111], v2 offset:47616
    s_waitcnt lgkmcnt(6)
    v_cmp_gt_u32 vcc, 4, v27
    v_mfma_f32_32x32x16_bf16 v[32:47], v[96:99], v[160:163], v[32:47]
    s_cbranch_vccnz Lst10
Lbk11:
    ds_read_b128 v[176:179], v92 offset:49152
    ds_read_b64_tr_b16 v[96:97], v2 offset:57344
    ds_read_b64_tr_b16 v[98:99], v2 offset:57856
    v_dot2c_f32_bf16 v65, v160, v160
    v_dot2c_f32_bf16 v65, v161, v161
    v_dot2c_f32_bf16 v65, v162, v162
    v_dot2c_f32_bf16 v65, v163, v163
    v_dot2c_f32_bf16 v64, v160, v88
    v_dot2c_f32_bf16 v64, v161, v88
    v_dot2c_f32_bf16 v65, v164, v164
    v_dot2c_f32_bf16 v65, v165, v165
    v_dot2c_f32_bf16 v65, v166, v166
    v_dot2c_f32_bf16 v65, v167, v167
    v_dot2c_f32_bf16 v64, v164, v88
    v_dot2c_f32_bf16 v64, v165, v88
    v_mfma_f32_32x32x16_bf16 v[32:47], v[100:103], v[164:167], v[32:47]
    ds_read_b128 v[180:183], v93 offset:49152
    ds_read_b64_tr_b16 v[100:101], v2 offset:59392
    ds_read_b64_tr_b16 v[102:103], v2 offset:59904
    s_waitcnt lgkmcnt(9)
    v_mfma_f32_32x32x16_bf16 v[32:47], v[104:107], v[168:171], v[32:47]
    ds_read_b32 v27, v24 offset:1152
    ds_read_b128 v[184:187], v94 offset:49152
    ds_read_b64_tr_b16 v[104:105], v2 offset:61440
    ds_read_b64_tr_b16 v[106:107], v2 offset:61952
    v_dot2c_f32_bf16 v65, v168, v168
    v_dot2c_f32_bf16 v65, v169, v169
    v_dot2c_f32_bf16 v65, v170, v170
    v_dot2c_f32_bf16 v65, v171, v171
    v_dot2c_f32_bf16 v64, v168, v88
    v_dot2c_f32_bf16 v64, v169, v88
    s_waitcnt lgkmcnt(12)
    v_dot2c_f32_bf16 v65, v172, v172
    v_dot2c_f32_bf16 v65, v173, v173
    v_dot2c_f32_bf16 v65, v174, v174
    v_dot2c_f32_bf16 v65, v175, v175
    v_dot2c_f32_bf16 v64, v172, v88
    v_dot2c_f32_bf16 v64, v173, v88
    s_waitcnt lgkmcnt(10)
    v_mfma_f32_32x32x16_bf16 v[32:47], v[108:111], v[172:175], v[32:47]
    ds_read_b128 v[188:191], v95 offset:49152
    ds_read_b64_tr_b16 v[108:109], v2 offset:63488
    ds_read_b64_tr_b16 v[110:111], v2 offset:64000
    s_waitcnt lgkmcnt(12)
    ds_add_u32 v25, v26
    s_waitcnt lgkmcnt(7)
    v_cmp_gt_u32 vcc, 5, v27
    v_mfma_f32_32x32x16_bf16 v[32:47], v[96:99], v[176:179], v[32:47]
    s_cbranch_vccnz Lst12
Lbk13:
    v_add_u32 v92, 0x10000, v92
    v_add_u32 v93, 0x10000, v93
    v_add_u32 v94, 0x10000, v94
    v_add_u32 v95, 0x10000, v95
    ds_read_b128 v[192:195], v92 offset:0
    ds_read_b64_tr_b16 v[96:97], v3 offset:8192
    ds_read_b64_tr_b16 v[98:99], v3 offset:8704
    v_dot2c_f32_bf16 v65, v176, v176
    v_dot2c_f32_bf16 v65, v177, v177
    v_dot2c_f32_bf16 v65, v178, v178
    v_dot2c_f32_bf16 v65, v179, v179
    v_dot2c_f32_bf16 v64, v176, v88
    v_dot2c_f32_bf16 v64, v177, v88
    v_dot2c_f32_bf16 v65, v180, v180
    v_dot2c_f32_bf16 v65, v181, v181
    v_dot2c_f32_bf16 v65, v182, v182
    v_dot2c_f32_bf16 v65, v183, v183
    v_dot2c_f32_bf16 v64, v180, v88
    v_dot2c_f32_bf16 v64, v181, v88
    v_mfma_f32_32x32x16_bf16 v[32:47], v[100:103], v[180:183], v[32:47]
    ds_read_b128 v[196:199], v93 offset:0
    ds_read_b64_tr_b16 v[100:101], v3 offset:10240
    ds_read_b64_tr_b16 v[102:103], v3 offset:10752
    s_waitcnt lgkmcnt(10)
    v_mfma_f32_32x32x16_bf16 v[32:47], v[104:107], v[184:187], v[32:47]
    ds_read_b32 v27, v24 offset:1152
    ds_read_b128 v[200:203], v94 offset:0
    ds_read_b64_tr_b16 v[104:105], v3 offset:12288
    s_waitcnt lgkmcnt(12)
    ds_read_b64_tr_b16 v[106:107], v3 offset:12800
    v_dot2c_f32_bf16 v65, v184, v184
    v_dot2c_f32_bf16 v65, v185, v185
    v_dot2c_f32_bf16 v65, v186, v186
    v_dot2c_f32_bf16 v65, v187, v187
    v_dot2c_f32_bf16 v64, v184, v88
    v_dot2c_f32_bf16 v64, v185, v88
    v_dot2c_f32_bf16 v65, v188, v188
    v_dot2c_f32_bf16 v65, v189, v189
    v_dot2c_f32_bf16 v65, v190, v190
    v_dot2c_f32_bf16 v65, v191, v191
    v_dot2c_f32_bf16 v64, v188, v88
    v_dot2c_f32_bf16 v64, v189, v88
    s_waitcnt lgkmcnt(11)
    v_mfma_f32_32x32x16_bf16 v[32:47], v[108:111], v[188:191], v[32:47]
    ds_read_b128 v[204:207], v95 offset:0
    ds_read_b64_tr_b16 v[108:109], v3 offset:14336
    s_waitcnt lgkmcnt(12)
    ds_read_b64_tr_b16 v[110:111], v3 offset:14848
    s_waitcnt lgkmcnt(6)
    v_cmp_gt_u32 vcc, 6, v27
    v_mfma_f32_32x32x16_bf16 v[32:47], v[96:99], v[192:195], v[32:47]
    s_cbranch_vccnz Lst14
Lbk15:
    ds_read_b128 v[208:211], v92 offset:16384
    ds_read_b64_tr_b16 v[96:97], v3 offset:24576
    ds_read_b64_tr_b16 v[98:99], v3 offset:25088
    v_dot2c_f32_bf16 v65, v192, v192
    v_dot2c_f32_bf16 v65, v193, v193
    v_dot2c_f32_bf16 v65, v194, v194
    v_dot2c_f32_bf16 v65, v195, v195
    v_dot2c_f32_bf16 v64, v192, v88
    v_dot2c_f32_bf16 v64, v193, v88
    v_dot2c_f32_bf16 v65, v196, v196
    v_dot2c_f32_bf16 v65, v197, v197
    v_dot2c_f32_bf16 v65, v198, v198
    v_dot2c_f32_bf16 v65, v199, v199
    v_dot2c_f32_bf16 v64, v196, v88
    v_dot2c_f32_bf16 v64, v197, v88
    v_mfma_f32_32x32x16_bf16 v[32:47], v[100:103], v[196:199], v[32:47]
    ds_read_b128 v[212:215], v93 offset:16384
    ds_read_b64_tr_b16 v[100:101], v3 offset:26624
    ds_read_b64_tr_b16 v[102:103], v3 offset:27136
    s_waitcnt lgkmcnt(9)
    v_mfma_f32_32x32x16_bf16 v[32:47], v[104:107], v[200:203], v[32:47]
    ds_read_b32 v27, v24 offset:1152
    ds_read_b128 v[216:219], v94 offset:16384
    ds_read_b64_tr_b16 v[104:105], v3 offset:28672
    ds_read_b64_tr_b16 v[106:107], v3 offset:29184
    v_dot2c_f32_bf16 v65, v200, v200
    v_dot2c_f32_bf16 v65, v201, v201
    v_dot2c_f32_bf16 v65, v202, v202
    v_dot2c_f32_bf16 v65, v203, v203
    v_dot2c_f32_bf16 v64, v200, v88
    v_dot2c_f32_bf16 v64, v201, v88
    s_waitcnt lgkmcnt(12)
    v_dot2c_f32_bf16 v65, v204, v204
    v_dot2c_f32_bf16 v65, v205, v205
    v_dot2c_f32_bf16 v65, v206, v206
    v_dot2c_f32_bf16 v65, v207, v207
    v_dot2c_f32_bf16 v64, v204, v88
    v_dot2c_f32_bf16 v64, v205, v88
    s_waitcnt lgkmcnt(10)
    v_mfma_f32_32x32x16_bf16 v[32:47], v[108:111], v[204:207], v[32:47]
    ds_read_b128 v[220:223], v95 offset:16384
    ds_read_b64_tr_b16 v[108:109], v3 offset:30720
    ds_read_b64_tr_b16 v[110:111], v3 offset:31232
    s_waitcnt lgkmcnt(6)
    v_cmp_gt_u32 vcc, 7, v27
    v_mfma_f32_32x32x16_bf16 v[32:47], v[96:99], v[208:211], v[32:47]
    s_cbranch_vccnz Lst16
Lbk17:
    ds_read_b128 v[224:227], v92 offset:32768
    ds_read_b64_tr_b16 v[96:97], v3 offset:40960
    ds_read_b64_tr_b16 v[98:99], v3 offset:41472
    v_dot2c_f32_bf16 v65, v208, v208
    v_dot2c_f32_bf16 v65, v209, v209
    v_dot2c_f32_bf16 v65, v210, v210
    v_dot2c_f32_bf16 v65, v211, v211
    v_dot2c_f32_bf16 v64, v208, v88
    v_dot2c_f32_bf16 v64, v209, v88
    v_dot2c_f32_bf16 v65, v212, v212
    v_dot2c_f32_bf16 v65, v213, v213
    v_dot2c_f32_bf16 v65, v214, v214
    v_dot2c_f32_bf16 v65, v215, v215
    v_dot2c_f32_bf16 v64, v212, v88
    v_dot2c_f32_bf16 v64, v213, v88
    v_mfma_f32_32x32x16_bf16 v[32:47], v[100:103], v[212:215], v[32:47]
    ds_read_b128 v[228:231], v93 offset:32768
    ds_read_b64_tr_b16 v[100:101], v3 offset:43008
    ds_read_b64_tr_b16 v[102:103], v3 offset:43520
    s_waitcnt lgkmcnt(9)
    v_mfma_f32_32x32x16_bf16 v[32:47], v[104:107], v[216:219], v[32:47]
    ds_read_b32 v27, v24 offset:1152
    ds_read_b128 v[232:235], v94 offset:32768
    ds_read_b64_tr_b16 v[104:105], v3 offset:45056
    ds_read_b64_tr_b16 v[106:107], v3 offset:45568
    v_dot2c_f32_bf16 v65, v216, v216
    v_dot2c_f32_bf16 v65, v217, v217
    v_dot2c_f32_bf16 v65, v218, v218
    v_dot2c_f32_bf16 v65, v219, v219
    v_dot2c_f32_bf16 v64, v216, v88
    v_dot2c_f32_bf16 v64, v217, v88
    s_waitcnt lgkmcnt(12)
    v_dot2c_f32_bf16 v65, v220, v220
    v_dot2c_f32_bf16 v65, v221, v221
    v_dot2c_f32_bf16 v65, v222, v222
    v_dot2c_f32_bf16 v65, v223, v223
    v_dot2c_f32_bf16 v64, v220, v88
    v_dot2c_f32_bf16 v64, v221, v88
    s_waitcnt lgkmcnt(10)
    v_mfma_f32_32x32x16_bf16 v[32:47], v[108:111], v[220:223], v[32:47]
    ds_read_b128 v[236:239], v95 offset:32768
    ds_read_b64_tr_b16 v[108:109], v3 offset:47104
    ds_read_b64_tr_b16 v[110:111], v3 offset:47616
    s_waitcnt lgkmcnt(6)
    v_cmp_gt_u32 vcc, 8, v27
    v_mfma_f32_32x32x16_bf16 v[32:47], v[96:99], v[224:227], v[32:47]
    s_cbranch_vccnz Lst18
Lbk19:
    ds_read_b128 v[240:243], v92 offset:49152
    ds_read_b64_tr_b16 v[96:97], v3 offset:57344
    ds_read_b64_tr_b16 v[98:99], v3 offset:57856
    v_dot2c_f32_bf16 v65, v224, v224
    v_dot2c_f32_bf16 v65, v225, v225
    v_dot2c_f32_bf16 v65, v226, v226
    v_dot2c_f32_bf16 v65, v227, v227
    v_dot2c_f32_bf16 v64, v224, v88
    v_dot2c_f32_bf16 v64, v225, v88
    v_dot2c_f32_bf16 v65, v228, v228
    v_dot2c_f32_bf16 v65, v229, v229
    v_dot2c_f32_bf16 v65, v230, v230
    v_dot2c_f32_bf16 v65, v231, v231
    v_dot2c_f32_bf16 v64, v228, v88
    v_dot2c_f32_bf16 v64, v229, v88
    v_mfma_f32_32x32x16_bf16 v[32:47], v[100:103], v[228:231], v[32:47]
    ds_read_b128 v[244:247], v93 offset:49152
    ds_read_b64_tr_b16 v[100:101], v3 offset:59392
    ds_read_b64_tr_b16 v[102:103], v3 offset:59904
    s_waitcnt lgkmcnt(9)
    v_mfma_f32_32x32x16_bf16 v[32:47], v[104:107], v[232:235], v[32:47]
    ds_read_b128 v[248:251], v94 offset:49152
    ds_read_b64_tr_b16 v[104:105], v3 offset:61440
    ds_read_b64_tr_b16 v[106:107], v3 offset:61952
    v_dot2c_f32_bf16 v65, v232, v232
    v_dot2c_f32_bf16 v65, v233, v233
    v_dot2c_f32_bf16 v65, v234, v234
    v_dot2c_f32_bf16 v65, v235, v235
    v_dot2c_f32_bf16 v64, v232, v88
    v_dot2c_f32_bf16 v64, v233, v88
    s_waitcnt lgkmcnt(11)
    v_dot2c_f32_bf16 v65, v236, v236
    v_dot2c_f32_bf16 v65, v237, v237
    v_dot2c_f32_bf16 v65, v238, v238
    v_dot2c_f32_bf16 v65, v239, v239
    v_dot2c_f32_bf16 v64, v236, v88
    v_dot2c_f32_bf16 v64, v237, v88
    s_waitcnt lgkmcnt(9)
    v_mfma_f32_32x32x16_bf16 v[32:47], v[108:111], v[236:239], v[32:47]
    s_waitcnt vmcnt(0)
    ds_read_b128 v[252:255], v95 offset:49152
    ds_read_b64_tr_b16 v[108:109], v3 offset:63488
    ds_read_b64_tr_b16 v[110:111], v3 offset:64000
    s_waitcnt lgkmcnt(9)
    v_mfma_f32_32x32x16_bf16 v[32:47], v[96:99], v[240:243], v[32:47]
    v_dot2c_f32_bf16 v65, v240, v240
    v_dot2c_f32_bf16 v65, v241, v241
    v_dot2c_f32_bf16 v65, v242, v242
    v_dot2c_f32_bf16 v65, v243, v243
    v_dot2c_f32_bf16 v64, v240, v88
    v_dot2c_f32_bf16 v64, v241, v88
    s_waitcnt lgkmcnt(8)
    v_dot2c_f32_bf16 v65, v244, v244
    v_dot2c_f32_bf16 v65, v245, v245
    v_dot2c_f32_bf16 v65, v246, v246
    v_dot2c_f32_bf16 v65, v247, v247
    v_dot2c_f32_bf16 v64, v244, v88
    v_dot2c_f32_bf16 v64, v245, v88
    s_waitcnt lgkmcnt(6)
    v_mfma_f32_32x32x16_bf16 v[32:47], v[100:103], v[244:247], v[32:47]
    ds_read_b32 v27, v24 offset:1152
    s_waitcnt lgkmcnt(4)
    v_mfma_f32_32x32x16_bf16 v[32:47], v[104:107], v[248:251], v[32:47]
    v_dot2c_f32_bf16 v65, v248, v248
    v_dot2c_f32_bf16 v65, v249, v249
    v_dot2c_f32_bf16 v65, v250, v250
    v_dot2c_f32_bf16 v65, v251, v251
    v_dot2c_f32_bf16 v64, v248, v88
    v_dot2c_f32_bf16 v64, v249, v88
    s_waitcnt lgkmcnt(3)
    v_dot2c_f32_bf16 v65, v252, v252
    v_dot2c_f32_bf16 v65, v253, v253
    v_dot2c_f32_bf16 v65, v254, v254
    v_dot2c_f32_bf16 v65, v255, v255
    v_dot2c_f32_bf16 v64, v252, v88
    v_dot2c_f32_bf16 v64, v253, v88
    s_waitcnt lgkmcnt(1)
    v_mfma_f32_32x32x16_bf16 v[32:47], v[108:111], v[252:255], v[32:47]
    s_waitcnt lgkmcnt(0)
    v_cmp_gt_u32 vcc, 10, v27
    s_cbranch_vccnz Lst20
Lbk21:
    ds_read_b64_tr_b16 v[96:97], v4 offset:0
    ds_read_b64_tr_b16 v[98:99], v4 offset:512
    ds_read_b64_tr_b16 v[100:101], v4 offset:2048
    ds_read_b64_tr_b16 v[102:103], v4 offset:2560
    ds_read_b64_tr_b16 v[104:105], v4 offset:4096
    ds_read_b64_tr_b16 v[106:107], v4 offset:4608
    ds_read_b64_tr_b16 v[108:109], v4 offset:6144
    ds_read_b64_tr_b16 v[110:111], v4 offset:6656
    ds_read_b64_tr_b16 v[112:113], v4 offset:8192
    ds_read_b64_tr_b16 v[114:115], v4 offset:8704
    ds_write2st64_b32 v7, v64, v65 offset1:1
    ds_add_u32 v25, v26
    s_branch Lhj3
Lhc2:
    ds_read_b32 v31, v24 offset:1152
    s_waitcnt lgkmcnt(0)
    v_cmp_gt_u32 vcc, 1, v31
    s_cbranch_vccnz Lst22
Lbk23:
    ds_read_b128 v[128:131], v92 offset:0
    ds_read_b64_tr_b16 v[96:97], v2 offset:8192
    ds_read_b64_tr_b16 v[98:99], v2 offset:8704
    ds_read_b128 v[132:135], v93 offset:0
    ds_read_b64_tr_b16 v[100:101], v2 offset:10240
    ds_read_b64_tr_b16 v[102:103], v2 offset:10752
    ds_read_b128 v[136:139], v94 offset:0
    ds_read_b64_tr_b16 v[104:105], v2 offset:12288
    ds_read_b64_tr_b16 v[106:107], v2 offset:12800
    ds_read_b128 v[140:143], v95 offset:0
    ds_read_b64_tr_b16 v[108:109], v2 offset:14336
    ds_read_b64_tr_b16 v[110:111], v2 offset:14848
    ds_read_b32 v27, v24 offset:1152
    s_waitcnt lgkmcnt(0)
    v_cmp_gt_u32 vcc, 2, v27
    v_dot2c_f32_bf16 v64, v130, v88
    v_dot2c_f32_bf16 v64, v131, v88
    v_dot2c_f32_bf16 v65, v96, v88
    v_dot2c_f32_bf16 v65, v97, v88
    v_dot2c_f32_bf16 v65, v98, v88
    v_dot2c_f32_bf16 v65, v99, v88
    v_dot2c_f32_bf16 v64, v134, v88
    v_dot2c_f32_bf16 v64, v135, v88
    v_dot2c_f32_bf16 v65, v100, v88
    v_dot2c_f32_bf16 v65, v101, v88
    v_dot2c_f32_bf16 v65, v102, v88
    v_dot2c_f32_bf16 v65, v103, v88
    v_mfma_f32_32x32x16_bf16 v[32:47], v[96:99], v[128:131], 0
    s_cbranch_vccnz Lst24
Lbk25:
    ds_read_b128 v[144:147], v92 offset:16384
    ds_read_b64_tr_b16 v[96:97], v2 offset:24576
    ds_read_b64_tr_b16 v[98:99], v2 offset:25088
    v_mfma_f32_32x32x16_bf16 v[32:47], v[100:103], v[132:135], v[32:47]
    ds_read_b128 v[148:151], v93 offset:16384
    ds_read_b64_tr_b16 v[100:101], v2 offset:26624
    ds_read_b64_tr_b16 v[102:103], v2 offset:27136
    v_dot2c_f32_bf16 v64, v138, v88
    v_dot2c_f32_bf16 v64, v139, v88
    v_dot2c_f32_bf16 v65, v104, v88
    v_dot2c_f32_bf16 v65, v105, v88
    v_dot2c_f32_bf16 v65, v106, v88
    v_dot2c_f32_bf16 v65, v107, v88
    v_dot2c_f32_bf16 v64, v142, v88
    v_dot2c_f32_bf16 v64, v143, v88
    v_dot2c_f32_bf16 v65, v108, v88
    v_dot2c_f32_bf16 v65, v109, v88
    v_dot2c_f32_bf16 v65, v110, v88
    v_dot2c_f32_bf16 v65, v111, v88
    v_mfma_f32_32x32x16_bf16 v[32:47], v[104:107], v[136:139], v[32:47]
    ds_read_b32 v27, v24 offset:1152
    ds_read_b128 v[152:155], v94 offset:16384
    ds_read_b64_tr_b16 v[104:105], v2 offset:28672
    ds_read_b64_tr_b16 v[106:107], v2 offset:29184
    v_mfma_f32_32x32x16_bf16 v[32:47], v[108:111], v[140:143], v[32:47]
    ds_read_b128 v[156:159], v95 offset:16384
    ds_read_b64_tr_b16 v[108:109], v2 offset:30720
    ds_read_b64_tr_b16 v[110:111], v2 offset:31232
    s_waitcnt lgkmcnt(6)
    v_cmp_gt_u32 vcc, 3, v27
    v_dot2c_f32_bf16 v64, v146, v88
    v_dot2c_f32_bf16 v64, v147, v88
    v_dot2c_f32_bf16 v65, v96, v88
    v_dot2c_f32_bf16 v65, v97, v88
    v_dot2c_f32_bf16 v65, v98, v88
    v_dot2c_f32_bf16 v65, v99, v88
    v_dot2c_f32_bf16 v64, v150, v88
    v_dot2c_f32_bf16 v64, v151, v88
    v_dot2c_f32_bf16 v65, v100, v88
    v_dot2c_f32_bf16 v65, v101, v88
    v_dot2c_f32_bf16 v65, v102, v88
    v_dot2c_f32_bf16 v65, v103, v88
    v_mfma_f32_32x32x16_bf16 v[32:47], v[96:99], v[144:147], v[32:47]
    s_cbranch_vccnz Lst26
Lbk27:
    ds_read_b128 v[160:163], v92 offset:32768
    ds_read_b64_tr_b16 v[96:97], v2 offset:40960
    ds_read_b64_tr_b16 v[98:99], v2 offset:41472
    v_mfma_f32_32x32x16_bf16 v[32:47], v[100:103], v[148:151], v[32:47]
    ds_read_b128 v[164:167], v93 offset:32768
    ds_read_b64_tr_b16 v[100:101], v2 offset:43008
    ds_read_b64_tr_b16 v[102:103], v2 offset:43520
    s_waitcnt lgkmcnt(11)
    v_dot2c_f32_bf16 v64, v154, v88
    v_dot2c_f32_bf16 v64, v155, v88
    s_waitcnt lgkmcnt(10)
    v_dot2c_f32_bf16 v65, v104, v88
    v_dot2c_f32_bf16 v65, v105, v88
    s_waitcnt lgkmcnt(9)
    v_dot2c_f32_bf16 v65, v106, v88
    v_dot2c_f32_bf16 v65, v107, v88
    s_waitcnt lgkmcnt(8)
    v_dot2c_f32_bf16 v64, v158, v88
    v_dot2c_f32_bf16 v64, v159, v88
    s_waitcnt lgkmcnt(7)
    v_dot2c_f32_bf16 v65, v108, v88
    v_dot2c_f32_bf16 v65, v109, v88
    s_waitcnt lgkmcnt(6)
    v_dot2c_f32_bf16 v65, v110, v88
    v_dot2c_f32_bf16 v65, v111, v88
    v_mfma_f32_32x32x16_bf16 v[32:47], v[104:107], v[152:155], v[32:47]
    ds_read_b32 v27, v24 offset:1152
    ds_read_b128 v[168:171], v94 offset:32768
    ds_read_b64_tr_b16 v[104:105], v2 offset:45056
    ds_read_b64_tr_b16 v[106:107], v2 offset:45568
    v_mfma_f32_32x32x16_bf16 v[32:47], v[108:111], v[156:159], v[32:47]
    ds_read_b128 v[172:175], v95 offset:32768
    ds_read_b64_tr_b16 v[108:109], v2 offset:47104
    ds_read_b64_tr_b16 v[110:111], v2 offset:47616
    s_waitcnt lgkmcnt(6)
    v_cmp_gt_u32 vcc, 4, v27
    v_dot2c_f32_bf16 v64, v162, v88
    v_dot2c_f32_bf16 v64, v163, v88
    v_dot2c_f32_bf16 v65, v96, v88
    v_dot2c_f32_bf16 v65, v97, v88
    v_dot2c_f32_bf16 v65, v98, v88
    v_dot2c_f32_bf16 v65, v99, v88
    v_dot2c_f32_bf16 v64, v166, v88
    v_dot2c_f32_bf16 v64, v167, v88
    v_dot2c_f32_bf16 v65, v100, v88
    v_dot2c_f32_bf16 v65, v101, v88
    v_dot2c_f32_bf16 v65, v102, v88
    v_dot2c_f32_bf16 v65, v103, v88
    v_mfma_f32_32x32x16_bf16 v[32:47], v[96:99], v[160:163], v[32:47]
    s_cbranch_vccnz Lst28
Lbk29:
    ds_read_b128 v[176:179], v92 offset:49152
    ds_read_b64_tr_b16 v[96:97], v2 offset:57344
    ds_read_b64_tr_b16 v[98:99], v2 offset:57856
    v_mfma_f32_32x32x16_bf16 v[32:47], v[100:103], v[164:167], v[32:47]
    ds_read_b128 v[180:183], v93 offset:49152
    ds_read_b64_tr_b16 v[100:101], v2 offset:59392
    ds_read_b64_tr_b16 v[102:103], v2 offset:59904
    s_waitcnt lgkmcnt(11)
    v_dot2c_f32_bf16 v64, v170, v88
    v_dot2c_f32_bf16 v64, v171, v88
    s_waitcnt lgkmcnt(10)
    v_dot2c_f32_bf16 v65, v104, v88
    v_dot2c_f32_bf16 v65, v105, v88
    s_waitcnt lgkmcnt(9)
    v_dot2c_f32_bf16 v65, v106, v88
    v_dot2c_f32_bf16 v65, v107, v88
    s_waitcnt lgkmcnt(8)
    v_dot2c_f32_bf16 v64, v174, v88
    v_dot2c_f32_bf16 v64, v175, v88
    s_waitcnt lgkmcnt(7)
    v_dot2c_f32_bf16 v65, v108, v88
    v_dot2c_f32_bf16 v65, v109, v88
    s_waitcnt lgkmcnt(6)
    v_dot2c_f32_bf16 v65, v110, v88
    v_dot2c_f32_bf16 v65, v111, v88
    v_mfma_f32_32x32x16_bf16 v[32:47], v[104:107], v[168:171], v[32:47]
    ds_read_b32 v27, v24 offset:1152
    ds_read_b128 v[184:187], v94 offset:49152
    ds_read_b64_tr_b16 v[104:105], v2 offset:61440
    ds_read_b64_tr_b16 v[106:107], v2 offset:61952
    v_mfma_f32_32x32x16_bf16 v[32:47], v[108:111], v[172:175], v[32:47]
    ds_read_b128 v[188:191], v95 offset:49152
    ds_read_b64_tr_b16 v[108:109], v2 offset:63488
    ds_read_b64_tr_b16 v[110:111], v2 offset:64000
    s_waitcnt lgkmcnt(12)
    ds_add_u32 v25, v26
    s_waitcnt lgkmcnt(7)
    v_cmp_gt_u32 vcc, 5, v27
    v_dot2c_f32_bf16 v64, v178, v88
    v_dot2c_f32_bf16 v64, v179, v88
    v_dot2c_f32_bf16 v65, v96, v88
    v_dot2c_f32_bf16 v65, v97, v88
    v_dot2c_f32_bf16 v65, v98, v88
    v_dot2c_f32_bf16 v65, v99, v88
    v_dot2c_f32_bf16 v64, v182, v88
    v_dot2c_f32_bf16 v64, v183, v88
    v_dot2c_f32_bf16 v65, v100, v88
    v_dot2c_f32_bf16 v65, v101, v88
    v_dot2c_f32_bf16 v65, v102, v88
    v_dot2c_f32_bf16 v65, v103, v88
    v_mfma_f32_32x32x16_bf16 v[32:47], v[96:99], v[176:179], v[32:47]
    s_cbranch_vccnz Lst30
Lbk31:
    v_add_u32 v92, 0x10000, v92
    v_add_u32 v93, 0x10000, v93
    v_add_u32 v94, 0x10000, v94
    v_add_u32 v95, 0x10000, v95
    ds_read_b128 v[192:195], v92 offset:0
    ds_read_b64_tr_b16 v[96:97], v3 offset:8192
    ds_read_b64_tr_b16 v[98:99], v3 offset:8704
    v_mfma_f32_32x32x16_bf16 v[32:47], v[100:103], v[180:183], v[32:47]
    ds_read_b128 v[196:199], v93 offset:0
    ds_read_b64_tr_b16 v[100:101], v3 offset:10240
    ds_read_b64_tr_b16 v[102:103], v3 offset:10752
    s_waitcnt lgkmcnt(12)
    v_dot2c_f32_bf16 v64, v186, v88
    v_dot2c_f32_bf16 v64, v187, v88
    s_waitcnt lgkmcnt(11)
    v_dot2c_f32_bf16 v65, v104, v88
    v_dot2c_f32_bf16 v65, v105, v88
    s_waitcnt lgkmcnt(10)
    v_dot2c_f32_bf16 v65, v106, v88
    v_dot2c_f32_bf16 v65, v107, v88
    s_waitcnt lgkmcnt(9)
    v_dot2c_f32_bf16 v64, v190, v88
    v_dot2c_f32_bf16 v64, v191, v88
    s_waitcnt lgkmcnt(8)
    v_dot2c_f32_bf16 v65, v108, v88
    v_dot2c_f32_bf16 v65, v109, v88
    s_waitcnt lgkmcnt(7)
    v_dot2c_f32_bf16 v65, v110, v88
    v_dot2c_f32_bf16 v65, v111, v88
    v_mfma_f32_32x32x16_bf16 v[32:47], v[104:107], v[184:187], v[32:47]
    ds_read_b32 v27, v24 offset:1152
    ds_read_b128 v[200:203], v94 offset:0
    ds_read_b64_tr_b16 v[104:105], v3 offset:12288
    ds_read_b64_tr_b16 v[106:107], v3 offset:12800
    v_mfma_f32_32x32x16_bf16 v[32:47], v[108:111], v[188:191], v[32:47]
    ds_read_b128 v[204:207], v95 offset:0
    ds_read_b64_tr_b16 v[108:109], v3 offset:14336
    s_waitcnt lgkmcnt(12)
    ds_read_b64_tr_b16 v[110:111], v3 offset:14848
    s_waitcnt lgkmcnt(6)
    v_cmp_gt_u32 vcc, 6, v27
    v_dot2c_f32_bf16 v64, v194, v88
    v_dot2c_f32_bf16 v64, v195, v88
    v_dot2c_f32_bf16 v65, v96, v88
    v_dot2c_f32_bf16 v65, v97, v88
    v_dot2c_f32_bf16 v65, v98, v88
    v_dot2c_f32_bf16 v65, v99, v88
    v_dot2c_f32_bf16 v64, v198, v88
    v_dot2c_f32_bf16 v64, v199, v88
    v_dot2c_f32_bf16 v65, v100, v88
    v_dot2c_f32_bf16 v65, v101, v88
    v_dot2c_f32_bf16 v65, v102, v88
    v_dot2c_f32_bf16 v65, v103, v88
    v_mfma_f32_32x32x16_bf16 v[32:47], v[96:99], v[192:195], v[32:47]
    s_cbranch_vccnz Lst32
Lbk33:
    ds_read_b128 v[208:211], v92 offset:16384
    ds_read_b64_tr_b16 v[96:97], v3 offset:24576
    ds_read_b64_tr_b16 v[98:99], v3 offset:25088
    v_mfma_f32_32x32x16_bf16 v[32:47], v[100:103], v[196:199], v[32:47]
    ds_read_b128 v[212:215], v93 offset:16384
    ds_read_b64_tr_b16 v[100:101], v3 offset:26624
    ds_read_b64_tr_b16 v[102:103], v3 offset:27136
    s_waitcnt lgkmcnt(11)
    v_dot2c_f32_bf16 v64, v202, v88
    v_dot2c_f32_bf16 v64, v203, v88
    s_waitcnt lgkmcnt(10)
    v_dot2c_f32_bf16 v65, v104, v88
    v_dot2c_f32_bf16 v65, v105, v88
    s_waitcnt lgkmcnt(9)
    v_dot2c_f32_bf16 v65, v106, v88
    v_dot2c_f32_bf16 v65, v107, v88
    s_waitcnt lgkmcnt(8)
    v_dot2c_f32_bf16 v64, v206, v88
    v_dot2c_f32_bf16 v64, v207, v88
    s_waitcnt lgkmcnt(7)
    v_dot2c_f32_bf16 v65, v108, v88
    v_dot2c_f32_bf16 v65, v109, v88
    s_waitcnt lgkmcnt(6)
    v_dot2c_f32_bf16 v65, v110, v88
    v_dot2c_f32_bf16 v65, v111, v88
    v_mfma_f32_32x32x16_bf16 v[32:47], v[104:107], v[200:203], v[32:47]
    ds_read_b32 v27, v24 offset:1152
    ds_read_b128 v[216:219], v94 offset:16384
    ds_read_b64_tr_b16 v[104:105], v3 offset:28672
    ds_read_b64_tr_b16 v[106:107], v3 offset:29184
    v_mfma_f32_32x32x16_bf16 v[32:47], v[108:111], v[204:207], v[32:47]
    ds_read_b128 v[220:223], v95 offset:16384
    ds_read_b64_tr_b16 v[108:109], v3 offset:30720
    ds_read_b64_tr_b16 v[110:111], v3 offset:31232
    s_waitcnt lgkmcnt(6)
    v_cmp_gt_u32 vcc, 7, v27
    v_dot2c_f32_bf16 v64, v210, v88
    v_dot2c_f32_bf16 v64, v211, v88
    v_dot2c_f32_bf16 v65, v96, v88
    v_dot2c_f32_bf16 v65, v97, v88
    v_dot2c_f32_bf16 v65, v98, v88
    v_dot2c_f32_bf16 v65, v99, v88
    v_dot2c_f32_bf16 v64, v214, v88
    v_dot2c_f32_bf16 v64, v215, v88
    v_dot2c_f32_bf16 v65, v100, v88
    v_dot2c_f32_bf16 v65, v101, v88
    v_dot2c_f32_bf16 v65, v102, v88
    v_dot2c_f32_bf16 v65, v103, v88
    v_mfma_f32_32x32x16_bf16 v[32:47], v[96:99], v[208:211], v[32:47]
    s_cbranch_vccnz Lst34
Lbk35:
    ds_read_b128 v[224:227], v92 offset:32768
    ds_read_b64_tr_b16 v[96:97], v3 offset:40960
    ds_read_b64_tr_b16 v[98:99], v3 offset:41472
    v_mfma_f32_32x32x16_bf16 v[32:47], v[100:103], v[212:215], v[32:47]
    ds_read_b128 v[228:231], v93 offset:32768
    ds_read_b64_tr_b16 v[100:101], v3 offset:43008
    ds_read_b64_tr_b16 v[102:103], v3 offset:43520
    s_waitcnt lgkmcnt(11)
    v_dot2c_f32_bf16 v64, v218, v88
    v_dot2c_f32_bf16 v64, v219, v88
    s_waitcnt lgkmcnt(10)
    v_dot2c_f32_bf16 v65, v104, v88
    v_dot2c_f32_bf16 v65, v105, v88
    s_waitcnt lgkmcnt(9)
    v_dot2c_f32_bf16 v65, v106, v88
    v_dot2c_f32_bf16 v65, v107, v88
    s_waitcnt lgkmcnt(8)
    v_dot2c_f32_bf16 v64, v222, v88
    v_dot2c_f32_bf16 v64, v223, v88
    s_waitcnt lgkmcnt(7)
    v_dot2c_f32_bf16 v65, v108, v88
    v_dot2c_f32_bf16 v65, v109, v88
    s_waitcnt lgkmcnt(6)
    v_dot2c_f32_bf16 v65, v110, v88
    v_dot2c_f32_bf16 v65, v111, v88
    v_mfma_f32_32x32x16_bf16 v[32:47], v[104:107], v[216:219], v[32:47]
    ds_read_b32 v27, v24 offset:1152
    ds_read_b128 v[232:235], v94 offset:32768
    ds_read_b64_tr_b16 v[104:105], v3 offset:45056
    ds_read_b64_tr_b16 v[106:107], v3 offset:45568
    v_mfma_f32_32x32x16_bf16 v[32:47], v[108:111], v[220:223], v[32:47]
    ds_read_b128 v[236:239], v95 offset:32768
    ds_read_b64_tr_b16 v[108:109], v3 offset:47104
    ds_read_b64_tr_b16 v[110:111], v3 offset:47616
    s_waitcnt lgkmcnt(6)
    v_cmp_gt_u32 vcc, 8, v27
    v_dot2c_f32_bf16 v64, v226, v88
    v_dot2c_f32_bf16 v64, v227, v88
    v_dot2c_f32_bf16 v65, v96, v88
    v_dot2c_f32_bf16 v65, v97, v88
    v_dot2c_f32_bf16 v65, v98, v88
    v_dot2c_f32_bf16 v65, v99, v88
    v_dot2c_f32_bf16 v64, v230, v88
    v_dot2c_f32_bf16 v64, v231, v88
    v_dot2c_f32_bf16 v65, v100, v88
    v_dot2c_f32_bf16 v65, v101, v88
    v_dot2c_f32_bf16 v65, v102, v88
    v_dot2c_f32_bf16 v65, v103, v88
    v_mfma_f32_32x32x16_bf16 v[32:47], v[96:99], v[224:227], v[32:47]
    s_cbranch_vccnz Lst36
Lbk37:
    ds_read_b128 v[240:243], v92 offset:49152
    ds_read_b64_tr_b16 v[96:97], v3 offset:57344
    ds_read_b64_tr_b16 v[98:99], v3 offset:57856
    v_mfma_f32_32x32x16_bf16 v[32:47], v[100:103], v[228:231], v[32:47]
    ds_read_b128 v[244:247], v93 offset:49152
    ds_read_b64_tr_b16 v[100:101], v3 offset:59392
    ds_read_b64_tr_b16 v[102:103], v3 offset:59904
    s_waitcnt lgkmcnt(11)
    v_dot2c_f32_bf16 v64, v234, v88
    v_dot2c_f32_bf16 v64, v235, v88
    s_waitcnt lgkmcnt(10)
    v_dot2c_f32_bf16 v65, v104, v88
    v_dot2c_f32_bf16 v65, v105, v88
    s_waitcnt lgkmcnt(9)
    v_dot2c_f32_bf16 v65, v106, v88
    v_dot2c_f32_bf16 v65, v107, v88
    s_waitcnt lgkmcnt(8)
    v_dot2c_f32_bf16 v64, v238, v88
    v_dot2c_f32_bf16 v64, v239, v88
    s_waitcnt lgkmcnt(7)
    v_dot2c_f32_bf16 v65, v108, v88
    v_dot2c_f32_bf16 v65, v109, v88
    s_waitcnt lgkmcnt(6)
    v_dot2c_f32_bf16 v65, v110, v88
    v_dot2c_f32_bf16 v65, v111, v88
    v_mfma_f32_32x32x16_bf16 v[32:47], v[104:107], v[232:235], v[32:47]
    ds_read_b128 v[248:251], v94 offset:49152
    ds_read_b64_tr_b16 v[104:105], v3 offset:61440
    ds_read_b64_tr_b16 v[106:107], v3 offset:61952
    v_mfma_f32_32x32x16_bf16 v[32:47], v[108:111], v[236:239], v[32:47]
    s_waitcnt vmcnt(0)
    ds_read_b128 v[252:255], v95 offset:49152
    ds_read_b64_tr_b16 v[108:109], v3 offset:63488
    ds_read_b64_tr_b16 v[110:111], v3 offset:64000
    s_waitcnt lgkmcnt(11)
    v_dot2c_f32_bf16 v64, v242, v88
    v_dot2c_f32_bf16 v64, v243, v88
    s_waitcnt lgkmcnt(10)
    v_dot2c_f32_bf16 v65, v96, v88
    v_dot2c_f32_bf16 v65, v97, v88
    s_waitcnt lgkmcnt(9)
    v_dot2c_f32_bf16 v65, v98, v88
    v_dot2c_f32_bf16 v65, v99, v88
    s_waitcnt lgkmcnt(8)
    v_dot2c_f32_bf16 v64, v246, v88
    v_dot2c_f32_bf16 v64, v247, v88
    s_waitcnt lgkmcnt(7)
    v_dot2c_f32_bf16 v65, v100, v88
    v_dot2c_f32_bf16 v65, v101, v88
    s_waitcnt lgkmcnt(6)
    v_dot2c_f32_bf16 v65, v102, v88
    v_dot2c_f32_bf16 v65, v103, v88
    v_mfma_f32_32x32x16_bf16 v[32:47], v[96:99], v[240:243], v[32:47]
    v_mfma_f32_32x32x16_bf16 v[32:47], v[100:103], v[244:247], v[32:47]
    ds_read_b32 v27, v24 offset:1152
    s_waitcnt lgkmcnt(6)
    v_dot2c_f32_bf16 v64, v250, v88
    v_dot2c_f32_bf16 v64, v251, v88
    s_waitcnt lgkmcnt(5)
    v_dot2c_f32_bf16 v65, v104, v88
    v_dot2c_f32_bf16 v65, v105, v88
    s_waitcnt lgkmcnt(4)
    v_dot2c_f32_bf16 v65, v106, v88
    v_dot2c_f32_bf16 v65, v107, v88
    s_waitcnt lgkmcnt(3)
    v_dot2c_f32_bf16 v64, v254, v88
    v_dot2c_f32_bf16 v64, v255, v88
    s_waitcnt lgkmcnt(2)
    v_dot2c_f32_bf16 v65, v108, v88
    v_dot2c_f32_bf16 v65, v109, v88
    s_waitcnt lgkmcnt(1)
    v_dot2c_f32_bf16 v65, v110, v88
    v_dot2c_f32_bf16 v65, v111, v88
    v_mfma_f32_32x32x16_bf16 v[32:47], v[104:107], v[248:251], v[32:47]
    v_mfma_f32_32x32x16_bf16 v[32:47], v[108:111], v[252:255], v[32:47]
    s_waitcnt lgkmcnt(0)
    v_cmp_gt_u32 vcc, 10, v27
    s_cbranch_vccnz Lst38
Lbk39:
    ds_read_b64_tr_b16 v[96:97], v4 offset:0
    ds_read_b64_tr_b16 v[98:99], v4 offset:512
    ds_read_b64_tr_b16 v[100:101], v4 offset:2048
    ds_read_b64_tr_b16 v[102:103], v4 offset:2560
    ds_read_b64_tr_b16 v[104:105], v4 offset:4096
    ds_read_b64_tr_b16 v[106:107], v4 offset:4608
    ds_read_b64_tr_b16 v[108:109], v4 offset:6144
    ds_read_b64_tr_b16 v[110:111], v4 offset:6656
    ds_read_b64_tr_b16 v[112:113], v4 offset:8192
    ds_read_b64_tr_b16 v[114:115], v4 offset:8704
    v_mov_b32 v66, v65
    s_nop 1
    v_permlane32_swap_b32 v65, v66
    v_add_f32 v65, v65, v66
    ds_write2st64_b32 v7, v64, v65 offset1:1
    ds_add_u32 v25, v26
Lhj3:
    s_waitcnt lgkmcnt(10)
    v_mfma_f32_32x32x16_bf16 v[48:63], v[96:99], v[128:131], 0
    ds_read_b64_tr_b16 v[96:97], v4 offset:10240
    ds_read_b64_tr_b16 v[98:99], v4 offset:10752
    s_waitcnt lgkmcnt(10)
    v_mfma_f32_32x32x16_bf16 v[48:63], v[100:103], v[132:135], v[48:63]
    ds_read_b64_tr_b16 v[100:101], v4 offset:12288
    ds_read_b64_tr_b16 v[102:103], v4 offset:12800
    s_waitcnt lgkmcnt(10)
    v_mfma_f32_32x32x16_bf16 v[48:63], v[104:107], v[136:139], v[48:63]
    ds_read_b32 v27, v29 offset:0
    ds_read_b64_tr_b16 v[104:105], v4 offset:14336
    ds_read_b64_tr_b16 v[106:107], v4 offset:14848
    s_waitcnt lgkmcnt(11)
    v_mfma_f32_32x32x16_bf16 v[48:63], v[108:111], v[140:143], v[48:63]
    ds_read_b64_tr_b16 v[108:109], v2 offset:0
    ds_read_b64_tr_b16 v[110:111], v2 offset:512
    s_waitcnt lgkmcnt(11)
    s_waitcnt lgkmcnt(4)
    v_cmp_gt_u32 vcc, 2, v27
    v_mfma_f32_32x32x16_bf16 v[48:63], v[112:115], v[144:147], v[48:63]
    s_cbranch_vccnz Lst40
Lbk41:
    ds_read_b64_tr_b16 v[112:113], v2 offset:2048
    ds_read_b64_tr_b16 v[114:115], v2 offset:2560
    ds_read2st64_b32 v[12:13], v5 offset1:1
    ds_read_b32 v11, v126
    v_mfma_f32_32x32x16_bf16 v[48:63], v[96:99], v[148:151], v[48:63]
    ds_read_b64_tr_b16 v[96:97], v2 offset:4096
    ds_read_b64_tr_b16 v[98:99], v2 offset:4608
    ds_read_b128 v[64:67], v6 offset:0
    ds_read_b128 v[68:71], v6 offset:32
    ds_read_b128 v[72:75], v6 offset:64
    s_waitcnt lgkmcnt(12)
    ds_read_b128 v[76:79], v6 offset:96
    v_mfma_f32_32x32x16_bf16 v[48:63], v[100:103], v[152:155], v[48:63]
    s_waitcnt lgkmcnt(12)
    ds_read_b64_tr_b16 v[100:101], v2 offset:6144
    s_waitcnt lgkmcnt(12)
    ds_read_b64_tr_b16 v[102:103], v2 offset:6656
    s_waitcnt lgkmcnt(8)
    v_add_f32 v12, v12, v11
    s_xor_b32 s87, s89, 4
    s_lshl_b32 s87, s87, 10
    v_permlane32_swap_b32 v12, v13
    v_add_f32 v12, v12, v13
    v_mov_b32 v13, v12
    s_nop 1
    v_permlane32_swap_b32 v12, v13
    v_mul_f32 v8, 0xbb000000, v12
    v_mfma_f32_32x32x16_bf16 v[48:63], v[104:107], v[156:159], v[48:63]
    ds_read_b64_tr_b16 v[104:105], v2 offset:8192
    ds_read_b64_tr_b16 v[106:107], v2 offset:8704
    v_mul_f32 v13, 0x3b000000, v13
    v_fma_f32 v13, -v8, v8, v13
    v_max_f32 v13, 0, v13
    v_add_f32 v13, 0x3727c5ac, v13
    v_rsq_f32 v12, v13
    s_nop 0
    v_mul_f32 v9, v13, v12
    v_mul_f32 v10, 0xc0135761, v12
    v_mul_f32 v13, v12, v12
    v_mfma_f32_32x32x16_bf16 v[48:63], v[108:111], v[160:163], v[48:63]
    ds_read_b64_tr_b16 v[108:109], v2 offset:10240
    ds_read_b64_tr_b16 v[110:111], v2 offset:10752
    v_mul_f32 v13, v13, v12
    v_mul_f32 v11, 0xbdd2d3e8, v13
    s_add_u32 s87, s87, 1048576
    v_mov_b32 v12, 0x7f800000
    v_cndmask_b32 v9, v12, v9, s[90:91]
    v_log_f32 v13, v9
    v_mfma_f32_32x32x16_bf16 v[48:63], v[112:115], v[164:167], v[48:63]
    ds_read_b32 v27, v24 offset:1152
    s_waitcnt lgkmcnt(12)
    ds_read_b64_tr_b16 v[112:113], v2 offset:12288
    s_waitcnt lgkmcnt(12)
    ds_read_b64_tr_b16 v[114:115], v2 offset:12800
    v_mfma_f32_32x32x16_bf16 v[48:63], v[96:99], v[168:171], v[48:63]
    s_waitcnt lgkmcnt(12)
    ds_read_b64_tr_b16 v[96:97], v2 offset:14336
    s_waitcnt lgkmcnt(12)
    ds_read_b64_tr_b16 v[98:99], v2 offset:14848
    s_waitcnt lgkmcnt(9)
    s_waitcnt lgkmcnt(4)
    v_cmp_gt_u32 vcc, 12, v27
    v_mfma_f32_32x32x16_bf16 v[48:63], v[100:103], v[172:175], v[48:63]
    s_cbranch_vccnz Lst42
Lbk43:
    ds_read_b64_tr_b16 v[100:101], v2 offset:16384
    ds_read_b64_tr_b16 v[102:103], v2 offset:16896
    v_mfma_f32_32x32x16_bf16 v[48:63], v[104:107], v[176:179], v[48:63]
    ds_read_b64_tr_b16 v[104:105], v2 offset:18432
    ds_read_b64_tr_b16 v[106:107], v2 offset:18944
    v_pk_fma_f32 v[32:33], v[64:65], v[8:9], v[32:33] op_sel_hi:[1,0,1]
    v_pk_fma_f32 v[34:35], v[66:67], v[8:9], v[34:35] op_sel_hi:[1,0,1]
    v_pk_fma_f32 v[36:37], v[68:69], v[8:9], v[36:37] op_sel_hi:[1,0,1]
    v_pk_fma_f32 v[38:39], v[70:71], v[8:9], v[38:39] op_sel_hi:[1,0,1]
    v_pk_fma_f32 v[40:41], v[72:73], v[8:9], v[40:41] op_sel_hi:[1,0,1]
    v_pk_fma_f32 v[42:43], v[74:75], v[8:9], v[42:43] op_sel_hi:[1,0,1]
    v_pk_fma_f32 v[44:45], v[76:77], v[8:9], v[44:45] op_sel_hi:[1,0,1]
    v_pk_fma_f32 v[46:47], v[78:79], v[8:9], v[46:47] op_sel_hi:[1,0,1]
    v_pk_mul_f32 v[64:65], v[32:33], v[32:33]
    v_pk_mul_f32 v[66:67], v[34:35], v[34:35]
    v_pk_mul_f32 v[68:69], v[36:37], v[36:37]
    v_pk_mul_f32 v[70:71], v[38:39], v[38:39]
    v_pk_mul_f32 v[72:73], v[40:41], v[40:41]
    v_pk_mul_f32 v[74:75], v[42:43], v[42:43]
    v_pk_mul_f32 v[76:77], v[44:45], v[44:45]
    v_pk_mul_f32 v[78:79], v[46:47], v[46:47]
    v_pk_fma_f32 v[64:65], v[64:65], v[10:11], v[10:11] op_sel:[0,1,0] op_sel_hi:[1,1,0]
    v_pk_fma_f32 v[66:67], v[66:67], v[10:11], v[10:11] op_sel:[0,1,0] op_sel_hi:[1,1,0]
    v_pk_fma_f32 v[68:69], v[68:69], v[10:11], v[10:11] op_sel:[0,1,0] op_sel_hi:[1,1,0]
    v_pk_fma_f32 v[70:71], v[70:71], v[10:11], v[10:11] op_sel:[0,1,0] op_sel_hi:[1,1,0]
    v_pk_fma_f32 v[72:73], v[72:73], v[10:11], v[10:11] op_sel:[0,1,0] op_sel_hi:[1,1,0]
    v_pk_fma_f32 v[74:75], v[74:75], v[10:11], v[10:11] op_sel:[0,1,0] op_sel_hi:[1,1,0]
    v_pk_fma_f32 v[76:77], v[76:77], v[10:11], v[10:11] op_sel:[0,1,0] op_sel_hi:[1,1,0]
    v_pk_fma_f32 v[78:79], v[78:79], v[10:11], v[10:11] op_sel:[0,1,0] op_sel_hi:[1,1,0]
    v_pk_fma_f32 v[64:65], v[64:65], v[32:33], v[12:13] op_sel:[0,0,1] op_sel_hi:[1,1,1]
    v_pk_fma_f32 v[66:67], v[66:67], v[34:35], v[12:13] op_sel:[0,0,1] op_sel_hi:[1,1,1]
    v_pk_fma_f32 v[68:69], v[68:69], v[36:37], v[12:13] op_sel:[0,0,1] op_sel_hi:[1,1,1]
    v_pk_fma_f32 v[70:71], v[70:71], v[38:39], v[12:13] op_sel:[0,0,1] op_sel_hi:[1,1,1]
    v_pk_fma_f32 v[72:73], v[72:73], v[40:41], v[12:13] op_sel:[0,0,1] op_sel_hi:[1,1,1]
    v_pk_fma_f32 v[74:75], v[74:75], v[42:43], v[12:13] op_sel:[0,0,1] op_sel_hi:[1,1,1]
    v_pk_fma_f32 v[76:77], v[76:77], v[44:45], v[12:13] op_sel:[0,0,1] op_sel_hi:[1,1,1]
    v_pk_fma_f32 v[78:79], v[78:79], v[46:47], v[12:13] op_sel:[0,0,1] op_sel_hi:[1,1,1]
    v_mfma_f32_32x32x16_bf16 v[48:63], v[108:111], v[180:183], v[48:63]
    ds_read_b64_tr_b16 v[108:109], v2 offset:20480
    ds_read_b64_tr_b16 v[110:111], v2 offset:20992
    s_waitcnt lgkmcnt(8)
    v_exp_f32 v64, v64
    v_exp_f32 v65, v65
    v_exp_f32 v66, v66
    v_mfma_f32_32x32x16_bf16 v[48:63], v[112:115], v[184:187], v[48:63]
    ds_read_b64_tr_b16 v[112:113], v2 offset:22528
    ds_read_b64_tr_b16 v[114:115], v2 offset:23040
    s_waitcnt lgkmcnt(8)
    v_exp_f32 v67, v67
    v_add_f32 v64, v9, v64
    v_add_f32 v65, v9, v65
    v_add_f32 v66, v9, v66
    v_mfma_f32_32x32x16_bf16 v[48:63], v[96:99], v[188:191], v[48:63]
    ds_read_b64_tr_b16 v[96:97], v2 offset:24576
    ds_read_b64_tr_b16 v[98:99], v2 offset:25088
    s_waitcnt lgkmcnt(8)
    v_rcp_f32 v64, v64
    v_exp_f32 v68, v68
    v_rcp_f32 v65, v65
    v_add_f32 v67, v9, v67
    v_mfma_f32_32x32x16_bf16 v[48:63], v[100:103], v[192:195], v[48:63]
    ds_read_b64_tr_b16 v[100:101], v2 offset:26624
    ds_read_b64_tr_b16 v[102:103], v2 offset:27136
    s_waitcnt lgkmcnt(8)
    v_exp_f32 v69, v69
    v_rcp_f32 v66, v66
    v_exp_f32 v70, v70
    v_add_f32 v68, v9, v68
    v_mfma_f32_32x32x16_bf16 v[48:63], v[104:107], v[196:199], v[48:63]
    ds_read_b64_tr_b16 v[104:105], v2 offset:28672
    ds_read_b64_tr_b16 v[106:107], v2 offset:29184
    s_waitcnt lgkmcnt(8)
    v_rcp_f32 v67, v67
    v_add_f32 v69, v9, v69
    v_add_f32 v70, v9, v70
    v_mul_f32 v32, v32, v64
    v_mul_f32 v33, v33, v65
    v_mul_f32 v34, v34, v66
    v_mfma_f32_32x32x16_bf16 v[48:63], v[108:111], v[200:203], v[48:63]
    ds_read_b64_tr_b16 v[108:109], v2 offset:30720
    ds_read_b64_tr_b16 v[110:111], v2 offset:31232
    s_waitcnt lgkmcnt(8)
    v_exp_f32 v71, v71
    v_rcp_f32 v68, v68
    v_exp_f32 v72, v72
    v_cvt_pk_bf16_f32 v116, v32, v33
    v_mfma_f32_32x32x16_bf16 v[48:63], v[112:115], v[204:207], v[48:63]
    ds_read_b64_tr_b16 v[112:113], v2 offset:32768
    ds_read_b64_tr_b16 v[114:115], v2 offset:33280
    s_waitcnt lgkmcnt(8)
    v_rcp_f32 v69, v69
    v_exp_f32 v73, v73
    v_add_f32 v71, v9, v71
    v_add_f32 v72, v9, v72
    v_mul_f32 v35, v35, v67
    v_mfma_f32_32x32x16_bf16 v[48:63], v[96:99], v[208:211], v[48:63]
    ds_read_b64_tr_b16 v[96:97], v2 offset:34816
    ds_read_b64_tr_b16 v[98:99], v2 offset:35328
    s_waitcnt lgkmcnt(8)
    v_rcp_f32 v70, v70
    v_exp_f32 v74, v74
    v_add_f32 v73, v9, v73
    v_cvt_pk_bf16_f32 v117, v34, v35
    v_mul_f32 v36, v36, v68
    v_mfma_f32_32x32x16_bf16 v[48:63], v[100:103], v[212:215], v[48:63]
    ds_read_b64_tr_b16 v[100:101], v2 offset:36864
    ds_read_b64_tr_b16 v[102:103], v2 offset:37376
    s_waitcnt lgkmcnt(8)
    v_rcp_f32 v71, v71
    v_exp_f32 v75, v75
    v_rcp_f32 v72, v72
    v_add_f32 v74, v9, v74
    v_mfma_f32_32x32x16_bf16 v[48:63], v[104:107], v[216:219], v[48:63]
    ds_read_b64_tr_b16 v[104:105], v2 offset:38912
    ds_read_b64_tr_b16 v[106:107], v2 offset:39424
    s_waitcnt lgkmcnt(8)
    v_exp_f32 v76, v76
    v_add_f32 v75, v9, v75
    v_mul_f32 v37, v37, v69
    v_mul_f32 v38, v38, v70
    v_mul_f32 v39, v39, v71
    v_mul_f32 v40, v40, v72
    v_mfma_f32_32x32x16_bf16 v[48:63], v[108:111], v[220:223], v[48:63]
    ds_read_b64_tr_b16 v[108:109], v2 offset:40960
    ds_read_b64_tr_b16 v[110:111], v2 offset:41472
    s_waitcnt lgkmcnt(8)
    v_rcp_f32 v73, v73
    v_exp_f32 v77, v77
    v_rcp_f32 v74, v74
    v_add_f32 v76, v9, v76
    v_mfma_f32_32x32x16_bf16 v[48:63], v[112:115], v[224:227], v[48:63]
    ds_read_b64_tr_b16 v[112:113], v2 offset:43008
    ds_read_b64_tr_b16 v[114:115], v2 offset:43520
    s_waitcnt lgkmcnt(8)
    v_exp_f32 v78, v78
    v_add_f32 v77, v9, v77
    v_cvt_pk_bf16_f32 v118, v36, v37
    v_cvt_pk_bf16_f32 v119, v38, v39
    v_mul_f32 v41, v41, v73
    v_mul_f32 v42, v42, v74
    v_mfma_f32_32x32x16_bf16 v[48:63], v[96:99], v[228:231], v[48:63]
    ds_read_b32 v27, v24 offset:1152
    ds_read_b64_tr_b16 v[96:97], v2 offset:45056
    ds_read_b64_tr_b16 v[98:99], v2 offset:45568
    s_waitcnt lgkmcnt(9)
    buffer_store_dwordx4 v[116:119], v124, s[72:75], s87 offen offset:0 sc1
    v_rcp_f32 v75, v75
    v_mfma_f32_32x32x16_bf16 v[48:63], v[100:103], v[232:235], v[48:63]
    ds_read_b64_tr_b16 v[100:101], v2 offset:47104
    ds_read_b64_tr_b16 v[102:103], v2 offset:47616
    ds_add_u32 v25, v26
    s_waitcnt lgkmcnt(10)
    v_exp_f32 v79, v79
    v_add_f32 v78, v9, v78
    s_waitcnt lgkmcnt(5)
    v_cmp_gt_u32 vcc, 14, v27
    v_mfma_f32_32x32x16_bf16 v[48:63], v[104:107], v[236:239], v[48:63]
    s_cbranch_vccnz Lst44
Lbk45:
    ds_read_b64_tr_b16 v[104:105], v2 offset:49152
    ds_read_b64_tr_b16 v[106:107], v2 offset:49664
    v_rcp_f32 v76, v76
    v_add_f32 v79, v9, v79
    v_mfma_f32_32x32x16_bf16 v[48:63], v[108:111], v[240:243], v[48:63]
    ds_read_b64_tr_b16 v[108:109], v2 offset:51200
    ds_read_b64_tr_b16 v[110:111], v2 offset:51712
    v_rcp_f32 v77, v77
    v_rcp_f32 v78, v78
    v_rcp_f32 v79, v79
    v_cvt_pk_bf16_f32 v120, v40, v41
    v_mfma_f32_32x32x16_bf16 v[48:63], v[112:115], v[244:247], v[48:63]
    ds_read_b64_tr_b16 v[112:113], v2 offset:53248
    ds_read_b64_tr_b16 v[114:115], v2 offset:53760
    s_waitcnt lgkmcnt(9)
    v_mul_f32 v43, v43, v75
    v_mul_f32 v44, v44, v76
    v_mul_f32 v45, v45, v77
    v_mul_f32 v46, v46, v78
    v_mul_f32 v47, v47, v79
    v_mfma_f32_32x32x16_bf16 v[48:63], v[96:99], v[248:251], v[48:63]
    ds_read_b64_tr_b16 v[96:97], v2 offset:55296
    ds_read_b64_tr_b16 v[98:99], v2 offset:55808
    s_waitcnt lgkmcnt(9)
    v_cvt_pk_bf16_f32 v121, v42, v43
    v_cvt_pk_bf16_f32 v122, v44, v45
    v_cvt_pk_bf16_f32 v123, v46, v47
    v_mfma_f32_32x32x16_bf16 v[48:63], v[100:103], v[252:255], v[48:63]
    ds_read_b64_tr_b16 v[100:101], v2 offset:57344
    ds_read_b64_tr_b16 v[102:103], v2 offset:57856
    s_waitcnt lgkmcnt(8)
    buffer_store_dwordx4 v[120:123], v124, s[72:75], s87 offen offset:1024 sc1
    v_mfma_f32_32x32x16_bf16 v[80:95], v[104:107], v[128:131], 0
    ds_read_b64_tr_b16 v[104:105], v2 offset:59392
    ds_read_b64_tr_b16 v[106:107], v2 offset:59904
    s_waitcnt lgkmcnt(8)
    v_mfma_f32_32x32x16_bf16 v[80:95], v[108:111], v[132:135], v[80:95]
    ds_read_b64_tr_b16 v[108:109], v2 offset:61440
    ds_read_b64_tr_b16 v[110:111], v2 offset:61952
    s_waitcnt lgkmcnt(8)
    v_mfma_f32_32x32x16_bf16 v[80:95], v[112:115], v[136:139], v[80:95]
    ds_read_b64_tr_b16 v[112:113], v2 offset:63488
    ds_read_b64_tr_b16 v[114:115], v2 offset:64000
    s_waitcnt lgkmcnt(8)
    v_mul_f32 v48, 0x3eb8aa3b, v48
    v_mul_f32 v49, 0x3eb8aa3b, v49
    v_mul_f32 v50, 0x3eb8aa3b, v50
    v_mfma_f32_32x32x16_bf16 v[80:95], v[96:99], v[140:143], v[80:95]
    ds_read_b64_tr_b16 v[96:97], v3 offset:0
    ds_read_b64_tr_b16 v[98:99], v3 offset:512
    s_waitcnt lgkmcnt(8)
    v_mul_f32 v51, 0x3eb8aa3b, v51
    v_mul_f32 v52, 0x3eb8aa3b, v52
    v_mul_f32 v53, 0x3eb8aa3b, v53
    v_mfma_f32_32x32x16_bf16 v[80:95], v[100:103], v[144:147], v[80:95]
    ds_read_b64_tr_b16 v[100:101], v3 offset:2048
    ds_read_b64_tr_b16 v[102:103], v3 offset:2560
    s_waitcnt lgkmcnt(8)
    v_mul_f32 v54, 0x3eb8aa3b, v54
    v_mul_f32 v55, 0x3eb8aa3b, v55
    v_mul_f32 v56, 0x3eb8aa3b, v56
    v_mfma_f32_32x32x16_bf16 v[80:95], v[104:107], v[148:151], v[80:95]
    ds_read_b64_tr_b16 v[104:105], v3 offset:4096
    ds_read_b64_tr_b16 v[106:107], v3 offset:4608
    s_waitcnt lgkmcnt(8)
    v_mul_f32 v57, 0x3eb8aa3b, v57
    v_mul_f32 v58, 0x3eb8aa3b, v58
    v_mul_f32 v59, 0x3eb8aa3b, v59
    v_mfma_f32_32x32x16_bf16 v[80:95], v[108:111], v[152:155], v[80:95]
    ds_read_b64_tr_b16 v[108:109], v3 offset:6144
    ds_read_b64_tr_b16 v[110:111], v3 offset:6656
    s_waitcnt lgkmcnt(8)
    v_mul_f32 v60, 0x3eb8aa3b, v60
    v_mul_f32 v61, 0x3eb8aa3b, v61
    v_mul_f32 v62, 0x3eb8aa3b, v62
    v_mfma_f32_32x32x16_bf16 v[80:95], v[112:115], v[156:159], v[80:95]
    ds_read_b64_tr_b16 v[112:113], v3 offset:8192
    ds_read_b64_tr_b16 v[114:115], v3 offset:8704
    s_waitcnt lgkmcnt(8)
    v_mul_f32 v63, 0x3eb8aa3b, v63
    s_xor_b32 s87, s96, 1048576
    s_add_u32 s87, s87, 7340032
    v_mfma_f32_32x32x16_bf16 v[80:95], v[96:99], v[160:163], v[80:95]
    ds_read_b64_tr_b16 v[96:97], v3 offset:10240
    ds_read_b64_tr_b16 v[98:99], v3 offset:10752
    s_waitcnt lgkmcnt(8)
    s_add_u32 s88, s87, 65536
    v_cvt_pk_bf16_f32 v116, v48, v49
    v_cvt_pk_bf16_f32 v117, v50, v51
    v_mfma_f32_32x32x16_bf16 v[80:95], v[100:103], v[164:167], v[80:95]
    ds_read_b32 v27, v24 offset:1152
    ds_read_b64_tr_b16 v[100:101], v3 offset:12288
    ds_read_b64_tr_b16 v[102:103], v3 offset:12800
    s_waitcnt lgkmcnt(9)
    v_cvt_pk_bf16_f32 v118, v52, v53
    v_mfma_f32_32x32x16_bf16 v[80:95], v[104:107], v[168:171], v[80:95]
    ds_read_b64_tr_b16 v[104:105], v3 offset:14336
    ds_read_b64_tr_b16 v[106:107], v3 offset:14848
    s_waitcnt lgkmcnt(9)
    v_cvt_pk_bf16_f32 v119, v54, v55
    s_waitcnt lgkmcnt(4)
    v_cmp_gt_u32 vcc, 16, v27
    v_mfma_f32_32x32x16_bf16 v[80:95], v[108:111], v[172:175], v[80:95]
    s_cbranch_vccnz Lst46
Lbk47:
    ds_read_b64_tr_b16 v[108:109], v3 offset:16384
    ds_read_b64_tr_b16 v[110:111], v3 offset:16896
    v_mfma_f32_32x32x16_bf16 v[80:95], v[112:115], v[176:179], v[80:95]
    ds_read_b64_tr_b16 v[112:113], v3 offset:18432
    ds_read_b64_tr_b16 v[114:115], v3 offset:18944
    buffer_store_dwordx4 v[116:119], v1, s[72:75], s87 offen sc1
    v_mfma_f32_32x32x16_bf16 v[80:95], v[96:99], v[180:183], v[80:95]
    ds_read_b64_tr_b16 v[96:97], v3 offset:20480
    ds_read_b64_tr_b16 v[98:99], v3 offset:20992
    s_waitcnt lgkmcnt(8)
    v_cvt_pk_bf16_f32 v120, v56, v57
    v_cvt_pk_bf16_f32 v121, v58, v59
    v_cvt_pk_bf16_f32 v122, v60, v61
    v_mfma_f32_32x32x16_bf16 v[80:95], v[100:103], v[184:187], v[80:95]
    ds_read_b64_tr_b16 v[100:101], v3 offset:22528
    ds_read_b64_tr_b16 v[102:103], v3 offset:23040
    s_waitcnt lgkmcnt(8)
    s_waitcnt vmcnt(1)
    ds_add_u32 v25, v26
    v_cvt_pk_bf16_f32 v123, v62, v63
    v_mfma_f32_32x32x16_bf16 v[80:95], v[104:107], v[188:191], v[80:95]
    ds_read_b64_tr_b16 v[104:105], v3 offset:24576
    ds_read_b64_tr_b16 v[106:107], v3 offset:25088
    s_waitcnt lgkmcnt(9)
    buffer_store_dwordx4 v[120:123], v1, s[72:75], s88 offen sc1
    v_mfma_f32_32x32x16_bf16 v[80:95], v[108:111], v[192:195], v[80:95]
    ds_read_b64_tr_b16 v[108:109], v3 offset:26624
    ds_read_b64_tr_b16 v[110:111], v3 offset:27136
    s_waitcnt lgkmcnt(9)
    v_mfma_f32_32x32x16_bf16 v[80:95], v[112:115], v[196:199], v[80:95]
    ds_read_b64_tr_b16 v[112:113], v3 offset:28672
    ds_read_b64_tr_b16 v[114:115], v3 offset:29184
    s_waitcnt lgkmcnt(9)
    v_mfma_f32_32x32x16_bf16 v[80:95], v[96:99], v[200:203], v[80:95]
    ds_read_b64_tr_b16 v[96:97], v3 offset:30720
    ds_read_b64_tr_b16 v[98:99], v3 offset:31232
    s_waitcnt lgkmcnt(9)
    v_mfma_f32_32x32x16_bf16 v[80:95], v[100:103], v[204:207], v[80:95]
    ds_read_b64_tr_b16 v[100:101], v3 offset:32768
    ds_read_b64_tr_b16 v[102:103], v3 offset:33280
    s_waitcnt lgkmcnt(8)
    v_mfma_f32_32x32x16_bf16 v[80:95], v[104:107], v[208:211], v[80:95]
    ds_read_b64_tr_b16 v[104:105], v3 offset:34816
    ds_read_b64_tr_b16 v[106:107], v3 offset:35328
    s_waitcnt lgkmcnt(8)
    v_mfma_f32_32x32x16_bf16 v[80:95], v[108:111], v[212:215], v[80:95]
    ds_read_b64_tr_b16 v[108:109], v3 offset:36864
    ds_read_b64_tr_b16 v[110:111], v3 offset:37376
    s_waitcnt lgkmcnt(8)
    v_mfma_f32_32x32x16_bf16 v[80:95], v[112:115], v[216:219], v[80:95]
    ds_read_b64_tr_b16 v[112:113], v3 offset:38912
    ds_read_b64_tr_b16 v[114:115], v3 offset:39424
    s_waitcnt lgkmcnt(8)
    v_mfma_f32_32x32x16_bf16 v[80:95], v[96:99], v[220:223], v[80:95]
    ds_read_b64_tr_b16 v[96:97], v3 offset:40960
    ds_read_b64_tr_b16 v[98:99], v3 offset:41472
    s_waitcnt lgkmcnt(8)
    v_mfma_f32_32x32x16_bf16 v[80:95], v[100:103], v[224:227], v[80:95]
    ds_read_b64_tr_b16 v[100:101], v3 offset:43008
    ds_read_b64_tr_b16 v[102:103], v3 offset:43520
    s_waitcnt lgkmcnt(8)
    v_mfma_f32_32x32x16_bf16 v[80:95], v[104:107], v[228:231], v[80:95]
    ds_read_b32 v27, v24 offset:1152
    ds_read_b64_tr_b16 v[104:105], v3 offset:45056
    ds_read_b64_tr_b16 v[106:107], v3 offset:45568
    s_waitcnt lgkmcnt(9)
    v_mfma_f32_32x32x16_bf16 v[80:95], v[108:111], v[232:235], v[80:95]
    ds_read_b64_tr_b16 v[108:109], v3 offset:47104
    ds_read_b64_tr_b16 v[110:111], v3 offset:47616
    ds_add_u32 v25, v26
    s_waitcnt lgkmcnt(10)
    s_waitcnt lgkmcnt(5)
    v_cmp_gt_u32 vcc, 18, v27
    v_mfma_f32_32x32x16_bf16 v[80:95], v[112:115], v[236:239], v[80:95]
    s_cbranch_vccnz Lst48
Lbk49:
    ds_read_b64_tr_b16 v[112:113], v3 offset:49152
    ds_read_b64_tr_b16 v[114:115], v3 offset:49664
    v_mfma_f32_32x32x16_bf16 v[80:95], v[96:99], v[240:243], v[80:95]
    ds_read_b64_tr_b16 v[96:97], v3 offset:51200
    ds_read_b64_tr_b16 v[98:99], v3 offset:51712
    v_mfma_f32_32x32x16_bf16 v[80:95], v[100:103], v[244:247], v[80:95]
    ds_read_b64_tr_b16 v[100:101], v3 offset:53248
    ds_read_b64_tr_b16 v[102:103], v3 offset:53760
    s_waitcnt lgkmcnt(9)
    v_mfma_f32_32x32x16_bf16 v[80:95], v[104:107], v[248:251], v[80:95]
    ds_read_b64_tr_b16 v[104:105], v3 offset:55296
    ds_read_b64_tr_b16 v[106:107], v3 offset:55808
    s_waitcnt lgkmcnt(9)
    v_mfma_f32_32x32x16_bf16 v[80:95], v[108:111], v[252:255], v[80:95]
    ds_read_b64_tr_b16 v[108:109], v3 offset:57344
    ds_read_b64_tr_b16 v[110:111], v3 offset:57856
    s_waitcnt lgkmcnt(8)
    v_mfma_f32_32x32x16_bf16 v[48:63], v[128:131], v[112:115], 0
    ds_read_b64_tr_b16 v[112:113], v3 offset:59392
    ds_read_b64_tr_b16 v[114:115], v3 offset:59904
    s_waitcnt lgkmcnt(8)
    v_mfma_f32_32x32x16_bf16 v[48:63], v[132:135], v[96:99], v[48:63]
    ds_read_b64_tr_b16 v[96:97], v3 offset:61440
    ds_read_b64_tr_b16 v[98:99], v3 offset:61952
    s_waitcnt lgkmcnt(8)
    v_mfma_f32_32x32x16_bf16 v[48:63], v[136:139], v[100:103], v[48:63]
    ds_read_b64_tr_b16 v[100:101], v3 offset:63488
    ds_read_b64_tr_b16 v[102:103], v3 offset:64000
    s_waitcnt lgkmcnt(8)
    s_xor_b32 s87, s96, 524288
    s_add_u32 s87, s87, 9437184
    s_add_u32 s88, s87, 65536
    v_mfma_f32_32x32x16_bf16 v[48:63], v[140:143], v[104:107], v[48:63]
    ds_read_b64_tr_b16 v[104:105], v4 offset:0
    ds_read_b64_tr_b16 v[106:107], v4 offset:512
    s_waitcnt lgkmcnt(8)
    v_cvt_pk_bf16_f32 v116, v80, v81
    v_cvt_pk_bf16_f32 v117, v82, v83
    v_cvt_pk_bf16_f32 v118, v84, v85
    v_mfma_f32_32x32x16_bf16 v[48:63], v[144:147], v[108:111], v[48:63]
    ds_read_b64_tr_b16 v[108:109], v4 offset:2048
    ds_read_b64_tr_b16 v[110:111], v4 offset:2560
    s_waitcnt lgkmcnt(8)
    v_cvt_pk_bf16_f32 v119, v86, v87
    v_mfma_f32_32x32x16_bf16 v[48:63], v[148:151], v[112:115], v[48:63]
    ds_read_b64_tr_b16 v[112:113], v4 offset:4096
    ds_read_b64_tr_b16 v[114:115], v4 offset:4608
    s_waitcnt lgkmcnt(8)
    buffer_store_dwordx4 v[116:119], v1, s[72:75], s87 offen sc1
    v_mfma_f32_32x32x16_bf16 v[48:63], v[152:155], v[96:99], v[48:63]
    ds_read_b64_tr_b16 v[96:97], v4 offset:6144
    ds_read_b64_tr_b16 v[98:99], v4 offset:6656
    s_waitcnt lgkmcnt(8)
    v_cvt_pk_bf16_f32 v120, v88, v89
    v_cvt_pk_bf16_f32 v121, v90, v91
    v_cvt_pk_bf16_f32 v122, v92, v93
    v_mfma_f32_32x32x16_bf16 v[48:63], v[156:159], v[100:103], v[48:63]
    ds_read_b64_tr_b16 v[100:101], v4 offset:8192
    ds_read_b64_tr_b16 v[102:103], v4 offset:8704
    s_waitcnt lgkmcnt(8)
    v_cvt_pk_bf16_f32 v123, v94, v95
    v_mfma_f32_32x32x16_bf16 v[48:63], v[160:163], v[104:107], v[48:63]
    ds_read_b64_tr_b16 v[104:105], v4 offset:10240
    ds_read_b64_tr_b16 v[106:107], v4 offset:10752
    s_waitcnt lgkmcnt(8)
    buffer_store_dwordx4 v[120:123], v1, s[72:75], s88 offen sc1
    v_mfma_f32_32x32x16_bf16 v[48:63], v[164:167], v[108:111], v[48:63]
    ds_read_b32 v27, v24 offset:1152
    ds_read_b64_tr_b16 v[108:109], v4 offset:12288
    ds_read_b64_tr_b16 v[110:111], v4 offset:12800
    s_waitcnt lgkmcnt(9)
    v_mfma_f32_32x32x16_bf16 v[48:63], v[168:171], v[112:115], v[48:63]
    ds_read_b64_tr_b16 v[112:113], v4 offset:14336
    ds_read_b64_tr_b16 v[114:115], v4 offset:14848
    s_waitcnt lgkmcnt(9)
    s_waitcnt lgkmcnt(4)
    v_cmp_gt_u32 vcc, 19, v27
    v_mfma_f32_32x32x16_bf16 v[48:63], v[172:175], v[96:99], v[48:63]
    s_cbranch_vccnz Lst50
Lbk51:
    ds_read_b64_tr_b16 v[96:97], v2 offset:0
    ds_read_b64_tr_b16 v[98:99], v2 offset:512
    v_mfma_f32_32x32x16_bf16 v[48:63], v[176:179], v[100:103], v[48:63]
    ds_read_b64_tr_b16 v[100:101], v2 offset:2048
    ds_read_b64_tr_b16 v[102:103], v2 offset:2560
    ds_read_b64 v[16:17], v127
    v_xor_b32 v127, 16, v127
    v_mfma_f32_32x32x16_bf16 v[48:63], v[180:183], v[104:107], v[48:63]
    ds_read_b64_tr_b16 v[104:105], v2 offset:4096
    ds_read_b64_tr_b16 v[106:107], v2 offset:4608
    s_waitcnt lgkmcnt(9)
    ds_read_b64 v[18:19], v127
    v_xor_b32 v127, 80, v127
    v_mfma_f32_32x32x16_bf16 v[48:63], v[184:187], v[108:111], v[48:63]
    ds_read_b64_tr_b16 v[108:109], v2 offset:6144
    ds_read_b64_tr_b16 v[110:111], v2 offset:6656
    s_waitcnt lgkmcnt(10)
    ds_read_b64 v[20:21], v127
    v_xor_b32 v127, 16, v127
    v_mfma_f32_32x32x16_bf16 v[48:63], v[188:191], v[112:115], v[48:63]
    ds_read_b64_tr_b16 v[112:113], v2 offset:8192
    ds_read_b64_tr_b16 v[114:115], v2 offset:8704
    s_waitcnt lgkmcnt(11)
    ds_read_b64 v[22:23], v127
    v_mfma_f32_32x32x16_bf16 v[48:63], v[192:195], v[96:99], v[48:63]
    ds_read_b64_tr_b16 v[96:97], v2 offset:10240
    s_waitcnt lgkmcnt(12)
    ds_read_b64_tr_b16 v[98:99], v2 offset:10752
    s_waitcnt lgkmcnt(12)
    v_mfma_f32_32x32x16_bf16 v[48:63], v[196:199], v[100:103], v[48:63]
    ds_read_b32 v27, v24 offset:1152
    s_waitcnt lgkmcnt(12)
    ds_read_b64_tr_b16 v[100:101], v2 offset:12288
    s_waitcnt lgkmcnt(12)
    ds_read_b64_tr_b16 v[102:103], v2 offset:12800
    s_waitcnt lgkmcnt(12)
    v_mfma_f32_32x32x16_bf16 v[48:63], v[200:203], v[104:107], v[48:63]
    ds_read_b64_tr_b16 v[104:105], v2 offset:14336
    s_waitcnt lgkmcnt(12)
    ds_read_b64_tr_b16 v[106:107], v2 offset:14848
    s_waitcnt lgkmcnt(11)
    s_waitcnt lgkmcnt(4)
    v_cmp_gt_u32 vcc, 20, v27
    v_mfma_f32_32x32x16_bf16 v[48:63], v[204:207], v[108:111], v[48:63]
    s_cbranch_vccnz Lst52
Lbk53:
    ds_read_b64_tr_b16 v[108:109], v2 offset:16384
    ds_read_b64_tr_b16 v[110:111], v2 offset:16896
    v_mfma_f32_32x32x16_bf16 v[48:63], v[208:211], v[112:115], v[48:63]
    ds_read_b64_tr_b16 v[112:113], v2 offset:18432
    ds_read_b64_tr_b16 v[114:115], v2 offset:18944
    v_mfma_f32_32x32x16_bf16 v[48:63], v[212:215], v[96:99], v[48:63]
    ds_read_b64_tr_b16 v[96:97], v2 offset:20480
    ds_read_b64_tr_b16 v[98:99], v2 offset:20992
    s_waitcnt lgkmcnt(8)
    v_mfma_f32_32x32x16_bf16 v[48:63], v[216:219], v[100:103], v[48:63]
    ds_read_b64_tr_b16 v[100:101], v2 offset:22528
    ds_read_b64_tr_b16 v[102:103], v2 offset:23040
    s_waitcnt lgkmcnt(8)
    v_mfma_f32_32x32x16_bf16 v[48:63], v[220:223], v[104:107], v[48:63]
    ds_read_b64_tr_b16 v[104:105], v2 offset:24576
    ds_read_b64_tr_b16 v[106:107], v2 offset:25088
    s_waitcnt lgkmcnt(8)
    v_mfma_f32_32x32x16_bf16 v[48:63], v[224:227], v[108:111], v[48:63]
    ds_read_b64_tr_b16 v[108:109], v2 offset:26624
    ds_read_b64_tr_b16 v[110:111], v2 offset:27136
    s_waitcnt lgkmcnt(8)
    v_mfma_f32_32x32x16_bf16 v[48:63], v[228:231], v[112:115], v[48:63]
    ds_read_b64_tr_b16 v[112:113], v2 offset:28672
    ds_read_b64_tr_b16 v[114:115], v2 offset:29184
    s_waitcnt lgkmcnt(8)
    v_mfma_f32_32x32x16_bf16 v[48:63], v[232:235], v[96:99], v[48:63]
    ds_read_b64_tr_b16 v[96:97], v2 offset:30720
    ds_read_b64_tr_b16 v[98:99], v2 offset:31232
    s_waitcnt vmcnt(0)
    ds_add_u32 v25, v26
    s_waitcnt lgkmcnt(9)
    v_mfma_f32_32x32x16_bf16 v[48:63], v[236:239], v[100:103], v[48:63]
    s_waitcnt lgkmcnt(7)
    v_mfma_f32_32x32x16_bf16 v[48:63], v[240:243], v[104:107], v[48:63]
    s_waitcnt lgkmcnt(5)
    v_mfma_f32_32x32x16_bf16 v[48:63], v[244:247], v[108:111], v[48:63]
    s_waitcnt lgkmcnt(3)
    v_mfma_f32_32x32x16_bf16 v[48:63], v[248:251], v[112:115], v[48:63]
    s_waitcnt lgkmcnt(1)
    v_mfma_f32_32x32x16_bf16 v[48:63], v[252:255], v[96:99], v[48:63]
    ds_read_b32 v27, v24 offset:1536
    v_lshrrev_b32 v9, 4, v0
    v_bfe_u32 v10, v0, 2, 2
    v_bfe_u32 v11, v0, 4, 1
    v_lshl_add_u32 v12, v15, 4, v10
    v_lshl_add_u32 v12, v11, 2, v12
    v_lshlrev_b32 v12, 7, v12
    v_bfe_u32 v13, v0, 3, 1
    v_lshl_add_u32 v12, v13, 6, v12
    v_bfe_u32 v13, v0, 1, 1
    v_lshl_add_u32 v12, v13, 5, v12
    v_lshl_add_u32 v12, v11, 4, v12
    v_and_b32 v13, 1, v0
    v_lshl_add_u32 v12, v13, 3, v12
    s_xor_b32 s87, s96, 1310720
    s_add_u32 s87, s87, 11534336
    v_cvt_pk_bf16_f32 v116, v48, v49
    v_cvt_pk_bf16_f32 v117, v50, v51
    v_cvt_pk_bf16_f32 v118, v52, v53
    v_cvt_pk_bf16_f32 v119, v54, v55
    buffer_store_dwordx4 v[116:119], v125, s[72:75], s87 offen offset:0 sc1
    v_cvt_pk_bf16_f32 v120, v56, v57
    v_cvt_pk_bf16_f32 v121, v58, v59
    v_cvt_pk_bf16_f32 v122, v60, v61
    v_cvt_pk_bf16_f32 v123, v62, v63
    buffer_store_dwordx4 v[120:123], v125, s[72:75], s87 offen offset:512 sc1
    v_add_u32 v64, 32768, v12
    v_xor_b32 v65, 16, v64
    v_xor_b32 v66, 64, v64
    v_xor_b32 v67, 80, v64
    v_and_b32 v10, 15, v0
    s_lshl_b32 s87, s84, 8
    v_lshl_add_u32 v68, v10, 4, s87
    v_lshl_add_u32 v68, v9, 9, v68
    s_lshl_b32 s86, s35, 1
    s_add_u32 s86, s86, s85
    s_lshl_b32 s97, s86, 15
    s_add_u32 s96, s97, 1048576
    s_mul_i32 s89, s35, 0
    s_waitcnt lgkmcnt(0)
    v_cmp_gt_u32 vcc, 1, v27
    s_cbranch_vccnz Lst54
Lbk55:
    s_add_u32 s88, s96, 0
    buffer_load_dwordx4 v[192:195], v68, s[72:75], s88 offen offset:0 sc1
    buffer_load_dwordx4 v[196:199], v68, s[72:75], s88 offen offset:2048 sc1
    s_add_u32 s88, s96, 4096
    buffer_load_dwordx4 v[200:203], v68, s[72:75], s88 offen offset:0 sc1
    buffer_load_dwordx4 v[204:207], v68, s[72:75], s88 offen offset:2048 sc1
    s_add_u32 s88, s96, 8192
    buffer_load_dwordx4 v[208:211], v68, s[72:75], s88 offen offset:0 sc1
    buffer_load_dwordx4 v[212:215], v68, s[72:75], s88 offen offset:2048 sc1
    s_lshl_b32 s87, s84, 7
    v_lshl_add_u32 v124, v10, 3, s87
    v_lshl_add_u32 v124, v15, 2, v124
    s_lshl_b32 s87, s34, 12
    s_add_u32 s97, s97, s87
    s_add_u32 s97, s97, 3145728
    s_lshl_b32 s81, s86, 3
    s_add_u32 s81, s81, s34
    s_lshl_b32 s81, s81, 8
    s_add_u32 s81, s81, 262144
    s_lshl_b32 s6, s99, 2
    s_add_u32 s6, s6, s3
    s_lshl_b32 s1, s6, 8
    s_add_u32 s1, s1, 40960
    s_mul_i32 s0, s6, 294912
    s_lshl_b32 s6, s100, 10
    s_add_u32 s0, s0, s6
    s_add_u32 s0, s0, 13746176
    s_lshl_b32 s39, s3, 11
    s_and_b32 s7, s2, 1
    s_lshl_b32 s6, s7, 3
    s_add_u32 s6, s6, s99
    s_lshr_b32 s100, s6, 2
    s_lshl_b32 s6, s6, 6
    s_add_u32 s83, s6, 256
    s_lshl_b32 s7, s36, 2
    s_add_u32 s7, s7, s3
    s_lshl_b32 s95, s7, 15
    s_add_u32 s80, s95, 3145728
    s_cmp_eq_u32 s38, 0
    s_cselect_b32 s82, 0x40000000, s80
    s_and_b32 s6, s36, 3
    s_mul_i32 s6, s6, 0
    s_add_u32 s82, s82, s6
    s_lshl_b32 s6, s7, 11
    s_add_u32 s90, s6, 262144
    s_lshl_b32 s6, s7, 7
    s_add_u32 s91, s6, 40960
    s_mul_i32 s6, s7, 147456
    s_add_u32 s92, s6, 13631488
    s_lshl_b32 s6, s37, 13
    s_add_u32 s93, s92, s6
    s_and_b32 s99, s99, 3
    s_lshl_b32 s7, s7, 2
    s_add_u32 s7, s7, s99
    s_mul_i32 s7, s7, 24576
    s_add_u32 s98, s7, 23068672
    s_mul_i32 s6, s100, 6144
    s_add_u32 s32, s98, s6
    s_lshl_b32 s6, s99, 2
    s_add_u32 s6, s6, s100
    s_lshl_b32 s7, s6, 6
    s_add_u32 s95, s95, s7
    s_lshl_b32 s6, s6, 11
    s_add_u32 s94, s80, s6
    s_lshr_b32 s6, s99, 1
    s_lshl_b32 s7, s36, 3
    s_add_u32 s7, s7, s6
    s_lshl_b32 s7, s7, 5
    s_and_b32 s6, s99, 1
    s_add_u32 s7, s7, s6
    s_lshl_b32 s33, s7, 2
    s_add_u32 s87, s39, 98304
    v_add_u32 v2, s87, v1
    v_lshl_add_u32 v12, v10, 4, s39
    v_lshl_add_u32 v3, v15, 8, v12
    v_add_u32 v3, 114688, v3
    v_add_u32 v12, 4, v0
    v_and_b32 v12, 8, v12
    v_lshl_add_u32 v12, v12, 3, s39
    v_add_u32 v12, 131072, v12
    s_mov_b32 vcc_lo, 0xffff0000
    s_mov_b32 vcc_hi, 0xffff0000
    v_cndmask_b32 v3, v3, v12, vcc
    v_and_b32 v30, 31, v0
    v_lshlrev_b32 v30, 2, v30
    v_mov_b32 v8, 0xffff
    v_mov_b32 v9, 0xffff0000
    v_cndmask_b32 v184, 0, v8, s[40:41]
    v_cndmask_b32 v12, 0, v9, s[42:43]
    v_or_b32 v184, v184, v12
    v_cndmask_b32 v185, 0, v8, s[44:45]
    v_cndmask_b32 v12, 0, v9, s[46:47]
    v_or_b32 v185, v185, v12
    v_cndmask_b32 v186, 0, v8, s[48:49]
    v_cndmask_b32 v12, 0, v9, s[50:51]
    v_or_b32 v186, v186, v12
    v_cndmask_b32 v187, 0, v8, s[52:53]
    v_cndmask_b32 v12, 0, v9, s[54:55]
    v_or_b32 v187, v187, v12
    v_cndmask_b32 v188, 0, v8, s[56:57]
    v_cndmask_b32 v12, 0, v9, s[58:59]
    v_or_b32 v188, v188, v12
    v_cndmask_b32 v189, 0, v8, s[60:61]
    v_cndmask_b32 v12, 0, v9, s[62:63]
    v_or_b32 v189, v189, v12
    v_cndmask_b32 v190, 0, v8, s[64:65]
    v_cndmask_b32 v12, 0, v9, s[66:67]
    v_or_b32 v190, v190, v12
    v_cndmask_b32 v191, 0, v8, s[68:69]
    v_cndmask_b32 v12, 0, v9, s[70:71]
    v_or_b32 v191, v191, v12
    s_mov_b32 s6, 0xffff
    s_mov_b32 s7, 0xffff
    v_lshlrev_b32 v32, 16, v16
    v_and_b32 v33, 0xffff0000, v16
    v_lshlrev_b32 v34, 16, v17
    v_and_b32 v35, 0xffff0000, v17
    v_lshlrev_b32 v36, 16, v18
    v_and_b32 v37, 0xffff0000, v18
    v_lshlrev_b32 v38, 16, v19
    v_and_b32 v39, 0xffff0000, v19
    v_lshlrev_b32 v40, 16, v20
    v_and_b32 v41, 0xffff0000, v20
    v_lshlrev_b32 v42, 16, v21
    v_and_b32 v43, 0xffff0000, v21
    v_lshlrev_b32 v44, 16, v22
    v_and_b32 v45, 0xffff0000, v22
    v_lshlrev_b32 v46, 16, v23
    v_and_b32 v47, 0xffff0000, v23
    s_waitcnt vmcnt(6)
    ds_add_u32 v25, v26
    ds_read_b32 v31, v24 offset:1152
    s_waitcnt lgkmcnt(0)
    v_cmp_gt_u32 vcc, 22, v31
    s_cbranch_vccnz Lst56
Lbk57:
    ds_read_b64_tr_b16 v[96:97], v64 offset:0
    ds_read_b64_tr_b16 v[98:99], v64 offset:1024
    ds_read_b64_tr_b16 v[100:101], v65 offset:0
    ds_read_b64_tr_b16 v[102:103], v65 offset:1024
    ds_read_b64_tr_b16 v[104:105], v66 offset:0
    ds_read_b64_tr_b16 v[106:107], v66 offset:1024
    ds_read_b64_tr_b16 v[108:109], v67 offset:0
    ds_read_b64_tr_b16 v[110:111], v67 offset:1024
    ds_read_b64_tr_b16 v[112:113], v64 offset:4096
    ds_read_b64_tr_b16 v[114:115], v64 offset:5120
    ds_read_b64_tr_b16 v[116:117], v65 offset:4096
    ds_read_b64_tr_b16 v[118:119], v65 offset:5120
    s_waitcnt vmcnt(5) lgkmcnt(10)
    v_mfma_f32_16x16x32_bf16 v[32:35], v[96:99], v[192:195], v[32:35]
    ds_read_b64_tr_b16 v[96:97], v66 offset:4096
    ds_read_b64_tr_b16 v[98:99], v66 offset:5120
    s_waitcnt lgkmcnt(10)
    v_mfma_f32_16x16x32_bf16 v[36:39], v[100:103], v[192:195], v[36:39]
    ds_read_b64_tr_b16 v[100:101], v67 offset:4096
    ds_read_b64_tr_b16 v[102:103], v67 offset:5120
    s_add_u32 s88, s96, 12288
    buffer_load_dwordx4 v[216:219], v68, s[72:75], s88 offen offset:0 sc1
    s_waitcnt lgkmcnt(10)
    v_mfma_f32_16x16x32_bf16 v[40:43], v[104:107], v[192:195], v[40:43]
    ds_read_b64_tr_b16 v[104:105], v64 offset:8192
    ds_read_b64_tr_b16 v[106:107], v64 offset:9216
    s_waitcnt lgkmcnt(10)
    v_mfma_f32_16x16x32_bf16 v[44:47], v[108:111], v[192:195], v[44:47]
    ds_read_b64_tr_b16 v[108:109], v65 offset:8192
    ds_read_b64_tr_b16 v[110:111], v65 offset:9216
    buffer_load_dwordx4 v[220:223], v68, s[72:75], s88 offen offset:2048 sc1
    s_waitcnt vmcnt(6) lgkmcnt(10)
    v_mfma_f32_16x16x32_bf16 v[32:35], v[112:115], v[196:199], v[32:35]
    ds_read_b64_tr_b16 v[112:113], v66 offset:8192
    ds_read_b64_tr_b16 v[114:115], v66 offset:9216
    s_waitcnt lgkmcnt(10)
    v_mfma_f32_16x16x32_bf16 v[36:39], v[116:119], v[196:199], v[36:39]
    ds_read_b64_tr_b16 v[116:117], v67 offset:8192
    ds_read_b64_tr_b16 v[118:119], v67 offset:9216
    s_add_u32 s88, s96, 16384
    buffer_load_dwordx4 v[224:227], v68, s[72:75], s88 offen offset:0 sc1
    s_waitcnt lgkmcnt(10)
    v_mfma_f32_16x16x32_bf16 v[40:43], v[96:99], v[196:199], v[40:43]
    ds_read_b64_tr_b16 v[96:97], v64 offset:12288
    ds_read_b64_tr_b16 v[98:99], v64 offset:13312
    s_waitcnt lgkmcnt(10)
    v_mfma_f32_16x16x32_bf16 v[44:47], v[100:103], v[196:199], v[44:47]
    ds_read_b64_tr_b16 v[100:101], v65 offset:12288
    ds_read_b64_tr_b16 v[102:103], v65 offset:13312
    buffer_load_dwordx4 v[228:231], v68, s[72:75], s88 offen offset:2048 sc1
    s_waitcnt vmcnt(7) lgkmcnt(10)
    v_mfma_f32_16x16x32_bf16 v[32:35], v[104:107], v[200:203], v[32:35]
    ds_read_b64_tr_b16 v[104:105], v66 offset:12288
    ds_read_b64_tr_b16 v[106:107], v66 offset:13312
    s_waitcnt lgkmcnt(10)
    v_mfma_f32_16x16x32_bf16 v[36:39], v[108:111], v[200:203], v[36:39]
    ds_read_b64_tr_b16 v[108:109], v67 offset:12288
    ds_read_b64_tr_b16 v[110:111], v67 offset:13312
    s_add_u32 s88, s96, 20480
    buffer_load_dwordx4 v[232:235], v68, s[72:75], s88 offen offset:0 sc1
    s_waitcnt lgkmcnt(10)
    v_mfma_f32_16x16x32_bf16 v[40:43], v[112:115], v[200:203], v[40:43]
    ds_read_b64_tr_b16 v[112:113], v64 offset:16384
    ds_read_b64_tr_b16 v[114:115], v64 offset:17408
    s_waitcnt lgkmcnt(10)
    v_mfma_f32_16x16x32_bf16 v[44:47], v[116:119], v[200:203], v[44:47]
    ds_read_b64_tr_b16 v[116:117], v65 offset:16384
    ds_read_b64_tr_b16 v[118:119], v65 offset:17408
    buffer_load_dwordx4 v[236:239], v68, s[72:75], s88 offen offset:2048 sc1
    s_waitcnt vmcnt(8) lgkmcnt(10)
    v_mfma_f32_16x16x32_bf16 v[32:35], v[96:99], v[204:207], v[32:35]
    ds_read_b64_tr_b16 v[96:97], v66 offset:16384
    ds_read_b64_tr_b16 v[98:99], v66 offset:17408
    s_waitcnt lgkmcnt(10)
    v_mfma_f32_16x16x32_bf16 v[36:39], v[100:103], v[204:207], v[36:39]
    ds_read_b64_tr_b16 v[100:101], v67 offset:16384
    ds_read_b64_tr_b16 v[102:103], v67 offset:17408
    s_add_u32 s88, s96, 24576
    buffer_load_dwordx4 v[240:243], v68, s[72:75], s88 offen offset:0 sc1
    s_waitcnt lgkmcnt(10)
    v_mfma_f32_16x16x32_bf16 v[40:43], v[104:107], v[204:207], v[40:43]
    ds_read_b64_tr_b16 v[104:105], v64 offset:20480
    ds_read_b64_tr_b16 v[106:107], v64 offset:21504
    s_waitcnt lgkmcnt(10)
    v_mfma_f32_16x16x32_bf16 v[44:47], v[108:111], v[204:207], v[44:47]
    ds_read_b64_tr_b16 v[108:109], v65 offset:20480
    ds_read_b64_tr_b16 v[110:111], v65 offset:21504
    buffer_load_dwordx4 v[244:247], v68, s[72:75], s88 offen offset:2048 sc1
    s_waitcnt vmcnt(9) lgkmcnt(10)
    v_mfma_f32_16x16x32_bf16 v[32:35], v[112:115], v[208:211], v[32:35]
    ds_read_b64_tr_b16 v[112:113], v66 offset:20480
    ds_read_b64_tr_b16 v[114:115], v66 offset:21504
    s_waitcnt lgkmcnt(10)
    v_mfma_f32_16x16x32_bf16 v[36:39], v[116:119], v[208:211], v[36:39]
    ds_read_b64_tr_b16 v[116:117], v67 offset:20480
    ds_read_b64_tr_b16 v[118:119], v67 offset:21504
    s_add_u32 s88, s96, 28672
    buffer_load_dwordx4 v[248:251], v68, s[72:75], s88 offen offset:0 sc1
    s_waitcnt lgkmcnt(10)
    v_mfma_f32_16x16x32_bf16 v[40:43], v[96:99], v[208:211], v[40:43]
    ds_read_b64_tr_b16 v[96:97], v64 offset:24576
    ds_read_b64_tr_b16 v[98:99], v64 offset:25600
    s_waitcnt lgkmcnt(10)
    v_mfma_f32_16x16x32_bf16 v[44:47], v[100:103], v[208:211], v[44:47]
    ds_read_b64_tr_b16 v[100:101], v65 offset:24576
    ds_read_b64_tr_b16 v[102:103], v65 offset:25600
    buffer_load_dwordx4 v[252:255], v68, s[72:75], s88 offen offset:2048 sc1
    s_waitcnt vmcnt(10) lgkmcnt(10)
    v_mfma_f32_16x16x32_bf16 v[32:35], v[104:107], v[212:215], v[32:35]
    ds_read_b64_tr_b16 v[104:105], v66 offset:24576
    ds_read_b64_tr_b16 v[106:107], v66 offset:25600
    s_waitcnt lgkmcnt(10)
    v_mfma_f32_16x16x32_bf16 v[36:39], v[108:111], v[212:215], v[36:39]
    ds_read_b64_tr_b16 v[108:109], v67 offset:24576
    ds_read_b64_tr_b16 v[110:111], v67 offset:25600
    s_waitcnt lgkmcnt(10)
    v_mfma_f32_16x16x32_bf16 v[40:43], v[112:115], v[212:215], v[40:43]
    ds_read_b64_tr_b16 v[112:113], v64 offset:28672
    ds_read_b64_tr_b16 v[114:115], v64 offset:29696
    s_waitcnt lgkmcnt(10)
    v_mfma_f32_16x16x32_bf16 v[44:47], v[116:119], v[212:215], v[44:47]
    ds_read_b64_tr_b16 v[116:117], v65 offset:28672
    ds_read_b64_tr_b16 v[118:119], v65 offset:29696
    s_waitcnt vmcnt(9) lgkmcnt(10)
    v_mfma_f32_16x16x32_bf16 v[32:35], v[96:99], v[216:219], v[32:35]
    ds_read_b32 v27, v24 offset:1152
    ds_read_b64_tr_b16 v[96:97], v66 offset:28672
    ds_read_b64_tr_b16 v[98:99], v66 offset:29696
    s_waitcnt lgkmcnt(11)
    v_mfma_f32_16x16x32_bf16 v[36:39], v[100:103], v[216:219], v[36:39]
    ds_read_b64_tr_b16 v[100:101], v67 offset:28672
    ds_read_b64_tr_b16 v[102:103], v67 offset:29696
    s_waitcnt lgkmcnt(4)
    v_cmp_gt_u32 vcc, 24, v27
    v_mfma_f32_16x16x32_bf16 v[40:43], v[104:107], v[216:219], v[40:43]
    s_cbranch_vccnz Lst58
Lbk59:
    ds_read_b64_tr_b16 v[104:105], v64 offset:32768
    ds_read_b64_tr_b16 v[106:107], v64 offset:33792
    v_mfma_f32_16x16x32_bf16 v[44:47], v[108:111], v[216:219], v[44:47]
    ds_read_b64_tr_b16 v[108:109], v65 offset:32768
    ds_read_b64_tr_b16 v[110:111], v65 offset:33792
    s_waitcnt vmcnt(8)
    v_mfma_f32_16x16x32_bf16 v[32:35], v[112:115], v[220:223], v[32:35]
    ds_read_b64_tr_b16 v[112:113], v66 offset:32768
    ds_read_b64_tr_b16 v[114:115], v66 offset:33792
    v_mfma_f32_16x16x32_bf16 v[36:39], v[116:119], v[220:223], v[36:39]
    ds_read_b64_tr_b16 v[116:117], v67 offset:32768
    ds_read_b64_tr_b16 v[118:119], v67 offset:33792
    s_waitcnt lgkmcnt(10)
    v_mfma_f32_16x16x32_bf16 v[40:43], v[96:99], v[220:223], v[40:43]
    ds_read_b64_tr_b16 v[96:97], v64 offset:36864
    ds_read_b64_tr_b16 v[98:99], v64 offset:37888
    s_waitcnt lgkmcnt(10)
    v_mfma_f32_16x16x32_bf16 v[44:47], v[100:103], v[220:223], v[44:47]
    ds_read_b64_tr_b16 v[100:101], v65 offset:36864
    ds_read_b64_tr_b16 v[102:103], v65 offset:37888
    s_waitcnt vmcnt(7) lgkmcnt(10)
    v_mfma_f32_16x16x32_bf16 v[32:35], v[104:107], v[224:227], v[32:35]
    ds_read_b64_tr_b16 v[104:105], v66 offset:36864
    ds_read_b64_tr_b16 v[106:107], v66 offset:37888
    s_waitcnt lgkmcnt(10)
    v_mfma_f32_16x16x32_bf16 v[36:39], v[108:111], v[224:227], v[36:39]
    ds_read_b64_tr_b16 v[108:109], v67 offset:36864
    ds_read_b64_tr_b16 v[110:111], v67 offset:37888
    s_waitcnt lgkmcnt(10)
    v_mfma_f32_16x16x32_bf16 v[40:43], v[112:115], v[224:227], v[40:43]
    ds_read_b64_tr_b16 v[112:113], v64 offset:40960
    ds_read_b64_tr_b16 v[114:115], v64 offset:41984
    s_waitcnt lgkmcnt(10)
    v_mfma_f32_16x16x32_bf16 v[44:47], v[116:119], v[224:227], v[44:47]
    ds_read_b64_tr_b16 v[116:117], v65 offset:40960
    ds_read_b64_tr_b16 v[118:119], v65 offset:41984
    s_waitcnt vmcnt(6) lgkmcnt(10)
    v_mfma_f32_16x16x32_bf16 v[32:35], v[96:99], v[228:231], v[32:35]
    ds_read_b64_tr_b16 v[96:97], v66 offset:40960
    ds_read_b64_tr_b16 v[98:99], v66 offset:41984
    s_waitcnt lgkmcnt(10)
    v_mfma_f32_16x16x32_bf16 v[36:39], v[100:103], v[228:231], v[36:39]
    ds_read_b64_tr_b16 v[100:101], v67 offset:40960
    ds_read_b64_tr_b16 v[102:103], v67 offset:41984
    s_waitcnt lgkmcnt(10)
    v_mfma_f32_16x16x32_bf16 v[40:43], v[104:107], v[228:231], v[40:43]
    ds_read_b64_tr_b16 v[104:105], v64 offset:45056
    ds_read_b64_tr_b16 v[106:107], v64 offset:46080
    s_waitcnt lgkmcnt(10)
    v_mfma_f32_16x16x32_bf16 v[44:47], v[108:111], v[228:231], v[44:47]
    ds_read_b64_tr_b16 v[108:109], v65 offset:45056
    ds_read_b64_tr_b16 v[110:111], v65 offset:46080
    s_waitcnt vmcnt(5) lgkmcnt(10)
    v_mfma_f32_16x16x32_bf16 v[32:35], v[112:115], v[232:235], v[32:35]
    ds_read_b64_tr_b16 v[112:113], v66 offset:45056
    ds_read_b64_tr_b16 v[114:115], v66 offset:46080
    s_waitcnt lgkmcnt(10)
    v_mfma_f32_16x16x32_bf16 v[36:39], v[116:119], v[232:235], v[36:39]
    ds_read_b64_tr_b16 v[116:117], v67 offset:45056
    ds_read_b64_tr_b16 v[118:119], v67 offset:46080
    s_waitcnt lgkmcnt(10)
    v_mfma_f32_16x16x32_bf16 v[40:43], v[96:99], v[232:235], v[40:43]
    ds_read_b64_tr_b16 v[96:97], v64 offset:49152
    ds_read_b64_tr_b16 v[98:99], v64 offset:50176
    s_waitcnt lgkmcnt(10)
    v_mfma_f32_16x16x32_bf16 v[44:47], v[100:103], v[232:235], v[44:47]
    ds_read_b64_tr_b16 v[100:101], v65 offset:49152
    ds_read_b64_tr_b16 v[102:103], v65 offset:50176
    s_waitcnt vmcnt(4) lgkmcnt(10)
    v_mfma_f32_16x16x32_bf16 v[32:35], v[104:107], v[236:239], v[32:35]
    ds_read_b64_tr_b16 v[104:105], v66 offset:49152
    ds_read_b64_tr_b16 v[106:107], v66 offset:50176
    s_waitcnt lgkmcnt(10)
    v_mfma_f32_16x16x32_bf16 v[36:39], v[108:111], v[236:239], v[36:39]
    ds_read_b64_tr_b16 v[108:109], v67 offset:49152
    ds_read_b64_tr_b16 v[110:111], v67 offset:50176
    s_waitcnt lgkmcnt(10)
    v_mfma_f32_16x16x32_bf16 v[40:43], v[112:115], v[236:239], v[40:43]
    ds_read_b64_tr_b16 v[112:113], v64 offset:53248
    ds_read_b64_tr_b16 v[114:115], v64 offset:54272
    s_waitcnt lgkmcnt(10)
    v_mfma_f32_16x16x32_bf16 v[44:47], v[116:119], v[236:239], v[44:47]
    ds_read_b64_tr_b16 v[116:117], v65 offset:53248
    ds_read_b64_tr_b16 v[118:119], v65 offset:54272
    s_waitcnt vmcnt(3) lgkmcnt(10)
    v_mfma_f32_16x16x32_bf16 v[32:35], v[96:99], v[240:243], v[32:35]
    ds_read_b64_tr_b16 v[96:97], v66 offset:53248
    ds_read_b64_tr_b16 v[98:99], v66 offset:54272
    s_waitcnt lgkmcnt(10)
    v_mfma_f32_16x16x32_bf16 v[36:39], v[100:103], v[240:243], v[36:39]
    ds_read_b64_tr_b16 v[100:101], v67 offset:53248
    ds_read_b64_tr_b16 v[102:103], v67 offset:54272
    s_waitcnt lgkmcnt(10)
    v_mfma_f32_16x16x32_bf16 v[40:43], v[104:107], v[240:243], v[40:43]
    ds_read_b64_tr_b16 v[104:105], v64 offset:57344
    ds_read_b64_tr_b16 v[106:107], v64 offset:58368
    s_waitcnt lgkmcnt(10)
    v_mfma_f32_16x16x32_bf16 v[44:47], v[108:111], v[240:243], v[44:47]
    ds_read_b64_tr_b16 v[108:109], v65 offset:57344
    ds_read_b64_tr_b16 v[110:111], v65 offset:58368
    s_waitcnt vmcnt(2) lgkmcnt(10)
    v_mfma_f32_16x16x32_bf16 v[32:35], v[112:115], v[244:247], v[32:35]
    ds_read_b64_tr_b16 v[112:113], v66 offset:57344
    ds_read_b64_tr_b16 v[114:115], v66 offset:58368
    s_waitcnt lgkmcnt(10)
    v_mfma_f32_16x16x32_bf16 v[36:39], v[116:119], v[244:247], v[36:39]
    ds_read_b64_tr_b16 v[116:117], v67 offset:57344
    ds_read_b64_tr_b16 v[118:119], v67 offset:58368
    s_waitcnt lgkmcnt(10)
    v_mfma_f32_16x16x32_bf16 v[40:43], v[96:99], v[244:247], v[40:43]
    ds_read_b64_tr_b16 v[96:97], v64 offset:61440
    ds_read_b64_tr_b16 v[98:99], v64 offset:62464
    s_waitcnt lgkmcnt(10)
    v_mfma_f32_16x16x32_bf16 v[44:47], v[100:103], v[244:247], v[44:47]
    ds_read_b64_tr_b16 v[100:101], v65 offset:61440
    ds_read_b64_tr_b16 v[102:103], v65 offset:62464
    s_waitcnt vmcnt(1) lgkmcnt(10)
    v_mfma_f32_16x16x32_bf16 v[32:35], v[104:107], v[248:251], v[32:35]
    ds_read_b64_tr_b16 v[104:105], v66 offset:61440
    ds_read_b64_tr_b16 v[106:107], v66 offset:62464
    s_waitcnt lgkmcnt(10)
    v_mfma_f32_16x16x32_bf16 v[36:39], v[108:111], v[248:251], v[36:39]
    ds_read_b64_tr_b16 v[108:109], v67 offset:61440
    ds_read_b64_tr_b16 v[110:111], v67 offset:62464
    ds_add_u32 v25, v26
    s_waitcnt lgkmcnt(11)
    v_mfma_f32_16x16x32_bf16 v[40:43], v[112:115], v[248:251], v[40:43]
    s_waitcnt lgkmcnt(9)
    v_mfma_f32_16x16x32_bf16 v[44:47], v[116:119], v[248:251], v[44:47]
    s_waitcnt vmcnt(0) lgkmcnt(7)
    v_mfma_f32_16x16x32_bf16 v[32:35], v[96:99], v[252:255], v[32:35]
    ds_read_b32 v27, v24 offset:1536
    s_waitcnt lgkmcnt(6)
    v_mfma_f32_16x16x32_bf16 v[36:39], v[100:103], v[252:255], v[36:39]
    s_waitcnt lgkmcnt(4)
    v_mfma_f32_16x16x32_bf16 v[40:43], v[104:107], v[252:255], v[40:43]
    s_waitcnt lgkmcnt(2)
    v_mfma_f32_16x16x32_bf16 v[44:47], v[108:111], v[252:255], v[44:47]
    s_waitcnt lgkmcnt(0)
    v_cmp_gt_u32 vcc, 2, v27
    v_cvt_pk_bf16_f32 v16, v32, v33
    v_cvt_pk_bf16_f32 v17, v34, v35
    v_cvt_pk_bf16_f32 v18, v36, v37
    v_cvt_pk_bf16_f32 v19, v38, v39
    buffer_store_dwordx4 v[16:19], v68, s[72:75], s97 offen offset:0 sc1
    v_cvt_pk_bf16_f32 v20, v40, v41
    v_cvt_pk_bf16_f32 v21, v42, v43
    v_cvt_pk_bf16_f32 v22, v44, v45
    v_cvt_pk_bf16_f32 v23, v46, v47
    buffer_store_dwordx4 v[20:23], v68, s[72:75], s97 offen offset:2048 sc1
    v_pk_mul_f32 v[122:123], v[32:33], v[32:33]
    v_pk_add_f32 v[120:121], v[32:33], v[34:35]
    v_pk_fma_f32 v[122:123], v[34:35], v[34:35], v[122:123]
    v_pk_fma_f32 v[122:123], v[36:37], v[36:37], v[122:123]
    v_pk_add_f32 v[120:121], v[120:121], v[36:37]
    v_pk_fma_f32 v[122:123], v[38:39], v[38:39], v[122:123]
    v_pk_add_f32 v[120:121], v[120:121], v[38:39]
    v_pk_fma_f32 v[122:123], v[40:41], v[40:41], v[122:123]
    v_pk_add_f32 v[120:121], v[120:121], v[40:41]
    v_pk_fma_f32 v[122:123], v[42:43], v[42:43], v[122:123]
    v_pk_add_f32 v[120:121], v[120:121], v[42:43]
    v_pk_fma_f32 v[122:123], v[44:45], v[44:45], v[122:123]
    v_pk_add_f32 v[120:121], v[120:121], v[44:45]
    v_pk_fma_f32 v[122:123], v[46:47], v[46:47], v[122:123]
    v_pk_add_f32 v[120:121], v[120:121], v[46:47]
    v_add_f32 v120, v120, v121
    v_add_f32 v122, v122, v123
    s_nop 1
    v_permlane32_swap_b32 v120, v122
    v_add_f32 v120, v120, v122
    v_mov_b32 v122, v120
    s_nop 1
    v_permlane16_swap_b32 v120, v122
    v_add_f32 v120, v120, v122
    s_mov_b64 exec, s[6:7]
    buffer_store_dword v120, v124, s[72:75], s81 offen sc1
    s_mov_b64 exec, -1
    s_cbranch_vccnz Lst60
Lbk61:
    ds_read_b128 v[8:11], v2 offset:57344
    ds_read_b128 v[176:179], v2 offset:8192
    ds_read_b128 v[144:147], v2 offset:0
    ds_read_b128 v[4:7], v2 offset:58368
    ds_read_b128 v[180:183], v2 offset:9216
    ds_read_b128 v[148:151], v2 offset:1024
    s_waitcnt lgkmcnt(4)
    v_mfma_f32_32x32x16_bf16 v[192:207], v[176:179], v[8:11], 0
    s_waitcnt lgkmcnt(3)
    v_mfma_f32_32x32x16_bf16 v[64:79], v[144:147], v[8:11], 0
    s_waitcnt lgkmcnt(1)
    v_mfma_f32_32x32x16_bf16 v[208:223], v[180:183], v[4:7], 0
    ds_read_b128 v[100:103], v2 offset:1024
    ds_read_b128 v[96:99], v2 offset:2048
    s_waitcnt lgkmcnt(2)
    v_mfma_f32_32x32x16_bf16 v[80:95], v[148:151], v[4:7], 0
    s_mov_b32 s97, 0
    s_nop 4
    v_cndmask_b32 v192, v64, v192, s[40:41]
    v_cndmask_b32 v193, v65, v193, s[42:43]
    v_cndmask_b32 v194, v66, v194, s[44:45]
    v_cndmask_b32 v195, v67, v195, s[46:47]
    v_cndmask_b32 v196, v68, v196, s[48:49]
    v_cndmask_b32 v197, v69, v197, s[50:51]
    v_cndmask_b32 v198, v70, v198, s[52:53]
    v_cndmask_b32 v199, v71, v199, s[54:55]
    v_cndmask_b32 v200, v72, v200, s[56:57]
    v_cndmask_b32 v201, v73, v201, s[58:59]
    v_cndmask_b32 v202, v74, v202, s[60:61]
    v_cndmask_b32 v203, v75, v203, s[62:63]
    v_cndmask_b32 v204, v76, v204, s[64:65]
    v_cndmask_b32 v205, v77, v205, s[66:67]
    v_cndmask_b32 v206, v78, v206, s[68:69]
    v_cndmask_b32 v207, v79, v207, s[70:71]
    v_max_f32 v12, v192, v193
    v_max3_f32 v12, v12, v194, v195
    v_max3_f32 v12, v12, v196, v197
    v_max3_f32 v12, v12, v198, v199
    v_max3_f32 v12, v12, v200, v201
    v_max3_f32 v12, v12, v202, v203
    v_max3_f32 v12, v12, v204, v205
    v_max3_f32 v12, v12, v206, v207
    v_cndmask_b32 v208, v80, v208, s[40:41]
    v_cndmask_b32 v209, v81, v209, s[42:43]
    v_cndmask_b32 v210, v82, v210, s[44:45]
    v_cndmask_b32 v211, v83, v211, s[46:47]
    v_cndmask_b32 v212, v84, v212, s[48:49]
    v_cndmask_b32 v213, v85, v213, s[50:51]
    v_cndmask_b32 v214, v86, v214, s[52:53]
    v_cndmask_b32 v215, v87, v215, s[54:55]
    v_cndmask_b32 v216, v88, v216, s[56:57]
    v_cndmask_b32 v217, v89, v217, s[58:59]
    v_cndmask_b32 v218, v90, v218, s[60:61]
    v_cndmask_b32 v219, v91, v219, s[62:63]
    v_cndmask_b32 v220, v92, v220, s[64:65]
    v_cndmask_b32 v221, v93, v221, s[66:67]
    v_cndmask_b32 v222, v94, v222, s[68:69]
    v_cndmask_b32 v223, v95, v223, s[70:71]
    v_max_f32 v13, v208, v209
    v_max3_f32 v13, v13, v210, v211
    v_max3_f32 v13, v13, v212, v213
    v_max3_f32 v13, v13, v214, v215
    v_max3_f32 v13, v13, v216, v217
    v_max3_f32 v13, v13, v218, v219
    v_max3_f32 v13, v13, v220, v221
    v_max3_f32 v13, v13, v222, v223
Lp263:
    s_load_dwordx16 s[40:55], s[4:5], s83
    s_nop 0
    v_permlane32_swap_b32 v12, v13
    v_max_f32 v12, v12, v13
    v_mov_b32 v13, v12
    s_nop 1
    v_permlane32_swap_b32 v12, v13
    v_pk_mul_f32 v[224:225], v[12:13], -1.0 op_sel:[0,0] op_sel_hi:[0,0]
    v_pk_mul_f32 v[226:227], v[12:13], -1.0 op_sel:[0,0] op_sel_hi:[0,0]
    v_pk_mul_f32 v[228:229], v[12:13], -1.0 op_sel:[0,0] op_sel_hi:[0,0]
    v_pk_mul_f32 v[230:231], v[12:13], -1.0 op_sel:[0,0] op_sel_hi:[0,0]
    v_pk_mul_f32 v[232:233], v[12:13], -1.0 op_sel:[0,0] op_sel_hi:[0,0]
    v_pk_mul_f32 v[234:235], v[12:13], -1.0 op_sel:[0,0] op_sel_hi:[0,0]
    v_pk_mul_f32 v[236:237], v[12:13], -1.0 op_sel:[0,0] op_sel_hi:[0,0]
    v_pk_mul_f32 v[238:239], v[12:13], -1.0 op_sel:[0,0] op_sel_hi:[0,0]
    ds_read_b32 v27, v24 offset:1536
    v_pk_mul_f32 v[240:241], v[12:13], -1.0 op_sel:[1,0] op_sel_hi:[1,0]
    v_pk_mul_f32 v[242:243], v[12:13], -1.0 op_sel:[1,0] op_sel_hi:[1,0]
    v_pk_mul_f32 v[244:245], v[12:13], -1.0 op_sel:[1,0] op_sel_hi:[1,0]
    v_pk_mul_f32 v[246:247], v[12:13], -1.0 op_sel:[1,0] op_sel_hi:[1,0]
    v_pk_mul_f32 v[248:249], v[12:13], -1.0 op_sel:[1,0] op_sel_hi:[1,0]
    v_pk_mul_f32 v[250:251], v[12:13], -1.0 op_sel:[1,0] op_sel_hi:[1,0]
    v_pk_mul_f32 v[252:253], v[12:13], -1.0 op_sel:[1,0] op_sel_hi:[1,0]
    v_pk_mul_f32 v[254:255], v[12:13], -1.0 op_sel:[1,0] op_sel_hi:[1,0]
    v_pk_add_f32 v[192:193], v[192:193], v[224:225]
    v_pk_add_f32 v[194:195], v[194:195], v[224:225]
    v_pk_add_f32 v[196:197], v[196:197], v[224:225]
    v_pk_add_f32 v[198:199], v[198:199], v[224:225]
    v_pk_add_f32 v[200:201], v[200:201], v[224:225]
    v_pk_add_f32 v[202:203], v[202:203], v[224:225]
    v_pk_add_f32 v[204:205], v[204:205], v[224:225]
    v_pk_add_f32 v[206:207], v[206:207], v[224:225]
    v_pk_add_f32 v[208:209], v[208:209], v[240:241]
    v_pk_add_f32 v[210:211], v[210:211], v[240:241]
    v_pk_add_f32 v[212:213], v[212:213], v[240:241]
    v_pk_add_f32 v[214:215], v[214:215], v[240:241]
    v_pk_add_f32 v[216:217], v[216:217], v[240:241]
    v_pk_add_f32 v[218:219], v[218:219], v[240:241]
    v_pk_add_f32 v[220:221], v[220:221], v[240:241]
    v_pk_add_f32 v[222:223], v[222:223], v[240:241]
    s_waitcnt lgkmcnt(0)
    v_cmp_gt_u32 vcc, 4, v27
    s_waitcnt vmcnt(0)
    ds_add_u32 v25, v26
    v_mov_b32 v26, 1
    v_exp_f32 v192, v192
    v_exp_f32 v193, v193
    v_exp_f32 v194, v194
    s_cbranch_vccnz Lst66
Lbk67:
    ds_read_b128 v[104:107], v3 offset:8192
    ds_read_b128 v[112:115], v3 offset:0
    ds_read_b128 v[116:119], v3 offset:512
    ds_read_b128 v[108:111], v3 offset:8704
    v_exp_f32 v195, v195
    v_exp_f32 v196, v196
    v_exp_f32 v197, v197
    v_exp_f32 v198, v198
    v_exp_f32 v199, v199
    v_exp_f32 v200, v200
    v_cvt_pk_bf16_f32 v120, v192, v193
    v_cvt_pk_bf16_f32 v121, v194, v195
    v_cvt_pk_bf16_f32 v122, v196, v197
    v_cvt_pk_bf16_f32 v123, v198, v199
    v_and_b32 v128, v120, v184
    v_and_b32 v129, v121, v185
    v_and_b32 v130, v122, v186
    v_and_b32 v131, v123, v187
    v_bfi_b32 v136, v184, 0, v120
    v_bfi_b32 v137, v185, 0, v121
    v_bfi_b32 v138, v186, 0, v122
    v_bfi_b32 v139, v187, 0, v123
    s_waitcnt lgkmcnt(3)
    v_mfma_f32_32x32x16_bf16 v[32:47], v[104:107], v[128:131], 0
    ds_read_b128 v[104:107], v3 offset:9216
    v_exp_f32 v201, v201
    v_exp_f32 v202, v202
    v_exp_f32 v203, v203
    v_exp_f32 v204, v204
    s_waitcnt lgkmcnt(3)
    v_mfma_f32_32x32x16_bf16 v[32:47], v[112:115], v[136:139], v[32:47]
    ds_read_b128 v[112:115], v3 offset:1024
    v_exp_f32 v205, v205
    v_exp_f32 v206, v206
    v_exp_f32 v207, v207
    v_cvt_pk_bf16_f32 v124, v200, v201
    v_cvt_pk_bf16_f32 v125, v202, v203
    v_cvt_pk_bf16_f32 v126, v204, v205
    v_cvt_pk_bf16_f32 v127, v206, v207
    v_bfi_b32 v140, v188, 0, v124
    v_bfi_b32 v141, v189, 0, v125
    v_bfi_b32 v142, v190, 0, v126
    v_bfi_b32 v143, v191, 0, v127
    v_and_b32 v132, v124, v188
    v_and_b32 v133, v125, v189
    v_and_b32 v134, v126, v190
    v_and_b32 v135, v127, v191
    s_waitcnt lgkmcnt(3)
    v_mfma_f32_32x32x16_bf16 v[32:47], v[116:119], v[140:143], v[32:47]
    ds_read_b128 v[116:119], v3 offset:1536
    v_exp_f32 v208, v208
    v_exp_f32 v209, v209
    v_exp_f32 v210, v210
    s_waitcnt lgkmcnt(3)
    v_mfma_f32_32x32x16_bf16 v[32:47], v[108:111], v[132:135], v[32:47]
    ds_read_b128 v[108:111], v3 offset:9728
    v_exp_f32 v211, v211
    v_exp_f32 v212, v212
    v_exp_f32 v213, v213
    v_exp_f32 v214, v214
    v_exp_f32 v215, v215
    v_exp_f32 v216, v216
    v_cvt_pk_bf16_f32 v120, v208, v209
    v_cvt_pk_bf16_f32 v121, v210, v211
    v_cvt_pk_bf16_f32 v122, v212, v213
    v_cvt_pk_bf16_f32 v123, v214, v215
    v_and_b32 v128, v120, v184
    v_and_b32 v129, v121, v185
    v_and_b32 v130, v122, v186
    v_and_b32 v131, v123, v187
    v_bfi_b32 v136, v184, 0, v120
    v_bfi_b32 v137, v185, 0, v121
    v_bfi_b32 v138, v186, 0, v122
    v_bfi_b32 v139, v187, 0, v123
    s_waitcnt lgkmcnt(3)
    v_mfma_f32_32x32x16_bf16 v[48:63], v[104:107], v[128:131], 0
    ds_read_b128 v[104:107], v3 offset:2048
    v_exp_f32 v217, v217
    v_exp_f32 v218, v218
    v_exp_f32 v219, v219
    v_exp_f32 v220, v220
    s_waitcnt lgkmcnt(3)
    v_mfma_f32_32x32x16_bf16 v[48:63], v[112:115], v[136:139], v[48:63]
    v_exp_f32 v221, v221
    v_exp_f32 v222, v222
    v_exp_f32 v223, v223
    v_mfma_f32_32x32x16_bf16 v[64:79], v[100:103], v[8:11], v[224:239]
    ds_read_b128 v[100:103], v2 offset:3072
    v_cvt_pk_bf16_f32 v124, v216, v217
    v_cvt_pk_bf16_f32 v125, v218, v219
    v_cvt_pk_bf16_f32 v126, v220, v221
    v_cvt_pk_bf16_f32 v127, v222, v223
    v_bfi_b32 v140, v188, 0, v124
    v_bfi_b32 v141, v189, 0, v125
    v_bfi_b32 v142, v190, 0, v126
    v_bfi_b32 v143, v191, 0, v127
    v_and_b32 v132, v124, v188
    v_and_b32 v133, v125, v189
    v_and_b32 v134, v126, v190
    v_and_b32 v135, v127, v191
    s_waitcnt lgkmcnt(3)
    v_mfma_f32_32x32x16_bf16 v[48:63], v[116:119], v[140:143], v[48:63]
    buffer_load_dword v28, v30, s[72:75], s1 offen offset:0 sc1
    buffer_load_dword v29, v30, s[72:75], s1 offen offset:128 sc1
    v_exp_f32 v64, v64
    v_exp_f32 v65, v65
    v_exp_f32 v66, v66
    s_waitcnt lgkmcnt(2)
    v_mfma_f32_32x32x16_bf16 v[48:63], v[108:111], v[132:135], v[48:63]
    ds_read_b128 v[108:111], v3 offset:2560
    v_exp_f32 v67, v67
    v_exp_f32 v68, v68
    v_exp_f32 v69, v69
    v_mfma_f32_32x32x16_bf16 v[80:95], v[96:99], v[8:11], v[224:239]
    v_exp_f32 v70, v70
    v_exp_f32 v71, v71
    v_exp_f32 v72, v72
    v_cvt_pk_bf16_f32 v120, v64, v65
    v_cvt_pk_bf16_f32 v121, v66, v67
    v_cvt_pk_bf16_f32 v122, v68, v69
    v_cvt_pk_bf16_f32 v123, v70, v71
    v_exp_f32 v73, v73
    v_exp_f32 v74, v74
    v_mfma_f32_32x32x16_bf16 v[32:47], v[112:115], v[120:123], v[32:47]
    ds_read_b128 v[112:115], v3 offset:3072
    v_exp_f32 v75, v75
    v_exp_f32 v76, v76
    v_exp_f32 v77, v77
    v_exp_f32 v78, v78
    v_exp_f32 v79, v79
    v_cvt_pk_bf16_f32 v124, v72, v73
    v_cvt_pk_bf16_f32 v125, v74, v75
    v_cvt_pk_bf16_f32 v126, v76, v77
    v_cvt_pk_bf16_f32 v127, v78, v79
    v_exp_f32 v80, v80
    v_exp_f32 v81, v81
    v_exp_f32 v82, v82
    v_mfma_f32_32x32x16_bf16 v[32:47], v[116:119], v[124:127], v[32:47]
    ds_read_b128 v[116:119], v3 offset:3584
    v_exp_f32 v83, v83
    v_exp_f32 v84, v84
    v_exp_f32 v85, v85
    v_mfma_f32_32x32x16_bf16 v[64:79], v[96:99], v[4:7], v[240:255]
    ds_read_b128 v[96:99], v2 offset:4096
    v_exp_f32 v86, v86
    v_exp_f32 v87, v87
    v_exp_f32 v88, v88
    v_cvt_pk_bf16_f32 v120, v80, v81
    v_cvt_pk_bf16_f32 v121, v82, v83
    v_cvt_pk_bf16_f32 v122, v84, v85
    v_cvt_pk_bf16_f32 v123, v86, v87
    v_exp_f32 v89, v89
    v_exp_f32 v90, v90
    s_waitcnt lgkmcnt(5)
    v_mfma_f32_32x32x16_bf16 v[32:47], v[104:107], v[120:123], v[32:47]
    v_exp_f32 v91, v91
    v_exp_f32 v92, v92
    v_exp_f32 v93, v93
    v_exp_f32 v94, v94
    v_exp_f32 v95, v95
    v_cvt_pk_bf16_f32 v124, v88, v89
    v_cvt_pk_bf16_f32 v125, v90, v91
    v_cvt_pk_bf16_f32 v126, v92, v93
    v_cvt_pk_bf16_f32 v127, v94, v95
    v_exp_f32 v64, v64
    v_exp_f32 v65, v65
    v_exp_f32 v66, v66
    s_waitcnt lgkmcnt(3)
    v_mfma_f32_32x32x16_bf16 v[32:47], v[108:111], v[124:127], v[32:47]
    v_exp_f32 v67, v67
    v_exp_f32 v68, v68
    v_exp_f32 v69, v69
    v_mfma_f32_32x32x16_bf16 v[80:95], v[100:103], v[8:11], v[224:239]
    v_exp_f32 v70, v70
    v_exp_f32 v71, v71
    v_exp_f32 v72, v72
    v_cvt_pk_bf16_f32 v120, v64, v65
    v_cvt_pk_bf16_f32 v121, v66, v67
    v_cvt_pk_bf16_f32 v122, v68, v69
    v_cvt_pk_bf16_f32 v123, v70, v71
    v_exp_f32 v73, v73
    v_exp_f32 v74, v74
    v_mfma_f32_32x32x16_bf16 v[48:63], v[104:107], v[120:123], v[48:63]
    ds_read_b128 v[104:107], v3 offset:4096
    v_exp_f32 v75, v75
    v_exp_f32 v76, v76
    v_exp_f32 v77, v77
    v_exp_f32 v78, v78
    v_exp_f32 v79, v79
    v_cvt_pk_bf16_f32 v124, v72, v73
    v_cvt_pk_bf16_f32 v125, v74, v75
    v_cvt_pk_bf16_f32 v126, v76, v77
    v_cvt_pk_bf16_f32 v127, v78, v79
    v_exp_f32 v80, v80
    v_exp_f32 v81, v81
    v_exp_f32 v82, v82
    v_mfma_f32_32x32x16_bf16 v[48:63], v[108:111], v[124:127], v[48:63]
    ds_read_b128 v[108:111], v3 offset:4608
    v_exp_f32 v83, v83
    v_exp_f32 v84, v84
    v_exp_f32 v85, v85
    v_mfma_f32_32x32x16_bf16 v[64:79], v[100:103], v[4:7], v[240:255]
    ds_read_b128 v[100:103], v2 offset:5120
    v_exp_f32 v86, v86
    v_exp_f32 v87, v87
    v_exp_f32 v88, v88
    v_cvt_pk_bf16_f32 v120, v80, v81
    v_cvt_pk_bf16_f32 v121, v82, v83
    v_cvt_pk_bf16_f32 v122, v84, v85
    v_cvt_pk_bf16_f32 v123, v86, v87
    v_exp_f32 v89, v89
    v_exp_f32 v90, v90
    s_waitcnt lgkmcnt(5)
    v_mfma_f32_32x32x16_bf16 v[32:47], v[112:115], v[120:123], v[32:47]
    v_exp_f32 v91, v91
    v_exp_f32 v92, v92
    v_exp_f32 v93, v93
    v_exp_f32 v94, v94
    v_exp_f32 v95, v95
    v_cvt_pk_bf16_f32 v124, v88, v89
    v_cvt_pk_bf16_f32 v125, v90, v91
    v_cvt_pk_bf16_f32 v126, v92, v93
    v_cvt_pk_bf16_f32 v127, v94, v95
    ds_read_b32 v27, v24 offset:1536
    v_exp_f32 v64, v64
    v_exp_f32 v65, v65
    v_exp_f32 v66, v66
    s_waitcnt lgkmcnt(5)
    v_mfma_f32_32x32x16_bf16 v[32:47], v[116:119], v[124:127], v[32:47]
    v_exp_f32 v67, v67
    v_exp_f32 v68, v68
    v_exp_f32 v69, v69
    s_waitcnt lgkmcnt(4)
    v_mfma_f32_32x32x16_bf16 v[80:95], v[96:99], v[8:11], v[224:239]
    v_exp_f32 v70, v70
    v_exp_f32 v71, v71
    v_exp_f32 v72, v72
    v_cvt_pk_bf16_f32 v120, v64, v65
    v_cvt_pk_bf16_f32 v121, v66, v67
    v_cvt_pk_bf16_f32 v122, v68, v69
    v_cvt_pk_bf16_f32 v123, v70, v71
    s_waitcnt lgkmcnt(0)
    v_cmp_gt_u32 vcc, 5, v27
    v_exp_f32 v73, v73
    v_exp_f32 v74, v74
    v_mfma_f32_32x32x16_bf16 v[48:63], v[112:115], v[120:123], v[48:63]
    ds_read_b128 v[112:115], v3 offset:5120
    s_cbranch_vccnz Lst68
Lbk69:
    v_exp_f32 v75, v75
    v_exp_f32 v76, v76
    v_exp_f32 v77, v77
    v_exp_f32 v78, v78
    v_exp_f32 v79, v79
    v_cvt_pk_bf16_f32 v124, v72, v73
    v_cvt_pk_bf16_f32 v125, v74, v75
    v_cvt_pk_bf16_f32 v126, v76, v77
    v_cvt_pk_bf16_f32 v127, v78, v79
    v_exp_f32 v80, v80
    v_exp_f32 v81, v81
    v_exp_f32 v82, v82
    v_mfma_f32_32x32x16_bf16 v[48:63], v[116:119], v[124:127], v[48:63]
    ds_read_b128 v[116:119], v3 offset:5632
    buffer_load_dwordx4 v[128:131], v1, s[72:75], s82 offen offset:0 sc1
    v_exp_f32 v83, v83
    v_exp_f32 v84, v84
    v_exp_f32 v85, v85
    v_mfma_f32_32x32x16_bf16 v[64:79], v[96:99], v[4:7], v[240:255]
    ds_read_b128 v[96:99], v2 offset:6144
    buffer_load_dwordx4 v[132:135], v1, s[72:75], s82 offen offset:1024 sc1
    v_exp_f32 v86, v86
    v_exp_f32 v87, v87
    v_exp_f32 v88, v88
    v_cvt_pk_bf16_f32 v120, v80, v81
    v_cvt_pk_bf16_f32 v121, v82, v83
    v_cvt_pk_bf16_f32 v122, v84, v85
    v_cvt_pk_bf16_f32 v123, v86, v87
    v_exp_f32 v89, v89
    v_exp_f32 v90, v90
    v_mfma_f32_32x32x16_bf16 v[32:47], v[104:107], v[120:123], v[32:47]
    buffer_load_dwordx4 v[136:139], v1, s[72:75], s82 offen offset:2048 sc1
    v_exp_f32 v91, v91
    v_exp_f32 v92, v92
    v_exp_f32 v93, v93
    v_exp_f32 v94, v94
    v_exp_f32 v95, v95
    v_cvt_pk_bf16_f32 v124, v88, v89
    v_cvt_pk_bf16_f32 v125, v90, v91
    v_cvt_pk_bf16_f32 v126, v92, v93
    v_cvt_pk_bf16_f32 v127, v94, v95
    v_exp_f32 v64, v64
    v_exp_f32 v65, v65
    v_exp_f32 v66, v66
    v_mfma_f32_32x32x16_bf16 v[32:47], v[108:111], v[124:127], v[32:47]
    buffer_load_dwordx4 v[140:143], v1, s[72:75], s82 offen offset:3072 sc1
    v_exp_f32 v67, v67
    v_exp_f32 v68, v68
    v_exp_f32 v69, v69
    v_mfma_f32_32x32x16_bf16 v[80:95], v[100:103], v[8:11], v[224:239]
    s_add_u32 s82, s82, 4096
    buffer_load_dwordx4 v[144:147], v1, s[72:75], s82 offen offset:0 sc1
    v_exp_f32 v70, v70
    v_exp_f32 v71, v71
    v_exp_f32 v72, v72
    v_cvt_pk_bf16_f32 v120, v64, v65
    v_cvt_pk_bf16_f32 v121, v66, v67
    v_cvt_pk_bf16_f32 v122, v68, v69
    v_cvt_pk_bf16_f32 v123, v70, v71
    v_exp_f32 v73, v73
    v_exp_f32 v74, v74
    v_mfma_f32_32x32x16_bf16 v[48:63], v[104:107], v[120:123], v[48:63]
    ds_read_b128 v[104:107], v3 offset:6144
    buffer_load_dwordx4 v[148:151], v1, s[72:75], s82 offen offset:1024 sc1
    v_exp_f32 v75, v75
    v_exp_f32 v76, v76
    v_exp_f32 v77, v77
    v_exp_f32 v78, v78
    v_exp_f32 v79, v79
    v_cvt_pk_bf16_f32 v124, v72, v73
    v_cvt_pk_bf16_f32 v125, v74, v75
    v_cvt_pk_bf16_f32 v126, v76, v77
    v_cvt_pk_bf16_f32 v127, v78, v79
    v_exp_f32 v80, v80
    v_exp_f32 v81, v81
    v_exp_f32 v82, v82
    v_mfma_f32_32x32x16_bf16 v[48:63], v[108:111], v[124:127], v[48:63]
    ds_read_b128 v[108:111], v3 offset:6656
    buffer_load_dwordx4 v[152:155], v1, s[72:75], s82 offen offset:2048 sc1
    v_exp_f32 v83, v83
    v_exp_f32 v84, v84
    v_exp_f32 v85, v85
    v_mfma_f32_32x32x16_bf16 v[64:79], v[100:103], v[4:7], v[240:255]
    ds_read_b128 v[100:103], v2 offset:7168
    buffer_load_dwordx4 v[156:159], v1, s[72:75], s82 offen offset:3072 sc1
    v_exp_f32 v86, v86
    v_exp_f32 v87, v87
    v_exp_f32 v88, v88
    v_cvt_pk_bf16_f32 v120, v80, v81
    v_cvt_pk_bf16_f32 v121, v82, v83
    v_cvt_pk_bf16_f32 v122, v84, v85
    v_cvt_pk_bf16_f32 v123, v86, v87
    v_exp_f32 v89, v89
    v_exp_f32 v90, v90
    s_waitcnt lgkmcnt(5)
    v_mfma_f32_32x32x16_bf16 v[32:47], v[112:115], v[120:123], v[32:47]
    s_add_u32 s82, s82, 4096
    buffer_load_dwordx4 v[160:163], v1, s[72:75], s82 offen offset:0 sc1
    v_exp_f32 v91, v91
    v_exp_f32 v92, v92
    v_exp_f32 v93, v93
    v_exp_f32 v94, v94
    v_exp_f32 v95, v95
    v_cvt_pk_bf16_f32 v124, v88, v89
    v_cvt_pk_bf16_f32 v125, v90, v91
    v_cvt_pk_bf16_f32 v126, v92, v93
    v_cvt_pk_bf16_f32 v127, v94, v95
    v_exp_f32 v64, v64
    v_exp_f32 v65, v65
    v_exp_f32 v66, v66
    s_waitcnt lgkmcnt(4)
    v_mfma_f32_32x32x16_bf16 v[32:47], v[116:119], v[124:127], v[32:47]
    buffer_load_dwordx4 v[164:167], v1, s[72:75], s82 offen offset:1024 sc1
    v_exp_f32 v67, v67
    v_exp_f32 v68, v68
    v_exp_f32 v69, v69
    s_waitcnt lgkmcnt(3)
    v_mfma_f32_32x32x16_bf16 v[80:95], v[96:99], v[8:11], v[224:239]
    buffer_load_dwordx4 v[168:171], v1, s[72:75], s82 offen offset:2048 sc1
    v_exp_f32 v70, v70
    v_exp_f32 v71, v71
    v_exp_f32 v72, v72
    v_cvt_pk_bf16_f32 v120, v64, v65
    v_cvt_pk_bf16_f32 v121, v66, v67
    v_cvt_pk_bf16_f32 v122, v68, v69
    v_cvt_pk_bf16_f32 v123, v70, v71
    v_exp_f32 v73, v73
    v_exp_f32 v74, v74
    v_mfma_f32_32x32x16_bf16 v[48:63], v[112:115], v[120:123], v[48:63]
    ds_read_b128 v[112:115], v3 offset:7168
    buffer_load_dwordx4 v[172:175], v1, s[72:75], s82 offen offset:3072 sc1
    v_exp_f32 v75, v75
    v_exp_f32 v76, v76
    v_exp_f32 v77, v77
    v_exp_f32 v78, v78
    v_exp_f32 v79, v79
    v_cvt_pk_bf16_f32 v124, v72, v73
    v_cvt_pk_bf16_f32 v125, v74, v75
    v_cvt_pk_bf16_f32 v126, v76, v77
    v_cvt_pk_bf16_f32 v127, v78, v79
    v_exp_f32 v80, v80
    v_exp_f32 v81, v81
    v_exp_f32 v82, v82
    v_mfma_f32_32x32x16_bf16 v[48:63], v[116:119], v[124:127], v[48:63]
    ds_read_b128 v[116:119], v3 offset:7680
    s_add_u32 s82, s82, 4096
    buffer_load_dwordx4 v[176:179], v1, s[72:75], s82 offen offset:0 sc1
    v_exp_f32 v83, v83
    v_exp_f32 v84, v84
    v_exp_f32 v85, v85
    v_mfma_f32_32x32x16_bf16 v[64:79], v[96:99], v[4:7], v[240:255]
    ds_read_b128 v[96:99], v2 offset:8192
    buffer_load_dwordx4 v[180:183], v1, s[72:75], s82 offen offset:1024 sc1
    v_exp_f32 v86, v86
    v_exp_f32 v87, v87
    v_exp_f32 v88, v88
    v_cvt_pk_bf16_f32 v120, v80, v81
    v_cvt_pk_bf16_f32 v121, v82, v83
    v_cvt_pk_bf16_f32 v122, v84, v85
    v_cvt_pk_bf16_f32 v123, v86, v87
    v_exp_f32 v89, v89
    v_exp_f32 v90, v90
    s_waitcnt lgkmcnt(5)
    v_mfma_f32_32x32x16_bf16 v[32:47], v[104:107], v[120:123], v[32:47]
    buffer_load_dwordx4 v[184:187], v1, s[72:75], s82 offen offset:2048 sc1
    v_exp_f32 v91, v91
    v_exp_f32 v92, v92
    v_exp_f32 v93, v93
    v_exp_f32 v94, v94
    v_exp_f32 v95, v95
    v_cvt_pk_bf16_f32 v124, v88, v89
    v_cvt_pk_bf16_f32 v125, v90, v91
    v_cvt_pk_bf16_f32 v126, v92, v93
    v_cvt_pk_bf16_f32 v127, v94, v95
    v_exp_f32 v64, v64
    v_exp_f32 v65, v65
    v_exp_f32 v66, v66
    s_waitcnt lgkmcnt(4)
    v_mfma_f32_32x32x16_bf16 v[32:47], v[108:111], v[124:127], v[32:47]
    buffer_load_dwordx4 v[188:191], v1, s[72:75], s82 offen offset:3072 sc1
    v_exp_f32 v67, v67
    v_exp_f32 v68, v68
    v_exp_f32 v69, v69
    s_waitcnt lgkmcnt(3)
    v_mfma_f32_32x32x16_bf16 v[80:95], v[100:103], v[8:11], v[224:239]
    s_add_u32 s82, s82, 4096
    buffer_load_dwordx4 v[192:195], v1, s[72:75], s82 offen offset:0 sc1
    v_exp_f32 v70, v70
    v_exp_f32 v71, v71
    v_exp_f32 v72, v72
    v_cvt_pk_bf16_f32 v120, v64, v65
    v_cvt_pk_bf16_f32 v121, v66, v67
    v_cvt_pk_bf16_f32 v122, v68, v69
    v_cvt_pk_bf16_f32 v123, v70, v71
    v_exp_f32 v73, v73
    v_exp_f32 v74, v74
    v_mfma_f32_32x32x16_bf16 v[48:63], v[104:107], v[120:123], v[48:63]
    ds_read_b128 v[104:107], v3 offset:8192
    buffer_load_dwordx4 v[196:199], v1, s[72:75], s82 offen offset:1024 sc1
    v_exp_f32 v75, v75
    v_exp_f32 v76, v76
    v_exp_f32 v77, v77
    v_exp_f32 v78, v78
    v_exp_f32 v79, v79
    v_cvt_pk_bf16_f32 v124, v72, v73
    v_cvt_pk_bf16_f32 v125, v74, v75
    v_cvt_pk_bf16_f32 v126, v76, v77
    v_cvt_pk_bf16_f32 v127, v78, v79
    v_exp_f32 v80, v80
    v_exp_f32 v81, v81
    v_exp_f32 v82, v82
    v_mfma_f32_32x32x16_bf16 v[48:63], v[108:111], v[124:127], v[48:63]
    ds_read_b128 v[108:111], v3 offset:8704
    buffer_load_dwordx4 v[200:203], v1, s[72:75], s82 offen offset:2048 sc1
    v_exp_f32 v83, v83
    v_exp_f32 v84, v84
    v_exp_f32 v85, v85
    v_mfma_f32_32x32x16_bf16 v[64:79], v[100:103], v[4:7], v[240:255]
    buffer_load_dwordx4 v[204:207], v1, s[72:75], s82 offen offset:3072 sc1
    v_exp_f32 v86, v86
    v_exp_f32 v87, v87
    v_exp_f32 v88, v88
    v_cvt_pk_bf16_f32 v120, v80, v81
    v_cvt_pk_bf16_f32 v121, v82, v83
    v_cvt_pk_bf16_f32 v122, v84, v85
    v_cvt_pk_bf16_f32 v123, v86, v87
    v_exp_f32 v89, v89
    v_exp_f32 v90, v90
    s_waitcnt lgkmcnt(4)
    v_mfma_f32_32x32x16_bf16 v[32:47], v[112:115], v[120:123], v[32:47]
    s_add_u32 s82, s82, 4096
    buffer_load_dwordx4 v[208:211], v1, s[72:75], s82 offen offset:0 sc1
    v_exp_f32 v91, v91
    v_exp_f32 v92, v92
    v_exp_f32 v93, v93
    v_exp_f32 v94, v94
    v_exp_f32 v95, v95
    buffer_load_dwordx4 v[212:215], v1, s[72:75], s82 offen offset:1024 sc1
    v_cvt_pk_bf16_f32 v124, v88, v89
    v_cvt_pk_bf16_f32 v125, v90, v91
    v_cvt_pk_bf16_f32 v126, v92, v93
    v_cvt_pk_bf16_f32 v127, v94, v95
    v_exp_f32 v64, v64
    v_exp_f32 v65, v65
    v_exp_f32 v66, v66
    s_waitcnt lgkmcnt(3)
    v_mfma_f32_32x32x16_bf16 v[32:47], v[116:119], v[124:127], v[32:47]
    buffer_load_dwordx4 v[216:219], v1, s[72:75], s82 offen offset:2048 sc1
    v_exp_f32 v67, v67
    v_exp_f32 v68, v68
    v_exp_f32 v69, v69
    s_waitcnt lgkmcnt(2)
    v_mfma_f32_32x32x16_bf16 v[80:95], v[96:99], v[4:7], v[240:255]
    buffer_load_dwordx4 v[220:223], v1, s[72:75], s82 offen offset:3072 sc1
    v_exp_f32 v70, v70
    v_exp_f32 v71, v71
    v_exp_f32 v72, v72
    v_cvt_pk_bf16_f32 v120, v64, v65
    v_cvt_pk_bf16_f32 v121, v66, v67
    v_cvt_pk_bf16_f32 v122, v68, v69
    v_cvt_pk_bf16_f32 v123, v70, v71
    v_exp_f32 v73, v73
    v_exp_f32 v74, v74
    v_mfma_f32_32x32x16_bf16 v[48:63], v[112:115], v[120:123], v[48:63]
    s_add_u32 s82, s82, 4096
    buffer_load_dwordx4 v[224:227], v1, s[72:75], s82 offen offset:0 sc1
    v_exp_f32 v75, v75
    v_exp_f32 v76, v76
    v_exp_f32 v77, v77
    v_exp_f32 v78, v78
    v_exp_f32 v79, v79
    buffer_load_dwordx4 v[228:231], v1, s[72:75], s82 offen offset:1024 sc1
    v_cvt_pk_bf16_f32 v124, v72, v73
    v_cvt_pk_bf16_f32 v125, v74, v75
    v_cvt_pk_bf16_f32 v126, v76, v77
    v_cvt_pk_bf16_f32 v127, v78, v79
    ds_read_b32 v27, v24 offset:1152
    v_lshl_add_u32 v16, v15, 9, v14
    v_exp_f32 v80, v80
    v_exp_f32 v81, v81
    v_exp_f32 v82, v82
    v_mfma_f32_32x32x16_bf16 v[48:63], v[116:119], v[124:127], v[48:63]
    buffer_load_dwordx4 v[232:235], v1, s[72:75], s82 offen offset:2048 sc1
    v_exp_f32 v83, v83
    v_exp_f32 v84, v84
    v_exp_f32 v85, v85
    buffer_load_dwordx4 v[236:239], v1, s[72:75], s82 offen offset:3072 sc1
    v_exp_f32 v86, v86
    v_exp_f32 v87, v87
    v_exp_f32 v88, v88
    v_cvt_pk_bf16_f32 v120, v80, v81
    v_cvt_pk_bf16_f32 v121, v82, v83
    v_cvt_pk_bf16_f32 v122, v84, v85
    v_cvt_pk_bf16_f32 v123, v86, v87
    s_waitcnt lgkmcnt(0)
    v_cmp_gt_u32 vcc, 31, v27
    v_exp_f32 v89, v89
    v_exp_f32 v90, v90
    v_mfma_f32_32x32x16_bf16 v[48:63], v[104:107], v[120:123], v[48:63]
    s_add_u32 s82, s82, 4096
    buffer_load_dwordx4 v[240:243], v1, s[72:75], s82 offen offset:0 sc1
    v_exp_f32 v91, v91
    v_exp_f32 v92, v92
    v_exp_f32 v93, v93
    v_exp_f32 v94, v94
    v_exp_f32 v95, v95
    buffer_load_dwordx4 v[244:247], v1, s[72:75], s82 offen offset:1024 sc1
    s_cbranch_vccnz Lst70
Lbk71:
    ds_read_b64_tr_b16 v[96:97], v16 offset:16384
    ds_read_b64_tr_b16 v[98:99], v16 offset:17408
    ds_read_b64_tr_b16 v[100:101], v16 offset:18432
    ds_read_b64_tr_b16 v[102:103], v16 offset:19456
    ds_read_b64_tr_b16 v[112:113], v16 offset:20480
    ds_read_b64_tr_b16 v[114:115], v16 offset:21504
    v_cvt_pk_bf16_f32 v124, v88, v89
    v_cvt_pk_bf16_f32 v125, v90, v91
    v_cvt_pk_bf16_f32 v126, v92, v93
    v_cvt_pk_bf16_f32 v127, v94, v95
    s_nop 1
    v_mfma_f32_32x32x16_bf16 v[48:63], v[108:111], v[124:127], v[48:63]
    ds_read_b64_tr_b16 v[104:105], v16 offset:22528
    ds_read_b64_tr_b16 v[106:107], v16 offset:23552
    ds_read_b64_tr_b16 v[108:109], v16 offset:24576
    ds_read_b64_tr_b16 v[110:111], v16 offset:25600
    s_mov_b32 s6, 0x67800000
    buffer_load_dwordx4 v[248:251], v1, s[72:75], s82 offen offset:2048 sc1
    buffer_load_dwordx4 v[252:255], v1, s[72:75], s82 offen offset:3072 sc1
    s_nop 4
    v_add_f32 v13, v40, v56
    v_cmp_ngt_f32 vcc, s6, v13
    s_cbranch_vccnz Lrd64
Lrb65:
    s_cmp_eq_u32 s38, 0
    s_cbranch_scc1 Lsp72
    s_waitcnt vmcnt(31) lgkmcnt(8)
    v_mfma_f32_32x32x16_bf16 v[64:79], v[96:99], v[128:131], 0
    ds_read_b64_tr_b16 v[96:97], v16 offset:26624
    ds_read_b64_tr_b16 v[98:99], v16 offset:27648
    s_waitcnt lgkmcnt(8)
    v_add_u32 v20, 0x10000, v1
    v_xor_b32 v18, 64, v16
    v_add_u32 v17, 0x10000, v16
    v_add_u32 v19, 0x10000, v18
    v_lshlrev_b32 v9, 1, v30
    s_waitcnt vmcnt(30)
    v_mfma_f32_32x32x16_bf16 v[64:79], v[100:103], v[132:135], v[64:79]
    ds_read_b64_tr_b16 v[100:101], v16 offset:28672
    ds_read_b64_tr_b16 v[102:103], v16 offset:29696
    s_waitcnt lgkmcnt(8)
    v_lshl_add_u32 v9, v15, 10, v9
    buffer_load_dwordx2 v[80:81], v9, s[72:75], s90 offen offset:0 sc1
    s_waitcnt vmcnt(30)
    v_mfma_f32_32x32x16_bf16 v[64:79], v[112:115], v[136:139], v[64:79]
    ds_read_b64_tr_b16 v[112:113], v16 offset:30720
    ds_read_b64_tr_b16 v[114:115], v16 offset:31744
    s_waitcnt lgkmcnt(8)
    buffer_load_dwordx2 v[82:83], v9, s[72:75], s90 offen offset:256 sc1
    s_waitcnt vmcnt(30)
    v_mfma_f32_32x32x16_bf16 v[64:79], v[104:107], v[140:143], v[64:79]
    ds_read_b64_tr_b16 v[104:105], v16 offset:32768
    ds_read_b64_tr_b16 v[106:107], v16 offset:33792
    s_waitcnt lgkmcnt(8)
    buffer_load_dwordx2 v[84:85], v9, s[72:75], s90 offen offset:512 sc1
    s_waitcnt vmcnt(30)
    v_mfma_f32_32x32x16_bf16 v[64:79], v[108:111], v[144:147], v[64:79]
    ds_read_b64_tr_b16 v[108:109], v16 offset:34816
    ds_read_b64_tr_b16 v[110:111], v16 offset:35840
    s_waitcnt lgkmcnt(8)
    buffer_load_dwordx2 v[86:87], v9, s[72:75], s90 offen offset:768 sc1
    s_waitcnt vmcnt(30)
    v_mfma_f32_32x32x16_bf16 v[64:79], v[96:99], v[148:151], v[64:79]
    ds_read_b64_tr_b16 v[96:97], v16 offset:36864
    ds_read_b64_tr_b16 v[98:99], v16 offset:37888
    s_waitcnt lgkmcnt(8)
    buffer_load_dword v30, v30, s[72:75], s91 offen sc1
    v_rcp_f32 v13, v40
    s_waitcnt vmcnt(30)
    v_mfma_f32_32x32x16_bf16 v[64:79], v[100:103], v[152:155], v[64:79]
    ds_read_b64_tr_b16 v[100:101], v16 offset:38912
    ds_read_b64_tr_b16 v[102:103], v16 offset:39936
    s_waitcnt lgkmcnt(8)
    s_add_u32 s87, s0, 0
    v_mul_f32 v13, v13, v28
    v_mul_f32 v32, v32, v13
    v_mul_f32 v33, v33, v13
    v_mul_f32 v34, v34, v13
    s_waitcnt vmcnt(29)
    v_mfma_f32_32x32x16_bf16 v[64:79], v[112:115], v[156:159], v[64:79]
    ds_read_b64_tr_b16 v[112:113], v16 offset:40960
    ds_read_b64_tr_b16 v[114:115], v16 offset:41984
    s_waitcnt lgkmcnt(8)
    v_mul_f32 v35, v35, v13
    v_mul_f32 v36, v36, v13
    v_mul_f32 v37, v37, v13
    v_mul_f32 v38, v38, v13
    v_mul_f32 v39, v39, v13
    s_waitcnt vmcnt(28)
    v_mfma_f32_32x32x16_bf16 v[64:79], v[104:107], v[160:163], v[64:79]
    ds_read_b64_tr_b16 v[104:105], v16 offset:43008
    ds_read_b64_tr_b16 v[106:107], v16 offset:44032
    s_waitcnt lgkmcnt(8)
    v_cvt_pk_bf16_f32 v40, v32, v33
    v_cvt_pk_bf16_f32 v41, v34, v35
    v_cvt_pk_bf16_f32 v42, v36, v37
    v_cvt_pk_bf16_f32 v43, v38, v39
    s_waitcnt vmcnt(27)
    v_mfma_f32_32x32x16_bf16 v[64:79], v[108:111], v[164:167], v[64:79]
    ds_read_b64_tr_b16 v[108:109], v16 offset:45056
    ds_read_b64_tr_b16 v[110:111], v16 offset:46080
    s_waitcnt lgkmcnt(8)
    buffer_store_dwordx4 v[40:43], v1, s[72:75], s87 offen sc1
    v_rcp_f32 v13, v56
    s_waitcnt vmcnt(27)
    v_mfma_f32_32x32x16_bf16 v[64:79], v[96:99], v[168:171], v[64:79]
    ds_read_b64_tr_b16 v[96:97], v16 offset:47104
    ds_read_b64_tr_b16 v[98:99], v16 offset:48128
    s_waitcnt lgkmcnt(8)
    s_add_u32 s87, s0, 147456
    v_mul_f32 v13, v13, v29
    v_mul_f32 v48, v48, v13
    s_waitcnt vmcnt(26)
    v_mfma_f32_32x32x16_bf16 v[64:79], v[100:103], v[172:175], v[64:79]
    ds_read_b64_tr_b16 v[100:101], v16 offset:49152
    ds_read_b64_tr_b16 v[102:103], v16 offset:50176
    s_waitcnt lgkmcnt(8)
    v_mul_f32 v49, v49, v13
    v_mul_f32 v50, v50, v13
    v_mul_f32 v51, v51, v13
    s_waitcnt vmcnt(25)
    v_mfma_f32_32x32x16_bf16 v[64:79], v[112:115], v[176:179], v[64:79]
    ds_read_b64_tr_b16 v[112:113], v16 offset:51200
    ds_read_b64_tr_b16 v[114:115], v16 offset:52224
    s_waitcnt lgkmcnt(8)
    v_mul_f32 v52, v52, v13
    v_mul_f32 v53, v53, v13
    v_mul_f32 v54, v54, v13
    s_waitcnt vmcnt(24)
    v_mfma_f32_32x32x16_bf16 v[64:79], v[104:107], v[180:183], v[64:79]
    ds_read_b64_tr_b16 v[104:105], v16 offset:53248
    ds_read_b64_tr_b16 v[106:107], v16 offset:54272
    s_waitcnt lgkmcnt(8)
    v_mul_f32 v55, v55, v13
    v_cvt_pk_bf16_f32 v56, v48, v49
    v_cvt_pk_bf16_f32 v57, v50, v51
    s_waitcnt vmcnt(23)
    v_mfma_f32_32x32x16_bf16 v[64:79], v[108:111], v[184:187], v[64:79]
    ds_read_b64_tr_b16 v[108:109], v16 offset:55296
    ds_read_b64_tr_b16 v[110:111], v16 offset:56320
    s_waitcnt lgkmcnt(8)
    v_cvt_pk_bf16_f32 v58, v52, v53
    v_cvt_pk_bf16_f32 v59, v54, v55
    s_waitcnt vmcnt(22)
    v_mfma_f32_32x32x16_bf16 v[64:79], v[96:99], v[188:191], v[64:79]
    ds_read_b64_tr_b16 v[96:97], v16 offset:57344
    ds_read_b64_tr_b16 v[98:99], v16 offset:58368
    s_waitcnt lgkmcnt(8)
    buffer_store_dwordx4 v[56:59], v1, s[72:75], s87 offen sc1
    v_xor_b32 v124, s49, v16
    v_xor_b32 v125, s50, v16
    s_waitcnt vmcnt(22)
    v_mfma_f32_32x32x16_bf16 v[64:79], v[100:103], v[192:195], v[64:79]
    ds_read_b64_tr_b16 v[100:101], v16 offset:59392
    ds_read_b64_tr_b16 v[102:103], v16 offset:60416
    s_waitcnt lgkmcnt(8)
    v_xor_b32 v126, s51, v16
    v_xor_b32 v127, s52, v16
    v_lshlrev_b32 v12, 4, v15
    s_waitcnt vmcnt(21)
    v_mfma_f32_32x32x16_bf16 v[64:79], v[112:115], v[196:199], v[64:79]
    ds_read_b64_tr_b16 v[112:113], v16 offset:61440
    ds_read_b64_tr_b16 v[114:115], v16 offset:62464
    s_waitcnt lgkmcnt(8)
    v_add_u32 v12, 149504, v12
    s_waitcnt vmcnt(5)
    v_add_f32 v80, v80, v82
    v_add_f32 v81, v81, v83
    v_mfma_f32_32x32x16_bf16 v[64:79], v[104:107], v[200:203], v[64:79]
    ds_read_b64_tr_b16 v[104:105], v16 offset:63488
    ds_read_b64_tr_b16 v[106:107], v16 offset:64512
    s_waitcnt lgkmcnt(8)
    s_waitcnt vmcnt(4)
    v_add_f32 v80, v80, v84
    v_add_f32 v81, v81, v85
    s_waitcnt vmcnt(3)
    v_add_f32 v80, v80, v86
    v_mfma_f32_32x32x16_bf16 v[64:79], v[108:111], v[204:207], v[64:79]
    ds_read_b32 v27, v24 offset:1792
    ds_read_b64_tr_b16 v[108:109], v17 offset:0
    ds_read_b64_tr_b16 v[110:111], v17 offset:1024
    s_waitcnt lgkmcnt(9)
    v_add_f32 v81, v81, v87
    v_mfma_f32_32x32x16_bf16 v[64:79], v[96:99], v[208:211], v[64:79]
    ds_read_b64_tr_b16 v[96:97], v17 offset:2048
    ds_read_b64_tr_b16 v[98:99], v17 offset:3072
    s_waitcnt lgkmcnt(9)
    s_waitcnt vmcnt(2)
    v_sub_f32 v30, 1.0, v30
    v_rcp_f32 v13, v30
    v_permlane32_swap_b32 v80, v81
    s_waitcnt lgkmcnt(4)
    v_cmp_gt_u32 vcc, 2, v27
    v_mfma_f32_32x32x16_bf16 v[64:79], v[100:103], v[212:215], v[64:79]
    s_cbranch_vccnz Lst74
Lbk75:
    ds_read_b64_tr_b16 v[100:101], v17 offset:4096
    ds_read_b64_tr_b16 v[102:103], v17 offset:5120
    v_mfma_f32_32x32x16_bf16 v[64:79], v[112:115], v[216:219], v[64:79]
    ds_read_b64_tr_b16 v[112:113], v17 offset:6144
    ds_read_b64_tr_b16 v[114:115], v17 offset:7168
    v_add_f32 v80, v80, v81
    v_mov_b32 v81, v80
    s_nop 1
    v_permlane32_swap_b32 v80, v81
    v_mul_f32 v8, 0xbb000000, v80
    v_mul_f32 v81, 0x3b000000, v81
    v_mfma_f32_32x32x16_bf16 v[64:79], v[104:107], v[220:223], v[64:79]
    ds_read_b64_tr_b16 v[104:105], v17 offset:8192
    ds_read_b64_tr_b16 v[106:107], v17 offset:9216
    s_waitcnt lgkmcnt(8)
    v_fma_f32 v81, -v8, v8, v81
    v_max_f32 v81, 0, v81
    v_add_f32 v81, 0x3727c5ac, v81
    v_rsq_f32 v80, v81
    s_nop 0
    v_mul_f32 v9, v81, v80
    v_mfma_f32_32x32x16_bf16 v[64:79], v[108:111], v[224:227], v[64:79]
    ds_read_b64_tr_b16 v[108:109], v17 offset:10240
    ds_read_b64_tr_b16 v[110:111], v17 offset:11264
    s_waitcnt lgkmcnt(8)
    v_mul_f32 v10, 0xc0135761, v80
    v_mul_f32 v81, v80, v80
    v_mul_f32 v81, v81, v80
    v_mfma_f32_32x32x16_bf16 v[64:79], v[96:99], v[228:231], v[64:79]
    ds_read_b64_tr_b16 v[96:97], v17 offset:12288
    ds_read_b64_tr_b16 v[98:99], v17 offset:13312
    s_waitcnt lgkmcnt(8)
    v_mul_f32 v11, 0xbdd2d3e8, v81
    v_mul_f32 v9, v9, v13
    v_min_f32 v9, 0x7149f2ca, v9
    v_mfma_f32_32x32x16_bf16 v[64:79], v[100:103], v[232:235], v[64:79]
    ds_read_b64_tr_b16 v[100:101], v17 offset:14336
    ds_read_b64_tr_b16 v[102:103], v17 offset:15360
    s_waitcnt lgkmcnt(8)
    v_log_f32 v13, v9
    v_mfma_f32_32x32x16_bf16 v[64:79], v[112:115], v[236:239], v[64:79]
    ds_read_b64_tr_b16 v[112:113], v18 offset:16384
    ds_read_b64_tr_b16 v[114:115], v18 offset:17408
    s_waitcnt lgkmcnt(8)
    ds_read_b128 v[48:51], v12 offset:0
    v_mfma_f32_32x32x16_bf16 v[64:79], v[104:107], v[240:243], v[64:79]
    ds_read_b64_tr_b16 v[104:105], v18 offset:18432
    ds_read_b64_tr_b16 v[106:107], v18 offset:19456
    s_waitcnt lgkmcnt(9)
    ds_read_b128 v[52:55], v12 offset:32
    v_mfma_f32_32x32x16_bf16 v[64:79], v[108:111], v[244:247], v[64:79]
    ds_read_b64_tr_b16 v[108:109], v18 offset:20480
    ds_read_b64_tr_b16 v[110:111], v18 offset:21504
    s_waitcnt lgkmcnt(10)
    ds_read_b128 v[56:59], v12 offset:64
    v_mfma_f32_32x32x16_bf16 v[64:79], v[96:99], v[248:251], v[64:79]
    ds_read_b64_tr_b16 v[96:97], v18 offset:22528
    ds_read_b64_tr_b16 v[98:99], v18 offset:23552
    s_waitcnt lgkmcnt(11)
    ds_read_b128 v[60:63], v12 offset:96
    v_mfma_f32_32x32x16_bf16 v[64:79], v[100:103], v[252:255], v[64:79]
    ds_read_b64_tr_b16 v[100:101], v18 offset:24576
    s_waitcnt lgkmcnt(12)
    ds_read_b64_tr_b16 v[102:103], v18 offset:25600
    s_waitcnt lgkmcnt(12)
    v_mfma_f32_32x32x16_bf16 v[80:95], v[112:115], v[128:131], 0
    ds_read_b64_tr_b16 v[112:113], v18 offset:26624
    s_waitcnt lgkmcnt(12)
    ds_read_b64_tr_b16 v[114:115], v18 offset:27648
    s_waitcnt lgkmcnt(11)
    v_mfma_f32_32x32x16_bf16 v[80:95], v[104:107], v[132:135], v[80:95]
    ds_read_b64_tr_b16 v[104:105], v18 offset:28672
    ds_read_b64_tr_b16 v[106:107], v18 offset:29696
    s_waitcnt lgkmcnt(10)
    s_waitcnt vmcnt(0)
    ds_add_u32 v25, v26
    v_pk_fma_f32 v[64:65], v[48:49], v[8:9], v[64:65] op_sel_hi:[1,0,1]
    v_pk_fma_f32 v[66:67], v[50:51], v[8:9], v[66:67] op_sel_hi:[1,0,1]
    v_pk_fma_f32 v[68:69], v[52:53], v[8:9], v[68:69] op_sel_hi:[1,0,1]
    v_pk_fma_f32 v[70:71], v[54:55], v[8:9], v[70:71] op_sel_hi:[1,0,1]
    s_waitcnt lgkmcnt(10)
    v_pk_fma_f32 v[72:73], v[56:57], v[8:9], v[72:73] op_sel_hi:[1,0,1]
    v_pk_fma_f32 v[74:75], v[58:59], v[8:9], v[74:75] op_sel_hi:[1,0,1]
    s_waitcnt lgkmcnt(7)
    v_pk_fma_f32 v[76:77], v[60:61], v[8:9], v[76:77] op_sel_hi:[1,0,1]
    v_pk_fma_f32 v[78:79], v[62:63], v[8:9], v[78:79] op_sel_hi:[1,0,1]
    v_pk_mul_f32 v[48:49], v[64:65], v[64:65]
    v_pk_mul_f32 v[50:51], v[66:67], v[66:67]
    v_pk_mul_f32 v[52:53], v[68:69], v[68:69]
    v_pk_mul_f32 v[54:55], v[70:71], v[70:71]
    v_pk_mul_f32 v[56:57], v[72:73], v[72:73]
    v_pk_mul_f32 v[58:59], v[74:75], v[74:75]
    v_pk_mul_f32 v[60:61], v[76:77], v[76:77]
    v_pk_mul_f32 v[62:63], v[78:79], v[78:79]
    v_pk_fma_f32 v[48:49], v[48:49], v[10:11], v[10:11] op_sel:[0,1,0] op_sel_hi:[1,1,0]
    v_pk_fma_f32 v[50:51], v[50:51], v[10:11], v[10:11] op_sel:[0,1,0] op_sel_hi:[1,1,0]
    v_pk_fma_f32 v[52:53], v[52:53], v[10:11], v[10:11] op_sel:[0,1,0] op_sel_hi:[1,1,0]
    v_pk_fma_f32 v[54:55], v[54:55], v[10:11], v[10:11] op_sel:[0,1,0] op_sel_hi:[1,1,0]
    v_pk_fma_f32 v[56:57], v[56:57], v[10:11], v[10:11] op_sel:[0,1,0] op_sel_hi:[1,1,0]
    v_pk_fma_f32 v[58:59], v[58:59], v[10:11], v[10:11] op_sel:[0,1,0] op_sel_hi:[1,1,0]
    v_pk_fma_f32 v[60:61], v[60:61], v[10:11], v[10:11] op_sel:[0,1,0] op_sel_hi:[1,1,0]
    v_pk_fma_f32 v[62:63], v[62:63], v[10:11], v[10:11] op_sel:[0,1,0] op_sel_hi:[1,1,0]
    v_pk_fma_f32 v[48:49], v[48:49], v[64:65], v[12:13] op_sel:[0,0,1] op_sel_hi:[1,1,1]
    v_pk_fma_f32 v[50:51], v[50:51], v[66:67], v[12:13] op_sel:[0,0,1] op_sel_hi:[1,1,1]
    v_pk_fma_f32 v[52:53], v[52:53], v[68:69], v[12:13] op_sel:[0,0,1] op_sel_hi:[1,1,1]
    v_pk_fma_f32 v[54:55], v[54:55], v[70:71], v[12:13] op_sel:[0,0,1] op_sel_hi:[1,1,1]
    v_pk_fma_f32 v[56:57], v[56:57], v[72:73], v[12:13] op_sel:[0,0,1] op_sel_hi:[1,1,1]
    v_pk_fma_f32 v[58:59], v[58:59], v[74:75], v[12:13] op_sel:[0,0,1] op_sel_hi:[1,1,1]
    v_pk_fma_f32 v[60:61], v[60:61], v[76:77], v[12:13] op_sel:[0,0,1] op_sel_hi:[1,1,1]
    v_pk_fma_f32 v[62:63], v[62:63], v[78:79], v[12:13] op_sel:[0,0,1] op_sel_hi:[1,1,1]
    v_mfma_f32_32x32x16_bf16 v[80:95], v[108:111], v[136:139], v[80:95]
    ds_read_b64_tr_b16 v[108:109], v18 offset:30720
    ds_read_b64_tr_b16 v[110:111], v18 offset:31744
    v_exp_f32 v48, v48
    v_mfma_f32_32x32x16_bf16 v[80:95], v[96:99], v[140:143], v[80:95]
    ds_read_b64_tr_b16 v[96:97], v18 offset:32768
    ds_read_b64_tr_b16 v[98:99], v18 offset:33792
    s_waitcnt lgkmcnt(9)
    v_exp_f32 v49, v49
    v_exp_f32 v50, v50
    v_add_f32 v48, v9, v48
    v_mfma_f32_32x32x16_bf16 v[80:95], v[100:103], v[144:147], v[80:95]
    ds_read_b64_tr_b16 v[100:101], v18 offset:34816
    ds_read_b64_tr_b16 v[102:103], v18 offset:35840
    s_waitcnt lgkmcnt(9)
    v_exp_f32 v51, v51
    v_rcp_f32 v48, v48
    v_add_f32 v49, v9, v49
    v_mfma_f32_32x32x16_bf16 v[80:95], v[112:115], v[148:151], v[80:95]
    ds_read_b64_tr_b16 v[112:113], v18 offset:36864
    ds_read_b64_tr_b16 v[114:115], v18 offset:37888
    s_waitcnt lgkmcnt(9)
    v_exp_f32 v52, v52
    v_rcp_f32 v49, v49
    v_add_f32 v50, v9, v50
    v_mfma_f32_32x32x16_bf16 v[80:95], v[104:107], v[152:155], v[80:95]
    ds_read_b64_tr_b16 v[104:105], v18 offset:38912
    ds_read_b64_tr_b16 v[106:107], v18 offset:39936
    s_waitcnt lgkmcnt(8)
    v_exp_f32 v53, v53
    v_add_f32 v51, v9, v51
    v_add_f32 v52, v9, v52
    v_mul_f32 v64, v64, v48
    v_mfma_f32_32x32x16_bf16 v[80:95], v[108:111], v[156:159], v[80:95]
    ds_read_b64_tr_b16 v[108:109], v18 offset:40960
    ds_read_b64_tr_b16 v[110:111], v18 offset:41984
    s_waitcnt lgkmcnt(8)
    v_rcp_f32 v50, v50
    v_exp_f32 v54, v54
    v_add_f32 v53, v9, v53
    v_mfma_f32_32x32x16_bf16 v[80:95], v[96:99], v[160:163], v[80:95]
    ds_read_b64_tr_b16 v[96:97], v18 offset:43008
    ds_read_b64_tr_b16 v[98:99], v18 offset:44032
    s_waitcnt lgkmcnt(8)
    v_rcp_f32 v51, v51
    v_exp_f32 v55, v55
    v_add_f32 v54, v9, v54
    v_mfma_f32_32x32x16_bf16 v[80:95], v[100:103], v[164:167], v[80:95]
    ds_read_b64_tr_b16 v[100:101], v18 offset:45056
    ds_read_b64_tr_b16 v[102:103], v18 offset:46080
    s_waitcnt lgkmcnt(8)
    v_rcp_f32 v52, v52
    v_add_f32 v55, v9, v55
    v_mul_f32 v65, v65, v49
    v_mul_f32 v66, v66, v50
    v_mfma_f32_32x32x16_bf16 v[80:95], v[112:115], v[168:171], v[80:95]
    ds_read_b64_tr_b16 v[112:113], v18 offset:47104
    ds_read_b64_tr_b16 v[114:115], v18 offset:48128
    s_waitcnt lgkmcnt(8)
    v_exp_f32 v56, v56
    v_rcp_f32 v53, v53
    v_cvt_pk_bf16_f32 v32, v64, v65
    v_mfma_f32_32x32x16_bf16 v[80:95], v[104:107], v[172:175], v[80:95]
    ds_read_b64_tr_b16 v[104:105], v18 offset:49152
    ds_read_b64_tr_b16 v[106:107], v18 offset:50176
    s_waitcnt lgkmcnt(8)
    v_exp_f32 v57, v57
    v_add_f32 v56, v9, v56
    v_mul_f32 v67, v67, v51
    v_mul_f32 v68, v68, v52
    v_mfma_f32_32x32x16_bf16 v[80:95], v[108:111], v[176:179], v[80:95]
    ds_read_b64_tr_b16 v[108:109], v18 offset:51200
    ds_read_b64_tr_b16 v[110:111], v18 offset:52224
    s_waitcnt lgkmcnt(8)
    v_rcp_f32 v54, v54
    v_exp_f32 v58, v58
    v_add_f32 v57, v9, v57
    v_mfma_f32_32x32x16_bf16 v[80:95], v[96:99], v[180:183], v[80:95]
    ds_read_b64_tr_b16 v[96:97], v18 offset:53248
    ds_read_b64_tr_b16 v[98:99], v18 offset:54272
    s_waitcnt lgkmcnt(8)
    v_rcp_f32 v55, v55
    v_add_f32 v58, v9, v58
    v_cvt_pk_bf16_f32 v33, v66, v67
    v_mul_f32 v69, v69, v53
    v_mfma_f32_32x32x16_bf16 v[80:95], v[100:103], v[184:187], v[80:95]
    ds_read_b64_tr_b16 v[100:101], v18 offset:55296
    ds_read_b64_tr_b16 v[102:103], v18 offset:56320
    s_waitcnt lgkmcnt(8)
    v_exp_f32 v59, v59
    v_rcp_f32 v56, v56
    v_cvt_pk_bf16_f32 v34, v68, v69
    v_mfma_f32_32x32x16_bf16 v[80:95], v[112:115], v[188:191], v[80:95]
    ds_read_b64_tr_b16 v[112:113], v18 offset:57344
    ds_read_b64_tr_b16 v[114:115], v18 offset:58368
    s_waitcnt lgkmcnt(8)
    v_exp_f32 v60, v60
    v_add_f32 v59, v9, v59
    v_mul_f32 v70, v70, v54
    v_mul_f32 v71, v71, v55
    v_mfma_f32_32x32x16_bf16 v[80:95], v[104:107], v[192:195], v[80:95]
    ds_read_b64_tr_b16 v[104:105], v18 offset:59392
    ds_read_b64_tr_b16 v[106:107], v18 offset:60416
    s_waitcnt lgkmcnt(8)
    v_rcp_f32 v57, v57
    v_exp_f32 v61, v61
    v_add_f32 v60, v9, v60
    v_mfma_f32_32x32x16_bf16 v[80:95], v[108:111], v[196:199], v[80:95]
    ds_read_b64_tr_b16 v[108:109], v18 offset:61440
    ds_read_b64_tr_b16 v[110:111], v18 offset:62464
    s_waitcnt lgkmcnt(8)
    v_rcp_f32 v58, v58
    v_add_f32 v61, v9, v61
    v_cvt_pk_bf16_f32 v35, v70, v71
    v_mul_f32 v72, v72, v56
    v_mfma_f32_32x32x16_bf16 v[80:95], v[96:99], v[200:203], v[80:95]
    ds_read_b64_tr_b16 v[96:97], v18 offset:63488
    ds_read_b64_tr_b16 v[98:99], v18 offset:64512
    s_waitcnt lgkmcnt(8)
    s_add_u32 s87, s93, 0
    buffer_store_dwordx4 v[32:35], v1, s[72:75], s87 offen offset:0 sc1
    v_exp_f32 v62, v62
    v_mfma_f32_32x32x16_bf16 v[80:95], v[100:103], v[204:207], v[80:95]
    ds_read_b64_tr_b16 v[100:101], v19 offset:0
    ds_read_b64_tr_b16 v[102:103], v19 offset:1024
    s_waitcnt lgkmcnt(8)
    v_rcp_f32 v59, v59
    v_exp_f32 v63, v63
    v_add_f32 v62, v9, v62
    v_mfma_f32_32x32x16_bf16 v[80:95], v[112:115], v[208:211], v[80:95]
    ds_read_b64_tr_b16 v[112:113], v19 offset:2048
    ds_read_b64_tr_b16 v[114:115], v19 offset:3072
    s_waitcnt lgkmcnt(8)
    v_rcp_f32 v60, v60
    v_add_f32 v63, v9, v63
    v_mul_f32 v73, v73, v57
    v_mul_f32 v74, v74, v58
    v_mfma_f32_32x32x16_bf16 v[80:95], v[104:107], v[212:215], v[80:95]
    ds_read_b64_tr_b16 v[104:105], v19 offset:4096
    ds_read_b64_tr_b16 v[106:107], v19 offset:5120
    s_waitcnt lgkmcnt(8)
    v_rcp_f32 v61, v61
    v_rcp_f32 v62, v62
    v_cvt_pk_bf16_f32 v36, v72, v73
    v_mfma_f32_32x32x16_bf16 v[80:95], v[108:111], v[216:219], v[80:95]
    ds_read_b64_tr_b16 v[108:109], v19 offset:6144
    ds_read_b64_tr_b16 v[110:111], v19 offset:7168
    s_waitcnt lgkmcnt(8)
    v_rcp_f32 v63, v63
    v_mul_f32 v75, v75, v59
    v_mul_f32 v76, v76, v60
    v_mul_f32 v77, v77, v61
    v_mfma_f32_32x32x16_bf16 v[80:95], v[96:99], v[220:223], v[80:95]
    ds_read_b64_tr_b16 v[96:97], v19 offset:8192
    ds_read_b64_tr_b16 v[98:99], v19 offset:9216
    s_waitcnt lgkmcnt(8)
    v_cvt_pk_bf16_f32 v37, v74, v75
    v_cvt_pk_bf16_f32 v38, v76, v77
    v_mul_f32 v78, v78, v62
    v_mfma_f32_32x32x16_bf16 v[80:95], v[100:103], v[224:227], v[80:95]
    ds_read_b64_tr_b16 v[100:101], v19 offset:10240
    ds_read_b64_tr_b16 v[102:103], v19 offset:11264
    s_waitcnt lgkmcnt(8)
    v_mul_f32 v79, v79, v63
    v_mfma_f32_32x32x16_bf16 v[80:95], v[112:115], v[228:231], v[80:95]
    ds_read_b64_tr_b16 v[112:113], v19 offset:12288
    ds_read_b64_tr_b16 v[114:115], v19 offset:13312
    s_waitcnt lgkmcnt(8)
    v_cvt_pk_bf16_f32 v39, v78, v79
    v_mfma_f32_32x32x16_bf16 v[80:95], v[104:107], v[232:235], v[80:95]
    ds_read_b64_tr_b16 v[104:105], v19 offset:14336
    ds_read_b64_tr_b16 v[106:107], v19 offset:15360
    ds_add_u32 v25, v26
    s_waitcnt lgkmcnt(9)
    v_mfma_f32_32x32x16_bf16 v[80:95], v[108:111], v[236:239], v[80:95]
    ds_read_b64_tr_b16 v[108:109], v17 offset:16384
    ds_read_b64_tr_b16 v[110:111], v17 offset:17408
    s_waitcnt lgkmcnt(9)
    buffer_store_dwordx4 v[36:39], v1, s[72:75], s87 offen offset:1024 sc1
    v_mfma_f32_32x32x16_bf16 v[80:95], v[96:99], v[240:243], v[80:95]
    ds_read_b64_tr_b16 v[96:97], v17 offset:18432
    ds_read_b64_tr_b16 v[98:99], v17 offset:19456
    s_waitcnt lgkmcnt(9)
    ds_read_b128 v[48:51], v12 offset:128
    v_mfma_f32_32x32x16_bf16 v[80:95], v[100:103], v[244:247], v[80:95]
    ds_read_b64_tr_b16 v[100:101], v17 offset:20480
    ds_read_b64_tr_b16 v[102:103], v17 offset:21504
    s_waitcnt lgkmcnt(10)
    ds_read_b128 v[52:55], v12 offset:160
    v_mfma_f32_32x32x16_bf16 v[80:95], v[112:115], v[248:251], v[80:95]
    ds_read_b64_tr_b16 v[112:113], v17 offset:22528
    ds_read_b64_tr_b16 v[114:115], v17 offset:23552
    s_waitcnt lgkmcnt(11)
    ds_read_b128 v[56:59], v12 offset:192
    ds_read_b128 v[60:63], v12 offset:224
    v_mfma_f32_32x32x16_bf16 v[80:95], v[104:107], v[252:255], v[80:95]
    s_waitcnt lgkmcnt(12)
    ds_read_b64_tr_b16 v[104:105], v17 offset:24576
    s_waitcnt lgkmcnt(12)
    ds_read_b64_tr_b16 v[106:107], v17 offset:25600
    s_waitcnt lgkmcnt(12)
    v_mfma_f32_32x32x16_bf16 v[64:79], v[108:111], v[128:131], 0
    ds_read_b64_tr_b16 v[108:109], v17 offset:26624
    s_waitcnt lgkmcnt(12)
    ds_read_b64_tr_b16 v[110:111], v17 offset:27648
    s_waitcnt lgkmcnt(12)
    v_mfma_f32_32x32x16_bf16 v[64:79], v[96:99], v[132:135], v[64:79]
    ds_read_b64_tr_b16 v[96:97], v17 offset:28672
    s_waitcnt lgkmcnt(12)
    ds_read_b64_tr_b16 v[98:99], v17 offset:29696
    s_waitcnt lgkmcnt(11)
    v_pk_fma_f32 v[80:81], v[48:49], v[8:9], v[80:81] op_sel_hi:[1,0,1]
    v_pk_fma_f32 v[82:83], v[50:51], v[8:9], v[82:83] op_sel_hi:[1,0,1]
    s_waitcnt lgkmcnt(10)
    v_pk_fma_f32 v[84:85], v[52:53], v[8:9], v[84:85] op_sel_hi:[1,0,1]
    v_pk_fma_f32 v[86:87], v[54:55], v[8:9], v[86:87] op_sel_hi:[1,0,1]
    s_waitcnt lgkmcnt(7)
    v_pk_fma_f32 v[88:89], v[56:57], v[8:9], v[88:89] op_sel_hi:[1,0,1]
    v_pk_fma_f32 v[90:91], v[58:59], v[8:9], v[90:91] op_sel_hi:[1,0,1]
    s_waitcnt lgkmcnt(6)
    v_pk_fma_f32 v[92:93], v[60:61], v[8:9], v[92:93] op_sel_hi:[1,0,1]
    v_pk_fma_f32 v[94:95], v[62:63], v[8:9], v[94:95] op_sel_hi:[1,0,1]
    v_pk_mul_f32 v[48:49], v[80:81], v[80:81]
    v_pk_mul_f32 v[50:51], v[82:83], v[82:83]
    v_pk_mul_f32 v[52:53], v[84:85], v[84:85]
    v_pk_mul_f32 v[54:55], v[86:87], v[86:87]
    v_pk_mul_f32 v[56:57], v[88:89], v[88:89]
    v_pk_mul_f32 v[58:59], v[90:91], v[90:91]
    v_pk_mul_f32 v[60:61], v[92:93], v[92:93]
    v_pk_mul_f32 v[62:63], v[94:95], v[94:95]
    v_pk_fma_f32 v[48:49], v[48:49], v[10:11], v[10:11] op_sel:[0,1,0] op_sel_hi:[1,1,0]
    v_pk_fma_f32 v[50:51], v[50:51], v[10:11], v[10:11] op_sel:[0,1,0] op_sel_hi:[1,1,0]
    v_pk_fma_f32 v[52:53], v[52:53], v[10:11], v[10:11] op_sel:[0,1,0] op_sel_hi:[1,1,0]
    v_pk_fma_f32 v[54:55], v[54:55], v[10:11], v[10:11] op_sel:[0,1,0] op_sel_hi:[1,1,0]
    v_pk_fma_f32 v[56:57], v[56:57], v[10:11], v[10:11] op_sel:[0,1,0] op_sel_hi:[1,1,0]
    v_pk_fma_f32 v[58:59], v[58:59], v[10:11], v[10:11] op_sel:[0,1,0] op_sel_hi:[1,1,0]
    v_pk_fma_f32 v[60:61], v[60:61], v[10:11], v[10:11] op_sel:[0,1,0] op_sel_hi:[1,1,0]
    v_pk_fma_f32 v[62:63], v[62:63], v[10:11], v[10:11] op_sel:[0,1,0] op_sel_hi:[1,1,0]
    v_pk_fma_f32 v[48:49], v[48:49], v[80:81], v[12:13] op_sel:[0,0,1] op_sel_hi:[1,1,1]
    v_pk_fma_f32 v[50:51], v[50:51], v[82:83], v[12:13] op_sel:[0,0,1] op_sel_hi:[1,1,1]
    v_pk_fma_f32 v[52:53], v[52:53], v[84:85], v[12:13] op_sel:[0,0,1] op_sel_hi:[1,1,1]
    v_pk_fma_f32 v[54:55], v[54:55], v[86:87], v[12:13] op_sel:[0,0,1] op_sel_hi:[1,1,1]
    v_pk_fma_f32 v[56:57], v[56:57], v[88:89], v[12:13] op_sel:[0,0,1] op_sel_hi:[1,1,1]
    v_pk_fma_f32 v[58:59], v[58:59], v[90:91], v[12:13] op_sel:[0,0,1] op_sel_hi:[1,1,1]
    v_pk_fma_f32 v[60:61], v[60:61], v[92:93], v[12:13] op_sel:[0,0,1] op_sel_hi:[1,1,1]
    v_pk_fma_f32 v[62:63], v[62:63], v[94:95], v[12:13] op_sel:[0,0,1] op_sel_hi:[1,1,1]
    v_mfma_f32_32x32x16_bf16 v[64:79], v[100:103], v[136:139], v[64:79]
    ds_read_b64_tr_b16 v[100:101], v17 offset:30720
    ds_read_b64_tr_b16 v[102:103], v17 offset:31744
    v_exp_f32 v48, v48
    v_mfma_f32_32x32x16_bf16 v[64:79], v[112:115], v[140:143], v[64:79]
    ds_read_b64_tr_b16 v[112:113], v16 offset:0
    ds_read_b64_tr_b16 v[114:115], v16 offset:1024
    s_waitcnt lgkmcnt(8)
    v_exp_f32 v49, v49
    v_exp_f32 v50, v50
    v_add_f32 v48, v9, v48
    v_mfma_f32_32x32x16_bf16 v[64:79], v[104:107], v[144:147], v[64:79]
    ds_read_b64_tr_b16 v[104:105], v16 offset:2048
    ds_read_b64_tr_b16 v[106:107], v16 offset:3072
    s_waitcnt lgkmcnt(8)
    v_exp_f32 v51, v51
    v_rcp_f32 v48, v48
    v_add_f32 v49, v9, v49
    v_mfma_f32_32x32x16_bf16 v[64:79], v[108:111], v[148:151], v[64:79]
    ds_read_b64_tr_b16 v[108:109], v16 offset:4096
    ds_read_b64_tr_b16 v[110:111], v16 offset:5120
    s_waitcnt lgkmcnt(8)
    v_exp_f32 v52, v52
    v_rcp_f32 v49, v49
    v_add_f32 v50, v9, v50
    v_mfma_f32_32x32x16_bf16 v[64:79], v[96:99], v[152:155], v[64:79]
    ds_read_b64_tr_b16 v[96:97], v16 offset:6144
    ds_read_b64_tr_b16 v[98:99], v16 offset:7168
    s_waitcnt lgkmcnt(8)
    v_exp_f32 v53, v53
    v_add_f32 v51, v9, v51
    v_add_f32 v52, v9, v52
    v_mul_f32 v80, v80, v48
    v_mfma_f32_32x32x16_bf16 v[64:79], v[100:103], v[156:159], v[64:79]
    ds_read_b64_tr_b16 v[100:101], v16 offset:8192
    ds_read_b64_tr_b16 v[102:103], v16 offset:9216
    s_waitcnt lgkmcnt(8)
    v_rcp_f32 v50, v50
    v_exp_f32 v54, v54
    v_add_f32 v53, v9, v53
    v_mfma_f32_32x32x16_bf16 v[64:79], v[112:115], v[160:163], v[64:79]
    ds_read_b64_tr_b16 v[112:113], v16 offset:10240
    ds_read_b64_tr_b16 v[114:115], v16 offset:11264
    s_waitcnt lgkmcnt(8)
    v_rcp_f32 v51, v51
    v_exp_f32 v55, v55
    v_add_f32 v54, v9, v54
    v_mfma_f32_32x32x16_bf16 v[64:79], v[104:107], v[164:167], v[64:79]
    ds_read_b32 v27, v24 offset:1152
    ds_read_b64_tr_b16 v[104:105], v16 offset:12288
    ds_read_b64_tr_b16 v[106:107], v16 offset:13312
    s_waitcnt lgkmcnt(9)
    v_rcp_f32 v52, v52
    v_add_f32 v55, v9, v55
    v_mfma_f32_32x32x16_bf16 v[64:79], v[108:111], v[168:171], v[64:79]
    ds_read_b64_tr_b16 v[108:109], v16 offset:14336
    ds_read_b64_tr_b16 v[110:111], v16 offset:15360
    s_waitcnt lgkmcnt(9)
    v_exp_f32 v56, v56
    v_mul_f32 v81, v81, v49
    v_mul_f32 v82, v82, v50
    s_waitcnt lgkmcnt(4)
    v_cmp_gt_u32 vcc, 33, v27
    v_mfma_f32_32x32x16_bf16 v[64:79], v[96:99], v[172:175], v[64:79]
    s_cbranch_vccnz Lst76
Lbk77:
    ds_read_b64_tr_b16 v[96:97], v17 offset:32768
    ds_read_b64_tr_b16 v[98:99], v17 offset:33792
    v_add_f32 v56, v9, v56
    v_mfma_f32_32x32x16_bf16 v[64:79], v[100:103], v[176:179], v[64:79]
    ds_read_b64_tr_b16 v[100:101], v17 offset:34816
    ds_read_b64_tr_b16 v[102:103], v17 offset:35840
    v_rcp_f32 v53, v53
    v_exp_f32 v57, v57
    v_cvt_pk_bf16_f32 v40, v80, v81
    v_mfma_f32_32x32x16_bf16 v[64:79], v[112:115], v[180:183], v[64:79]
    ds_read_b64_tr_b16 v[112:113], v17 offset:36864
    ds_read_b64_tr_b16 v[114:115], v17 offset:37888
    s_waitcnt lgkmcnt(8)
    v_rcp_f32 v54, v54
    v_add_f32 v57, v9, v57
    v_mul_f32 v83, v83, v51
    v_mul_f32 v84, v84, v52
    v_mfma_f32_32x32x16_bf16 v[64:79], v[104:107], v[184:187], v[64:79]
    ds_read_b64_tr_b16 v[104:105], v17 offset:38912
    ds_read_b64_tr_b16 v[106:107], v17 offset:39936
    s_waitcnt lgkmcnt(8)
    v_exp_f32 v58, v58
    v_rcp_f32 v55, v55
    v_cvt_pk_bf16_f32 v41, v82, v83
    v_mfma_f32_32x32x16_bf16 v[64:79], v[108:111], v[188:191], v[64:79]
    ds_read_b64_tr_b16 v[108:109], v17 offset:40960
    ds_read_b64_tr_b16 v[110:111], v17 offset:41984
    s_waitcnt lgkmcnt(8)
    v_exp_f32 v59, v59
    v_add_f32 v58, v9, v58
    v_mul_f32 v85, v85, v53
    v_mul_f32 v86, v86, v54
    v_mfma_f32_32x32x16_bf16 v[64:79], v[96:99], v[192:195], v[64:79]
    ds_read_b64_tr_b16 v[96:97], v17 offset:43008
    ds_read_b64_tr_b16 v[98:99], v17 offset:44032
    s_waitcnt lgkmcnt(8)
    v_rcp_f32 v56, v56
    v_exp_f32 v60, v60
    v_add_f32 v59, v9, v59
    v_mfma_f32_32x32x16_bf16 v[64:79], v[100:103], v[196:199], v[64:79]
    ds_read_b64_tr_b16 v[100:101], v17 offset:45056
    ds_read_b64_tr_b16 v[102:103], v17 offset:46080
    s_waitcnt lgkmcnt(8)
    v_rcp_f32 v57, v57
    v_add_f32 v60, v9, v60
    v_cvt_pk_bf16_f32 v42, v84, v85
    v_mul_f32 v87, v87, v55
    v_mfma_f32_32x32x16_bf16 v[64:79], v[112:115], v[200:203], v[64:79]
    ds_read_b64_tr_b16 v[112:113], v17 offset:47104
    ds_read_b64_tr_b16 v[114:115], v17 offset:48128
    s_waitcnt lgkmcnt(8)
    v_exp_f32 v61, v61
    v_rcp_f32 v58, v58
    v_cvt_pk_bf16_f32 v43, v86, v87
    v_mfma_f32_32x32x16_bf16 v[64:79], v[104:107], v[204:207], v[64:79]
    ds_read_b64_tr_b16 v[104:105], v17 offset:49152
    ds_read_b64_tr_b16 v[106:107], v17 offset:50176
    s_waitcnt lgkmcnt(8)
    s_add_u32 s87, s93, 2048
    buffer_store_dwordx4 v[40:43], v1, s[72:75], s87 offen offset:0 sc1
    v_exp_f32 v62, v62
    v_mfma_f32_32x32x16_bf16 v[64:79], v[108:111], v[208:211], v[64:79]
    ds_read_b64_tr_b16 v[108:109], v17 offset:51200
    ds_read_b64_tr_b16 v[110:111], v17 offset:52224
    s_waitcnt lgkmcnt(8)
    v_rcp_f32 v59, v59
    v_add_f32 v61, v9, v61
    v_add_f32 v62, v9, v62
    v_mul_f32 v88, v88, v56
    v_mfma_f32_32x32x16_bf16 v[64:79], v[96:99], v[212:215], v[64:79]
    ds_read_b64_tr_b16 v[96:97], v17 offset:53248
    ds_read_b64_tr_b16 v[98:99], v17 offset:54272
    s_waitcnt lgkmcnt(8)
    v_exp_f32 v63, v63
    v_rcp_f32 v60, v60
    v_mul_f32 v89, v89, v57
    v_mfma_f32_32x32x16_bf16 v[64:79], v[100:103], v[216:219], v[64:79]
    ds_read_b64_tr_b16 v[100:101], v17 offset:55296
    ds_read_b64_tr_b16 v[102:103], v17 offset:56320
    s_waitcnt lgkmcnt(8)
    v_rcp_f32 v61, v61
    v_add_f32 v63, v9, v63
    v_cvt_pk_bf16_f32 v44, v88, v89
    v_mul_f32 v90, v90, v58
    v_mfma_f32_32x32x16_bf16 v[64:79], v[112:115], v[220:223], v[64:79]
    ds_read_b64_tr_b16 v[112:113], v17 offset:57344
    ds_read_b64_tr_b16 v[114:115], v17 offset:58368
    s_waitcnt lgkmcnt(8)
    v_rcp_f32 v62, v62
    v_rcp_f32 v63, v63
    v_mul_f32 v91, v91, v59
    v_mfma_f32_32x32x16_bf16 v[64:79], v[104:107], v[224:227], v[64:79]
    ds_read_b64_tr_b16 v[104:105], v17 offset:59392
    ds_read_b64_tr_b16 v[106:107], v17 offset:60416
    s_waitcnt lgkmcnt(8)
    v_cvt_pk_bf16_f32 v45, v90, v91
    v_mul_f32 v92, v92, v60
    v_mul_f32 v93, v93, v61
    v_mul_f32 v94, v94, v62
    v_mul_f32 v95, v95, v63
    v_mfma_f32_32x32x16_bf16 v[64:79], v[108:111], v[228:231], v[64:79]
    ds_read_b64_tr_b16 v[108:109], v17 offset:61440
    ds_read_b64_tr_b16 v[110:111], v17 offset:62464
    s_waitcnt lgkmcnt(8)
    v_cvt_pk_bf16_f32 v46, v92, v93
    v_cvt_pk_bf16_f32 v47, v94, v95
    v_mfma_f32_32x32x16_bf16 v[64:79], v[96:99], v[232:235], v[64:79]
    ds_read_b64_tr_b16 v[96:97], v17 offset:63488
    ds_read_b64_tr_b16 v[98:99], v17 offset:64512
    s_waitcnt lgkmcnt(8)
    buffer_store_dwordx4 v[44:47], v1, s[72:75], s87 offen offset:1024 sc1
    v_mfma_f32_32x32x16_bf16 v[64:79], v[100:103], v[236:239], v[64:79]
    ds_read_b64_tr_b16 v[100:101], v19 offset:16384
    ds_read_b64_tr_b16 v[102:103], v19 offset:17408
    s_waitcnt lgkmcnt(8)
    ds_read_b128 v[48:51], v12 offset:256
    v_mfma_f32_32x32x16_bf16 v[64:79], v[112:115], v[240:243], v[64:79]
    ds_read_b64_tr_b16 v[112:113], v19 offset:18432
    ds_read_b64_tr_b16 v[114:115], v19 offset:19456
    s_waitcnt lgkmcnt(9)
    ds_read_b128 v[52:55], v12 offset:288
    v_mfma_f32_32x32x16_bf16 v[64:79], v[104:107], v[244:247], v[64:79]
    ds_read_b64_tr_b16 v[104:105], v19 offset:20480
    ds_read_b64_tr_b16 v[106:107], v19 offset:21504
    s_waitcnt lgkmcnt(10)
    ds_read_b128 v[56:59], v12 offset:320
    v_mfma_f32_32x32x16_bf16 v[64:79], v[108:111], v[248:251], v[64:79]
    ds_read_b64_tr_b16 v[108:109], v19 offset:22528
    ds_read_b64_tr_b16 v[110:111], v19 offset:23552
    s_waitcnt lgkmcnt(11)
    ds_read_b128 v[60:63], v12 offset:352
    v_mfma_f32_32x32x16_bf16 v[64:79], v[96:99], v[252:255], v[64:79]
    ds_read_b64_tr_b16 v[96:97], v19 offset:24576
    s_waitcnt lgkmcnt(12)
    ds_read_b64_tr_b16 v[98:99], v19 offset:25600
    s_waitcnt lgkmcnt(12)
    v_mfma_f32_32x32x16_bf16 v[80:95], v[100:103], v[128:131], 0
    ds_read_b64_tr_b16 v[100:101], v19 offset:26624
    s_waitcnt lgkmcnt(12)
    ds_read_b64_tr_b16 v[102:103], v19 offset:27648
    s_waitcnt lgkmcnt(11)
    v_mfma_f32_32x32x16_bf16 v[80:95], v[112:115], v[132:135], v[80:95]
    ds_read_b64_tr_b16 v[112:113], v19 offset:28672
    ds_read_b64_tr_b16 v[114:115], v19 offset:29696
    s_waitcnt lgkmcnt(10)
    v_pk_fma_f32 v[64:65], v[48:49], v[8:9], v[64:65] op_sel_hi:[1,0,1]
    v_pk_fma_f32 v[66:67], v[50:51], v[8:9], v[66:67] op_sel_hi:[1,0,1]
    v_pk_fma_f32 v[68:69], v[52:53], v[8:9], v[68:69] op_sel_hi:[1,0,1]
    v_pk_fma_f32 v[70:71], v[54:55], v[8:9], v[70:71] op_sel_hi:[1,0,1]
    s_waitcnt lgkmcnt(9)
    v_pk_fma_f32 v[72:73], v[56:57], v[8:9], v[72:73] op_sel_hi:[1,0,1]
    v_pk_fma_f32 v[74:75], v[58:59], v[8:9], v[74:75] op_sel_hi:[1,0,1]
    s_waitcnt lgkmcnt(6)
    v_pk_fma_f32 v[76:77], v[60:61], v[8:9], v[76:77] op_sel_hi:[1,0,1]
    v_pk_fma_f32 v[78:79], v[62:63], v[8:9], v[78:79] op_sel_hi:[1,0,1]
    v_pk_mul_f32 v[48:49], v[64:65], v[64:65]
    v_pk_mul_f32 v[50:51], v[66:67], v[66:67]
    v_pk_mul_f32 v[52:53], v[68:69], v[68:69]
    v_pk_mul_f32 v[54:55], v[70:71], v[70:71]
    v_pk_mul_f32 v[56:57], v[72:73], v[72:73]
    v_pk_mul_f32 v[58:59], v[74:75], v[74:75]
    v_pk_mul_f32 v[60:61], v[76:77], v[76:77]
    v_pk_mul_f32 v[62:63], v[78:79], v[78:79]
    v_pk_fma_f32 v[48:49], v[48:49], v[10:11], v[10:11] op_sel:[0,1,0] op_sel_hi:[1,1,0]
    v_pk_fma_f32 v[50:51], v[50:51], v[10:11], v[10:11] op_sel:[0,1,0] op_sel_hi:[1,1,0]
    v_pk_fma_f32 v[52:53], v[52:53], v[10:11], v[10:11] op_sel:[0,1,0] op_sel_hi:[1,1,0]
    v_pk_fma_f32 v[54:55], v[54:55], v[10:11], v[10:11] op_sel:[0,1,0] op_sel_hi:[1,1,0]
    v_pk_fma_f32 v[56:57], v[56:57], v[10:11], v[10:11] op_sel:[0,1,0] op_sel_hi:[1,1,0]
    v_pk_fma_f32 v[58:59], v[58:59], v[10:11], v[10:11] op_sel:[0,1,0] op_sel_hi:[1,1,0]
    v_pk_fma_f32 v[60:61], v[60:61], v[10:11], v[10:11] op_sel:[0,1,0] op_sel_hi:[1,1,0]
    v_pk_fma_f32 v[62:63], v[62:63], v[10:11], v[10:11] op_sel:[0,1,0] op_sel_hi:[1,1,0]
    v_pk_fma_f32 v[48:49], v[48:49], v[64:65], v[12:13] op_sel:[0,0,1] op_sel_hi:[1,1,1]
    v_pk_fma_f32 v[50:51], v[50:51], v[66:67], v[12:13] op_sel:[0,0,1] op_sel_hi:[1,1,1]
    v_pk_fma_f32 v[52:53], v[52:53], v[68:69], v[12:13] op_sel:[0,0,1] op_sel_hi:[1,1,1]
    v_pk_fma_f32 v[54:55], v[54:55], v[70:71], v[12:13] op_sel:[0,0,1] op_sel_hi:[1,1,1]
    v_pk_fma_f32 v[56:57], v[56:57], v[72:73], v[12:13] op_sel:[0,0,1] op_sel_hi:[1,1,1]
    v_pk_fma_f32 v[58:59], v[58:59], v[74:75], v[12:13] op_sel:[0,0,1] op_sel_hi:[1,1,1]
    v_pk_fma_f32 v[60:61], v[60:61], v[76:77], v[12:13] op_sel:[0,0,1] op_sel_hi:[1,1,1]
    v_pk_fma_f32 v[62:63], v[62:63], v[78:79], v[12:13] op_sel:[0,0,1] op_sel_hi:[1,1,1]
    v_mfma_f32_32x32x16_bf16 v[80:95], v[104:107], v[136:139], v[80:95]
    ds_read_b64_tr_b16 v[104:105], v19 offset:30720
    ds_read_b64_tr_b16 v[106:107], v19 offset:31744
    v_exp_f32 v48, v48
    v_mfma_f32_32x32x16_bf16 v[80:95], v[108:111], v[140:143], v[80:95]
    ds_read_b64_tr_b16 v[108:109], v18 offset:0
    ds_read_b64_tr_b16 v[110:111], v18 offset:1024
    s_waitcnt lgkmcnt(8)
    v_exp_f32 v49, v49
    v_exp_f32 v50, v50
    v_add_f32 v48, v9, v48
    v_mfma_f32_32x32x16_bf16 v[80:95], v[96:99], v[144:147], v[80:95]
    ds_read_b64_tr_b16 v[96:97], v18 offset:2048
    ds_read_b64_tr_b16 v[98:99], v18 offset:3072
    s_waitcnt lgkmcnt(8)
    v_exp_f32 v51, v51
    v_rcp_f32 v48, v48
    v_add_f32 v49, v9, v49
    v_mfma_f32_32x32x16_bf16 v[80:95], v[100:103], v[148:151], v[80:95]
    ds_read_b64_tr_b16 v[100:101], v18 offset:4096
    ds_read_b64_tr_b16 v[102:103], v18 offset:5120
    s_waitcnt lgkmcnt(8)
    v_exp_f32 v52, v52
    v_rcp_f32 v49, v49
    v_add_f32 v50, v9, v50
    v_mfma_f32_32x32x16_bf16 v[80:95], v[112:115], v[152:155], v[80:95]
    ds_read_b64_tr_b16 v[112:113], v18 offset:6144
    ds_read_b64_tr_b16 v[114:115], v18 offset:7168
    s_waitcnt lgkmcnt(8)
    v_exp_f32 v53, v53
    v_add_f32 v51, v9, v51
    v_add_f32 v52, v9, v52
    v_mul_f32 v64, v64, v48
    v_mfma_f32_32x32x16_bf16 v[80:95], v[104:107], v[156:159], v[80:95]
    ds_read_b64_tr_b16 v[104:105], v18 offset:8192
    ds_read_b64_tr_b16 v[106:107], v18 offset:9216
    s_waitcnt lgkmcnt(8)
    v_rcp_f32 v50, v50
    v_exp_f32 v54, v54
    v_add_f32 v53, v9, v53
    v_mfma_f32_32x32x16_bf16 v[80:95], v[108:111], v[160:163], v[80:95]
    ds_read_b64_tr_b16 v[108:109], v18 offset:10240
    ds_read_b64_tr_b16 v[110:111], v18 offset:11264
    s_waitcnt lgkmcnt(8)
    v_rcp_f32 v51, v51
    v_exp_f32 v55, v55
    v_add_f32 v54, v9, v54
    v_mfma_f32_32x32x16_bf16 v[80:95], v[96:99], v[164:167], v[80:95]
    ds_read_b64_tr_b16 v[96:97], v18 offset:12288
    ds_read_b64_tr_b16 v[98:99], v18 offset:13312
    s_waitcnt lgkmcnt(8)
    v_rcp_f32 v52, v52
    v_add_f32 v55, v9, v55
    v_mul_f32 v65, v65, v49
    v_mul_f32 v66, v66, v50
    v_mfma_f32_32x32x16_bf16 v[80:95], v[100:103], v[168:171], v[80:95]
    ds_read_b64_tr_b16 v[100:101], v18 offset:14336
    ds_read_b64_tr_b16 v[102:103], v18 offset:15360
    s_waitcnt lgkmcnt(8)
    s_waitcnt vmcnt(0)
    ds_add_u32 v25, v26
    v_exp_f32 v56, v56
    v_rcp_f32 v53, v53
    v_cvt_pk_bf16_f32 v116, v64, v65
    v_mfma_f32_32x32x16_bf16 v[80:95], v[112:115], v[172:175], v[80:95]
    ds_read_b32 v27, v24 offset:1536
    ds_read_b64_tr_b16 v[112:113], v19 offset:32768
    ds_read_b64_tr_b16 v[114:115], v19 offset:33792
    s_waitcnt lgkmcnt(10)
    v_exp_f32 v57, v57
    v_add_f32 v56, v9, v56
    v_mfma_f32_32x32x16_bf16 v[80:95], v[104:107], v[176:179], v[80:95]
    ds_read_b64_tr_b16 v[104:105], v19 offset:34816
    ds_read_b64_tr_b16 v[106:107], v19 offset:35840
    s_waitcnt lgkmcnt(10)
    v_rcp_f32 v54, v54
    v_add_f32 v57, v9, v57
    v_mul_f32 v67, v67, v51
    v_mul_f32 v68, v68, v52
    v_mul_f32 v69, v69, v53
    s_waitcnt lgkmcnt(4)
    v_cmp_gt_u32 vcc, 6, v27
    v_mfma_f32_32x32x16_bf16 v[80:95], v[108:111], v[180:183], v[80:95]
    s_cbranch_vccnz Lst78
Lbk79:
    ds_read_b64_tr_b16 v[108:109], v19 offset:36864
    ds_read_b64_tr_b16 v[110:111], v19 offset:37888
    v_exp_f32 v58, v58
    v_cvt_pk_bf16_f32 v117, v66, v67
    v_mfma_f32_32x32x16_bf16 v[80:95], v[96:99], v[184:187], v[80:95]
    ds_read_b64_tr_b16 v[96:97], v19 offset:38912
    ds_read_b64_tr_b16 v[98:99], v19 offset:39936
    v_rcp_f32 v55, v55
    v_exp_f32 v59, v59
    v_rcp_f32 v56, v56
    v_add_f32 v58, v9, v58
    v_mfma_f32_32x32x16_bf16 v[80:95], v[100:103], v[188:191], v[80:95]
    ds_read_b64_tr_b16 v[100:101], v19 offset:40960
    ds_read_b64_tr_b16 v[102:103], v19 offset:41984
    s_waitcnt lgkmcnt(8)
    v_exp_f32 v60, v60
    v_add_f32 v59, v9, v59
    v_cvt_pk_bf16_f32 v118, v68, v69
    v_mul_f32 v70, v70, v54
    v_mul_f32 v71, v71, v55
    v_mul_f32 v72, v72, v56
    v_mfma_f32_32x32x16_bf16 v[80:95], v[112:115], v[192:195], v[80:95]
    ds_read_b64_tr_b16 v[112:113], v19 offset:43008
    ds_read_b64_tr_b16 v[114:115], v19 offset:44032
    s_waitcnt lgkmcnt(8)
    v_rcp_f32 v57, v57
    v_exp_f32 v61, v61
    v_add_f32 v60, v9, v60
    v_mfma_f32_32x32x16_bf16 v[80:95], v[104:107], v[196:199], v[80:95]
    ds_read_b64_tr_b16 v[104:105], v19 offset:45056
    ds_read_b64_tr_b16 v[106:107], v19 offset:46080
    s_waitcnt lgkmcnt(8)
    v_rcp_f32 v58, v58
    v_exp_f32 v62, v62
    v_add_f32 v61, v9, v61
    v_mfma_f32_32x32x16_bf16 v[80:95], v[108:111], v[200:203], v[80:95]
    ds_read_b64_tr_b16 v[108:109], v19 offset:47104
    ds_read_b64_tr_b16 v[110:111], v19 offset:48128
    s_waitcnt lgkmcnt(8)
    v_rcp_f32 v59, v59
    v_add_f32 v62, v9, v62
    v_cvt_pk_bf16_f32 v119, v70, v71
    v_mul_f32 v73, v73, v57
    v_mfma_f32_32x32x16_bf16 v[80:95], v[96:99], v[204:207], v[80:95]
    ds_read_b64_tr_b16 v[96:97], v19 offset:49152
    ds_read_b64_tr_b16 v[98:99], v19 offset:50176
    s_waitcnt lgkmcnt(8)
    s_add_u32 s87, s93, 4096
    buffer_store_dwordx4 v[116:119], v1, s[72:75], s87 offen offset:0 sc1
    v_exp_f32 v63, v63
    v_mfma_f32_32x32x16_bf16 v[80:95], v[100:103], v[208:211], v[80:95]
    ds_read_b64_tr_b16 v[100:101], v19 offset:51200
    ds_read_b64_tr_b16 v[102:103], v19 offset:52224
    s_waitcnt lgkmcnt(8)
    v_rcp_f32 v60, v60
    v_add_f32 v63, v9, v63
    v_cvt_pk_bf16_f32 v120, v72, v73
    v_mul_f32 v74, v74, v58
    v_mfma_f32_32x32x16_bf16 v[80:95], v[112:115], v[212:215], v[80:95]
    ds_read_b32 v27, v24 offset:1152
    ds_read_b64_tr_b16 v[112:113], v19 offset:53248
    ds_read_b64_tr_b16 v[114:115], v19 offset:54272
    s_waitcnt lgkmcnt(9)
    v_rcp_f32 v61, v61
    v_mul_f32 v75, v75, v59
    v_mfma_f32_32x32x16_bf16 v[80:95], v[104:107], v[216:219], v[80:95]
    ds_read_b64_tr_b16 v[104:105], v19 offset:55296
    ds_read_b64_tr_b16 v[106:107], v19 offset:56320
    s_waitcnt lgkmcnt(9)
    v_rcp_f32 v62, v62
    v_rcp_f32 v63, v63
    v_cvt_pk_bf16_f32 v121, v74, v75
    v_mul_f32 v76, v76, v60
    s_waitcnt lgkmcnt(4)
    v_cmp_gt_u32 vcc, 34, v27
    v_mfma_f32_32x32x16_bf16 v[80:95], v[108:111], v[220:223], v[80:95]
    s_cbranch_vccnz Lst80
Lbk81:
    ds_read_b64_tr_b16 v[108:109], v19 offset:57344
    ds_read_b64_tr_b16 v[110:111], v19 offset:58368
    v_mul_f32 v77, v77, v61
    v_mfma_f32_32x32x16_bf16 v[80:95], v[96:99], v[224:227], v[80:95]
    ds_read_b64_tr_b16 v[96:97], v19 offset:59392
    ds_read_b64_tr_b16 v[98:99], v19 offset:60416
    v_cvt_pk_bf16_f32 v122, v76, v77
    v_mul_f32 v78, v78, v62
    v_mul_f32 v79, v79, v63
    v_mfma_f32_32x32x16_bf16 v[80:95], v[100:103], v[228:231], v[80:95]
    ds_read_b64_tr_b16 v[100:101], v19 offset:61440
    ds_read_b64_tr_b16 v[102:103], v19 offset:62464
    s_waitcnt lgkmcnt(8)
    v_cvt_pk_bf16_f32 v123, v78, v79
    v_mfma_f32_32x32x16_bf16 v[80:95], v[112:115], v[232:235], v[80:95]
    ds_read_b64_tr_b16 v[112:113], v19 offset:63488
    ds_read_b64_tr_b16 v[114:115], v19 offset:64512
    s_waitcnt lgkmcnt(8)
    buffer_store_dwordx4 v[120:123], v1, s[72:75], s87 offen offset:1024 sc1
    v_mfma_f32_32x32x16_bf16 v[80:95], v[104:107], v[236:239], v[80:95]
    s_waitcnt lgkmcnt(6)
    s_lshl_b32 s88, s42, 12
    s_add_u32 s88, s88, s92
    buffer_load_dwordx4 v[128:131], v1, s[72:75], s88 offen offset:0 sc1
    buffer_load_dwordx4 v[132:135], v1, s[72:75], s88 offen offset:1024 sc1
    v_mfma_f32_32x32x16_bf16 v[80:95], v[108:111], v[240:243], v[80:95]
    s_waitcnt lgkmcnt(4)
    buffer_load_dwordx4 v[136:139], v1, s[72:75], s88 offen offset:2048 sc1
    buffer_load_dwordx4 v[140:143], v1, s[72:75], s88 offen offset:3072 sc1
    ds_read_b128 v[48:51], v12 offset:384
    v_mfma_f32_32x32x16_bf16 v[80:95], v[96:99], v[244:247], v[80:95]
    s_waitcnt lgkmcnt(3)
    ds_read_b128 v[52:55], v12 offset:416
    ds_read_b128 v[56:59], v12 offset:448
    v_mfma_f32_32x32x16_bf16 v[80:95], v[100:103], v[248:251], v[80:95]
    s_waitcnt lgkmcnt(3)
    ds_read_b128 v[60:63], v12 offset:480
    v_mfma_f32_32x32x16_bf16 v[80:95], v[112:115], v[252:255], v[80:95]
    ds_read_b64_tr_b16 v[96:97], v124 offset:0
    ds_read_b64_tr_b16 v[98:99], v124 offset:1024
    ds_read_b64_tr_b16 v[100:101], v125 offset:0
    ds_read_b64_tr_b16 v[102:103], v125 offset:1024
    ds_read_b64_tr_b16 v[104:105], v126 offset:0
    ds_read_b64_tr_b16 v[106:107], v126 offset:1024
    ds_read_b64_tr_b16 v[108:109], v124 offset:2048
    ds_read_b64_tr_b16 v[110:111], v124 offset:3072
    ds_read_b64_tr_b16 v[112:113], v125 offset:2048
    s_waitcnt lgkmcnt(12)
    ds_read_b64_tr_b16 v[114:115], v125 offset:3072
    s_nop 0
    v_pk_fma_f32 v[80:81], v[48:49], v[8:9], v[80:81] op_sel_hi:[1,0,1]
    v_pk_fma_f32 v[82:83], v[50:51], v[8:9], v[82:83] op_sel_hi:[1,0,1]
    s_waitcnt lgkmcnt(12)
    v_pk_fma_f32 v[84:85], v[52:53], v[8:9], v[84:85] op_sel_hi:[1,0,1]
    v_pk_fma_f32 v[86:87], v[54:55], v[8:9], v[86:87] op_sel_hi:[1,0,1]
    v_pk_mul_f32 v[48:49], v[80:81], v[80:81]
    v_pk_mul_f32 v[50:51], v[82:83], v[82:83]
    v_pk_mul_f32 v[52:53], v[84:85], v[84:85]
    v_pk_mul_f32 v[54:55], v[86:87], v[86:87]
    v_pk_fma_f32 v[48:49], v[48:49], v[10:11], v[10:11] op_sel:[0,1,0] op_sel_hi:[1,1,0]
    v_pk_fma_f32 v[50:51], v[50:51], v[10:11], v[10:11] op_sel:[0,1,0] op_sel_hi:[1,1,0]
    v_pk_fma_f32 v[52:53], v[52:53], v[10:11], v[10:11] op_sel:[0,1,0] op_sel_hi:[1,1,0]
    v_pk_fma_f32 v[54:55], v[54:55], v[10:11], v[10:11] op_sel:[0,1,0] op_sel_hi:[1,1,0]
    v_pk_fma_f32 v[48:49], v[48:49], v[80:81], v[12:13] op_sel:[0,0,1] op_sel_hi:[1,1,1]
    v_pk_fma_f32 v[50:51], v[50:51], v[82:83], v[12:13] op_sel:[0,0,1] op_sel_hi:[1,1,1]
    v_pk_fma_f32 v[52:53], v[52:53], v[84:85], v[12:13] op_sel:[0,0,1] op_sel_hi:[1,1,1]
    v_pk_fma_f32 v[54:55], v[54:55], v[86:87], v[12:13] op_sel:[0,0,1] op_sel_hi:[1,1,1]
    v_exp_f32 v48, v48
    v_exp_f32 v49, v49
    v_exp_f32 v50, v50
    v_exp_f32 v51, v51
    v_exp_f32 v52, v52
    v_exp_f32 v53, v53
    v_exp_f32 v54, v54
    v_exp_f32 v55, v55
    v_pk_add_f32 v[48:49], v[48:49], v[8:9] op_sel:[0,1] op_sel_hi:[1,1]
    v_pk_add_f32 v[50:51], v[50:51], v[8:9] op_sel:[0,1] op_sel_hi:[1,1]
    v_pk_add_f32 v[52:53], v[52:53], v[8:9] op_sel:[0,1] op_sel_hi:[1,1]
    v_pk_add_f32 v[54:55], v[54:55], v[8:9] op_sel:[0,1] op_sel_hi:[1,1]
    v_rcp_f32 v48, v48
    v_rcp_f32 v49, v49
    v_rcp_f32 v50, v50
    v_rcp_f32 v51, v51
    v_rcp_f32 v52, v52
    v_rcp_f32 v53, v53
    v_rcp_f32 v54, v54
    v_rcp_f32 v55, v55
    v_pk_mul_f32 v[80:81], v[80:81], v[48:49]
    v_pk_mul_f32 v[82:83], v[82:83], v[50:51]
    v_pk_mul_f32 v[84:85], v[84:85], v[52:53]
    v_pk_mul_f32 v[86:87], v[86:87], v[54:55]
    v_cvt_pk_bf16_f32 v240, v80, v81
    v_cvt_pk_bf16_f32 v241, v82, v83
    v_cvt_pk_bf16_f32 v242, v84, v85
    v_cvt_pk_bf16_f32 v243, v86, v87
    s_add_u32 s87, s93, 6144
    buffer_store_dwordx4 v[240:243], v1, s[72:75], s87 offen offset:0 sc1
    s_waitcnt lgkmcnt(11)
    v_pk_fma_f32 v[88:89], v[56:57], v[8:9], v[88:89] op_sel_hi:[1,0,1]
    v_pk_fma_f32 v[90:91], v[58:59], v[8:9], v[90:91] op_sel_hi:[1,0,1]
    s_waitcnt lgkmcnt(10)
    v_pk_fma_f32 v[92:93], v[60:61], v[8:9], v[92:93] op_sel_hi:[1,0,1]
    v_pk_fma_f32 v[94:95], v[62:63], v[8:9], v[94:95] op_sel_hi:[1,0,1]
    v_pk_mul_f32 v[56:57], v[88:89], v[88:89]
    v_pk_mul_f32 v[58:59], v[90:91], v[90:91]
    v_pk_mul_f32 v[60:61], v[92:93], v[92:93]
    v_pk_mul_f32 v[62:63], v[94:95], v[94:95]
    v_pk_fma_f32 v[56:57], v[56:57], v[10:11], v[10:11] op_sel:[0,1,0] op_sel_hi:[1,1,0]
    v_pk_fma_f32 v[58:59], v[58:59], v[10:11], v[10:11] op_sel:[0,1,0] op_sel_hi:[1,1,0]
    v_pk_fma_f32 v[60:61], v[60:61], v[10:11], v[10:11] op_sel:[0,1,0] op_sel_hi:[1,1,0]
    v_pk_fma_f32 v[62:63], v[62:63], v[10:11], v[10:11] op_sel:[0,1,0] op_sel_hi:[1,1,0]
    v_pk_fma_f32 v[56:57], v[56:57], v[88:89], v[12:13] op_sel:[0,0,1] op_sel_hi:[1,1,1]
    v_pk_fma_f32 v[58:59], v[58:59], v[90:91], v[12:13] op_sel:[0,0,1] op_sel_hi:[1,1,1]
    v_pk_fma_f32 v[60:61], v[60:61], v[92:93], v[12:13] op_sel:[0,0,1] op_sel_hi:[1,1,1]
    v_pk_fma_f32 v[62:63], v[62:63], v[94:95], v[12:13] op_sel:[0,0,1] op_sel_hi:[1,1,1]
    v_exp_f32 v56, v56
    v_exp_f32 v57, v57
    v_exp_f32 v58, v58
    v_exp_f32 v59, v59
    v_exp_f32 v60, v60
    v_exp_f32 v61, v61
    v_exp_f32 v62, v62
    v_exp_f32 v63, v63
    v_pk_add_f32 v[56:57], v[56:57], v[8:9] op_sel:[0,1] op_sel_hi:[1,1]
    v_pk_add_f32 v[58:59], v[58:59], v[8:9] op_sel:[0,1] op_sel_hi:[1,1]
    v_pk_add_f32 v[60:61], v[60:61], v[8:9] op_sel:[0,1] op_sel_hi:[1,1]
    v_pk_add_f32 v[62:63], v[62:63], v[8:9] op_sel:[0,1] op_sel_hi:[1,1]
    v_rcp_f32 v56, v56
    v_rcp_f32 v57, v57
    v_rcp_f32 v58, v58
    v_rcp_f32 v59, v59
    v_rcp_f32 v60, v60
    v_rcp_f32 v61, v61
    v_rcp_f32 v62, v62
    v_rcp_f32 v63, v63
    v_pk_mul_f32 v[88:89], v[88:89], v[56:57]
    v_pk_mul_f32 v[90:91], v[90:91], v[58:59]
    v_pk_mul_f32 v[92:93], v[92:93], v[60:61]
    v_pk_mul_f32 v[94:95], v[94:95], v[62:63]
    v_cvt_pk_bf16_f32 v244, v88, v89
    v_cvt_pk_bf16_f32 v245, v90, v91
    v_cvt_pk_bf16_f32 v246, v92, v93
    v_cvt_pk_bf16_f32 v247, v94, v95
    buffer_store_dwordx4 v[244:247], v1, s[72:75], s87 offen offset:1024 sc1
Lsj73:
    s_waitcnt lgkmcnt(8)
    v_mfma_f32_32x32x16_bf16 v[48:63], v[96:99], v[32:35], 0
    ds_read_b64_tr_b16 v[96:97], v126 offset:2048
    ds_read_b64_tr_b16 v[98:99], v126 offset:3072
    s_waitcnt lgkmcnt(8)
    v_mfma_f32_32x32x16_bf16 v[64:79], v[100:103], v[32:35], 0
    ds_read_b32 v27, v24 offset:1536
    ds_read_b64_tr_b16 v[100:101], v124 offset:4096
    ds_read_b64_tr_b16 v[102:103], v124 offset:5120
    s_waitcnt lgkmcnt(9)
    v_mfma_f32_32x32x16_bf16 v[80:95], v[104:107], v[32:35], 0
    ds_read_b64_tr_b16 v[104:105], v125 offset:4096
    ds_read_b64_tr_b16 v[106:107], v125 offset:5120
    s_waitcnt lgkmcnt(9)
    s_waitcnt lgkmcnt(4)
    v_cmp_gt_u32 vcc, 7, v27
    v_mfma_f32_32x32x16_bf16 v[48:63], v[108:111], v[36:39], v[48:63]
    s_cbranch_vccnz Lst86
Lbk87:
    ds_read_b64_tr_b16 v[108:109], v126 offset:4096
    ds_read_b64_tr_b16 v[110:111], v126 offset:5120
    v_mfma_f32_32x32x16_bf16 v[64:79], v[112:115], v[36:39], v[64:79]
    ds_read_b64_tr_b16 v[112:113], v124 offset:6144
    ds_read_b64_tr_b16 v[114:115], v124 offset:7168
    s_lshl_b32 s88, s43, 12
    s_add_u32 s88, s88, s92
    v_mfma_f32_32x32x16_bf16 v[80:95], v[96:99], v[36:39], v[80:95]
    ds_read_b64_tr_b16 v[96:97], v125 offset:6144
    ds_read_b64_tr_b16 v[98:99], v125 offset:7168
    s_waitcnt lgkmcnt(8)
    buffer_load_dwordx4 v[144:147], v1, s[72:75], s88 offen offset:0 sc1
    v_mfma_f32_32x32x16_bf16 v[48:63], v[100:103], v[40:43], v[48:63]
    ds_read_b64_tr_b16 v[100:101], v126 offset:6144
    ds_read_b64_tr_b16 v[102:103], v126 offset:7168
    s_waitcnt lgkmcnt(8)
    v_mfma_f32_32x32x16_bf16 v[64:79], v[104:107], v[40:43], v[64:79]
    ds_read_b64_tr_b16 v[104:105], v124 offset:16384
    ds_read_b64_tr_b16 v[106:107], v124 offset:17408
    s_waitcnt lgkmcnt(8)
    buffer_load_dwordx4 v[148:151], v1, s[72:75], s88 offen offset:1024 sc1
    v_mfma_f32_32x32x16_bf16 v[80:95], v[108:111], v[40:43], v[80:95]
    ds_read_b64_tr_b16 v[108:109], v125 offset:16384
    ds_read_b64_tr_b16 v[110:111], v125 offset:17408
    s_waitcnt lgkmcnt(8)
    v_mfma_f32_32x32x16_bf16 v[48:63], v[112:115], v[44:47], v[48:63]
    ds_read_b64_tr_b16 v[112:113], v126 offset:16384
    ds_read_b64_tr_b16 v[114:115], v126 offset:17408
    s_waitcnt lgkmcnt(8)
    buffer_load_dwordx4 v[152:155], v1, s[72:75], s88 offen offset:2048 sc1
    v_mfma_f32_32x32x16_bf16 v[64:79], v[96:99], v[44:47], v[64:79]
    ds_read_b64_tr_b16 v[96:97], v124 offset:18432
    ds_read_b64_tr_b16 v[98:99], v124 offset:19456
    s_waitcnt lgkmcnt(8)
    v_mfma_f32_32x32x16_bf16 v[80:95], v[100:103], v[44:47], v[80:95]
    ds_read_b64_tr_b16 v[100:101], v125 offset:18432
    ds_read_b64_tr_b16 v[102:103], v125 offset:19456
    s_waitcnt lgkmcnt(8)
    buffer_load_dwordx4 v[156:159], v1, s[72:75], s88 offen offset:3072 sc1
    v_mfma_f32_32x32x16_bf16 v[48:63], v[104:107], v[116:119], v[48:63]
    ds_read_b64_tr_b16 v[104:105], v126 offset:18432
    ds_read_b64_tr_b16 v[106:107], v126 offset:19456
    s_waitcnt lgkmcnt(8)
    s_lshl_b32 s88, s44, 12
    s_add_u32 s88, s88, s92
    v_mfma_f32_32x32x16_bf16 v[64:79], v[108:111], v[116:119], v[64:79]
    ds_read_b64_tr_b16 v[108:109], v124 offset:20480
    ds_read_b64_tr_b16 v[110:111], v124 offset:21504
    s_waitcnt lgkmcnt(8)
    buffer_load_dwordx4 v[160:163], v1, s[72:75], s88 offen offset:0 sc1
    v_mfma_f32_32x32x16_bf16 v[80:95], v[112:115], v[116:119], v[80:95]
    ds_read_b64_tr_b16 v[112:113], v125 offset:20480
    ds_read_b64_tr_b16 v[114:115], v125 offset:21504
    s_waitcnt lgkmcnt(8)
    v_mfma_f32_32x32x16_bf16 v[48:63], v[96:99], v[120:123], v[48:63]
    ds_read_b64_tr_b16 v[96:97], v126 offset:20480
    ds_read_b64_tr_b16 v[98:99], v126 offset:21504
    s_waitcnt lgkmcnt(8)
    buffer_load_dwordx4 v[164:167], v1, s[72:75], s88 offen offset:1024 sc1
    v_mfma_f32_32x32x16_bf16 v[64:79], v[100:103], v[120:123], v[64:79]
    ds_read_b64_tr_b16 v[100:101], v124 offset:22528
    ds_read_b64_tr_b16 v[102:103], v124 offset:23552
    s_waitcnt lgkmcnt(8)
    v_mfma_f32_32x32x16_bf16 v[80:95], v[104:107], v[120:123], v[80:95]
    ds_read_b64_tr_b16 v[104:105], v125 offset:22528
    ds_read_b64_tr_b16 v[106:107], v125 offset:23552
    s_waitcnt lgkmcnt(8)
    buffer_load_dwordx4 v[168:171], v1, s[72:75], s88 offen offset:2048 sc1
    v_mfma_f32_32x32x16_bf16 v[48:63], v[108:111], v[240:243], v[48:63]
    ds_read_b64_tr_b16 v[108:109], v126 offset:22528
    ds_read_b64_tr_b16 v[110:111], v126 offset:23552
    s_waitcnt lgkmcnt(8)
    s_waitcnt vmcnt(7)
    ds_add_u32 v25, v26
    v_mfma_f32_32x32x16_bf16 v[64:79], v[112:115], v[240:243], v[64:79]
    ds_read_b64_tr_b16 v[112:113], v124 offset:32768
    ds_read_b64_tr_b16 v[114:115], v124 offset:33792
    s_waitcnt lgkmcnt(9)
    buffer_load_dwordx4 v[172:175], v1, s[72:75], s88 offen offset:3072 sc1
    v_mfma_f32_32x32x16_bf16 v[80:95], v[96:99], v[240:243], v[80:95]
    ds_read_b64_tr_b16 v[96:97], v125 offset:32768
    ds_read_b64_tr_b16 v[98:99], v125 offset:33792
    s_waitcnt lgkmcnt(9)
    s_lshl_b32 s88, s45, 12
    s_add_u32 s88, s88, s92
    v_mfma_f32_32x32x16_bf16 v[48:63], v[100:103], v[244:247], v[48:63]
    ds_read_b64_tr_b16 v[100:101], v126 offset:32768
    ds_read_b64_tr_b16 v[102:103], v126 offset:33792
    s_waitcnt lgkmcnt(9)
    buffer_load_dwordx4 v[176:179], v1, s[72:75], s88 offen offset:0 sc1
    v_mfma_f32_32x32x16_bf16 v[64:79], v[104:107], v[244:247], v[64:79]
    ds_read_b64_tr_b16 v[104:105], v124 offset:34816
    ds_read_b64_tr_b16 v[106:107], v124 offset:35840
    s_waitcnt lgkmcnt(9)
    v_mfma_f32_32x32x16_bf16 v[80:95], v[108:111], v[244:247], v[80:95]
    ds_read_b64_tr_b16 v[108:109], v125 offset:34816
    ds_read_b64_tr_b16 v[110:111], v125 offset:35840
    s_waitcnt lgkmcnt(8)
    buffer_load_dwordx4 v[180:183], v1, s[72:75], s88 offen offset:1024 sc1
    v_mfma_f32_32x32x16_bf16 v[48:63], v[112:115], v[128:131], v[48:63]
    ds_read_b64_tr_b16 v[112:113], v126 offset:34816
    ds_read_b64_tr_b16 v[114:115], v126 offset:35840
    s_waitcnt lgkmcnt(8)
    v_mfma_f32_32x32x16_bf16 v[64:79], v[96:99], v[128:131], v[64:79]
    ds_read_b64_tr_b16 v[96:97], v124 offset:36864
    ds_read_b64_tr_b16 v[98:99], v124 offset:37888
    s_waitcnt lgkmcnt(8)
    buffer_load_dwordx4 v[184:187], v1, s[72:75], s88 offen offset:2048 sc1
    v_mfma_f32_32x32x16_bf16 v[80:95], v[100:103], v[128:131], v[80:95]
    ds_read_b64_tr_b16 v[100:101], v125 offset:36864
    ds_read_b64_tr_b16 v[102:103], v125 offset:37888
    s_waitcnt lgkmcnt(8)
    v_mfma_f32_32x32x16_bf16 v[48:63], v[104:107], v[132:135], v[48:63]
    ds_read_b64_tr_b16 v[104:105], v126 offset:36864
    ds_read_b64_tr_b16 v[106:107], v126 offset:37888
    s_waitcnt lgkmcnt(8)
    buffer_load_dwordx4 v[188:191], v1, s[72:75], s88 offen offset:3072 sc1
    v_mfma_f32_32x32x16_bf16 v[64:79], v[108:111], v[132:135], v[64:79]
    ds_read_b64_tr_b16 v[108:109], v124 offset:38912
    ds_read_b64_tr_b16 v[110:111], v124 offset:39936
    s_waitcnt lgkmcnt(8)
    buffer_load_dwordx4 v[16:19], v1, s[72:75], s94 offen offset:0 sc1
    v_mfma_f32_32x32x16_bf16 v[80:95], v[112:115], v[132:135], v[80:95]
    ds_read_b64_tr_b16 v[112:113], v125 offset:38912
    ds_read_b64_tr_b16 v[114:115], v125 offset:39936
    s_waitcnt lgkmcnt(8)
    buffer_load_dwordx4 v[20:23], v1, s[72:75], s94 offen offset:1024 sc1
    v_mfma_f32_32x32x16_bf16 v[48:63], v[96:99], v[136:139], v[48:63]
    ds_read_b64_tr_b16 v[96:97], v126 offset:38912
    ds_read_b64_tr_b16 v[98:99], v126 offset:39936
    s_waitcnt lgkmcnt(8)
    s_mov_b32 s89, 1
    s_add_u32 s6, s100, 1
    s_and_b32 s6, s6, 3
    s_lshl_b32 s6, s6, 8
    v_mfma_f32_32x32x16_bf16 v[64:79], v[100:103], v[136:139], v[64:79]
    ds_read_b64_tr_b16 v[100:101], v124 offset:49152
    ds_read_b64_tr_b16 v[102:103], v124 offset:50176
    s_waitcnt lgkmcnt(8)
    s_add_u32 s6, s6, s33
    s_add_u32 s84, s6, 32
    s_add_u32 s6, s100, 2
    s_and_b32 s6, s6, 3
    v_mfma_f32_32x32x16_bf16 v[80:95], v[104:107], v[136:139], v[80:95]
    ds_read_b64_tr_b16 v[104:105], v125 offset:49152
    ds_read_b64_tr_b16 v[106:107], v125 offset:50176
    s_waitcnt lgkmcnt(8)
    s_lshl_b32 s6, s6, 8
    s_add_u32 s6, s6, s33
    s_add_u32 s85, s6, 32
    s_add_u32 s6, s100, 3
    v_mfma_f32_32x32x16_bf16 v[48:63], v[108:111], v[140:143], v[48:63]
    ds_read_b32 v27, v24 offset:1152
    ds_read_b64_tr_b16 v[108:109], v126 offset:49152
    ds_read_b64_tr_b16 v[110:111], v126 offset:50176
    s_waitcnt lgkmcnt(9)
    s_and_b32 s6, s6, 3
    v_mfma_f32_32x32x16_bf16 v[64:79], v[112:115], v[140:143], v[64:79]
    ds_read_b64_tr_b16 v[112:113], v124 offset:51200
    ds_read_b64_tr_b16 v[114:115], v124 offset:52224
    s_waitcnt lgkmcnt(9)
    s_lshl_b32 s6, s6, 8
    s_add_u32 s6, s6, s33
    s_waitcnt lgkmcnt(4)
    v_cmp_gt_u32 vcc, 35, v27
    v_mfma_f32_32x32x16_bf16 v[80:95], v[96:99], v[140:143], v[80:95]
    s_cbranch_vccnz Lst88
Lbk89:
    ds_read_b64_tr_b16 v[96:97], v125 offset:51200
    ds_read_b64_tr_b16 v[98:99], v125 offset:52224
    s_waitcnt vmcnt(13)
    v_mfma_f32_32x32x16_bf16 v[48:63], v[100:103], v[144:147], v[48:63]
    ds_read_b64_tr_b16 v[100:101], v126 offset:51200
    ds_read_b64_tr_b16 v[102:103], v126 offset:52224
    s_add_u32 s86, s6, 40
    v_lshl_add_u32 v2, v15, 2, v0
    v_add_u32 v2, 0, v2
    v_mfma_f32_32x32x16_bf16 v[64:79], v[104:107], v[144:147], v[64:79]
    ds_read_b64_tr_b16 v[104:105], v124 offset:53248
    ds_read_b64_tr_b16 v[106:107], v124 offset:54272
    s_waitcnt lgkmcnt(8)
    v_and_b32 v2, 31, v2
    v_lshlrev_b32 v2, 4, v2
    v_lshl_add_u32 v2, v15, 9, v2
    v_mfma_f32_32x32x16_bf16 v[80:95], v[108:111], v[144:147], v[80:95]
    ds_read_b64_tr_b16 v[108:109], v125 offset:53248
    ds_read_b64_tr_b16 v[110:111], v125 offset:54272
    s_waitcnt lgkmcnt(8)
    v_lshl_add_u32 v3, v15, 2, v0
    v_add_u32 v3, 8, v3
    v_and_b32 v3, 31, v3
    s_waitcnt vmcnt(12)
    v_mfma_f32_32x32x16_bf16 v[48:63], v[112:115], v[148:151], v[48:63]
    ds_read_b64_tr_b16 v[112:113], v126 offset:53248
    ds_read_b64_tr_b16 v[114:115], v126 offset:54272
    s_waitcnt lgkmcnt(8)
    v_lshlrev_b32 v3, 4, v3
    v_lshl_add_u32 v3, v15, 9, v3
    v_mfma_f32_32x32x16_bf16 v[64:79], v[96:99], v[148:151], v[64:79]
    ds_read_b64_tr_b16 v[96:97], v124 offset:55296
    ds_read_b64_tr_b16 v[98:99], v124 offset:56320
    s_waitcnt lgkmcnt(8)
    v_mfma_f32_32x32x16_bf16 v[80:95], v[100:103], v[148:151], v[80:95]
    ds_read_b64_tr_b16 v[100:101], v125 offset:55296
    ds_read_b64_tr_b16 v[102:103], v125 offset:56320
    s_waitcnt lgkmcnt(8)
    s_waitcnt vmcnt(11)
    v_mfma_f32_32x32x16_bf16 v[48:63], v[104:107], v[152:155], v[48:63]
    ds_read_b64_tr_b16 v[104:105], v126 offset:55296
    ds_read_b64_tr_b16 v[106:107], v126 offset:56320
    s_waitcnt lgkmcnt(8)
    v_mfma_f32_32x32x16_bf16 v[64:79], v[108:111], v[152:155], v[64:79]
    v_add_u32 v124, 65536, v124
    ds_read_b64_tr_b16 v[108:109], v124 offset:49152
    ds_read_b64_tr_b16 v[110:111], v124 offset:50176
    s_waitcnt lgkmcnt(8)
    v_mfma_f32_32x32x16_bf16 v[80:95], v[112:115], v[152:155], v[80:95]
    v_add_u32 v125, 65536, v125
    ds_read_b64_tr_b16 v[112:113], v125 offset:49152
    ds_read_b64_tr_b16 v[114:115], v125 offset:50176
    s_waitcnt lgkmcnt(8)
    s_waitcnt vmcnt(10)
    v_mfma_f32_32x32x16_bf16 v[48:63], v[96:99], v[156:159], v[48:63]
    v_add_u32 v126, 65536, v126
    ds_read_b64_tr_b16 v[96:97], v126 offset:49152
    ds_read_b64_tr_b16 v[98:99], v126 offset:50176
    s_waitcnt lgkmcnt(8)
    v_mfma_f32_32x32x16_bf16 v[64:79], v[100:103], v[156:159], v[64:79]
    ds_read_b64_tr_b16 v[100:101], v124 offset:51200
    ds_read_b64_tr_b16 v[102:103], v124 offset:52224
    s_waitcnt lgkmcnt(8)
    v_mfma_f32_32x32x16_bf16 v[80:95], v[104:107], v[156:159], v[80:95]
    ds_read_b64_tr_b16 v[104:105], v125 offset:51200
    ds_read_b64_tr_b16 v[106:107], v125 offset:52224
    s_waitcnt lgkmcnt(8)
    s_waitcnt vmcnt(9)
    v_mfma_f32_32x32x16_bf16 v[48:63], v[108:111], v[160:163], v[48:63]
    ds_read_b64_tr_b16 v[108:109], v126 offset:51200
    ds_read_b64_tr_b16 v[110:111], v126 offset:52224
    s_waitcnt lgkmcnt(8)
    v_mfma_f32_32x32x16_bf16 v[64:79], v[112:115], v[160:163], v[64:79]
    ds_read_b64_tr_b16 v[112:113], v124 offset:53248
    ds_read_b64_tr_b16 v[114:115], v124 offset:54272
    s_waitcnt lgkmcnt(8)
    v_mfma_f32_32x32x16_bf16 v[80:95], v[96:99], v[160:163], v[80:95]
    ds_read_b32 v27, v24 offset:1536
    ds_read_b64_tr_b16 v[96:97], v125 offset:53248
    ds_read_b64_tr_b16 v[98:99], v125 offset:54272
    s_waitcnt lgkmcnt(9)
    s_waitcnt vmcnt(8)
    v_mfma_f32_32x32x16_bf16 v[48:63], v[100:103], v[164:167], v[48:63]
    ds_read_b64_tr_b16 v[100:101], v126 offset:53248
    ds_read_b64_tr_b16 v[102:103], v126 offset:54272
    s_waitcnt lgkmcnt(9)
    s_waitcnt lgkmcnt(4)
    v_cmp_gt_u32 vcc, 8, v27
    v_mfma_f32_32x32x16_bf16 v[64:79], v[104:107], v[164:167], v[64:79]
    s_cbranch_vccnz Lst90
Lbk91:
    ds_read_b64_tr_b16 v[104:105], v124 offset:55296
    ds_read_b64_tr_b16 v[106:107], v124 offset:56320
    v_mfma_f32_32x32x16_bf16 v[80:95], v[108:111], v[164:167], v[80:95]
    ds_read_b64_tr_b16 v[108:109], v125 offset:55296
    ds_read_b64_tr_b16 v[110:111], v125 offset:56320
    s_lshl_b32 s88, s46, 12
    s_add_u32 s88, s88, s92
    s_waitcnt vmcnt(7)
    v_mfma_f32_32x32x16_bf16 v[48:63], v[112:115], v[168:171], v[48:63]
    ds_read_b64_tr_b16 v[112:113], v126 offset:55296
    ds_read_b64_tr_b16 v[114:115], v126 offset:56320
    s_waitcnt lgkmcnt(8)
    buffer_load_dwordx4 v[192:195], v1, s[72:75], s88 offen offset:0 sc1
    v_mfma_f32_32x32x16_bf16 v[64:79], v[96:99], v[168:171], v[64:79]
    ds_read_b64_tr_b16 v[96:97], v124 offset:0
    ds_read_b64_tr_b16 v[98:99], v124 offset:1024
    s_waitcnt lgkmcnt(8)
    buffer_load_dwordx4 v[196:199], v1, s[72:75], s88 offen offset:1024 sc1
    v_mfma_f32_32x32x16_bf16 v[80:95], v[100:103], v[168:171], v[80:95]
    ds_read_b64_tr_b16 v[100:101], v125 offset:0
    ds_read_b64_tr_b16 v[102:103], v125 offset:1024
    s_waitcnt lgkmcnt(8)
    buffer_load_dwordx4 v[200:203], v1, s[72:75], s88 offen offset:2048 sc1
    s_waitcnt vmcnt(9)
    v_mfma_f32_32x32x16_bf16 v[48:63], v[104:107], v[172:175], v[48:63]
    ds_read_b64_tr_b16 v[104:105], v126 offset:0
    ds_read_b64_tr_b16 v[106:107], v126 offset:1024
    s_waitcnt lgkmcnt(8)
    buffer_load_dwordx4 v[204:207], v1, s[72:75], s88 offen offset:3072 sc1
    v_mfma_f32_32x32x16_bf16 v[64:79], v[108:111], v[172:175], v[64:79]
    ds_read_b64_tr_b16 v[108:109], v124 offset:2048
    ds_read_b64_tr_b16 v[110:111], v124 offset:3072
    s_waitcnt lgkmcnt(8)
    s_lshl_b32 s88, s47, 12
    s_add_u32 s88, s88, s92
    v_mfma_f32_32x32x16_bf16 v[80:95], v[112:115], v[172:175], v[80:95]
    ds_read_b64_tr_b16 v[112:113], v125 offset:2048
    ds_read_b64_tr_b16 v[114:115], v125 offset:3072
    s_waitcnt lgkmcnt(8)
    buffer_load_dwordx4 v[208:211], v1, s[72:75], s88 offen offset:0 sc1
    s_waitcnt vmcnt(10)
    v_mfma_f32_32x32x16_bf16 v[48:63], v[96:99], v[176:179], v[48:63]
    ds_read_b64_tr_b16 v[96:97], v126 offset:2048
    ds_read_b64_tr_b16 v[98:99], v126 offset:3072
    s_waitcnt lgkmcnt(8)
    buffer_load_dwordx4 v[212:215], v1, s[72:75], s88 offen offset:1024 sc1
    v_mfma_f32_32x32x16_bf16 v[64:79], v[100:103], v[176:179], v[64:79]
    ds_read_b64_tr_b16 v[100:101], v124 offset:4096
    ds_read_b64_tr_b16 v[102:103], v124 offset:5120
    s_waitcnt lgkmcnt(8)
    buffer_load_dwordx4 v[216:219], v1, s[72:75], s88 offen offset:2048 sc1
    v_mfma_f32_32x32x16_bf16 v[80:95], v[104:107], v[176:179], v[80:95]
    ds_read_b64_tr_b16 v[104:105], v125 offset:4096
    ds_read_b64_tr_b16 v[106:107], v125 offset:5120
    s_waitcnt lgkmcnt(8)
    buffer_load_dwordx4 v[220:223], v1, s[72:75], s88 offen offset:3072 sc1
    s_waitcnt vmcnt(12)
    v_mfma_f32_32x32x16_bf16 v[48:63], v[108:111], v[180:183], v[48:63]
    ds_read_b64_tr_b16 v[108:109], v126 offset:4096
    ds_read_b64_tr_b16 v[110:111], v126 offset:5120
    s_waitcnt lgkmcnt(8)
    s_lshl_b32 s88, s48, 12
    s_add_u32 s88, s88, s92
    v_mfma_f32_32x32x16_bf16 v[64:79], v[112:115], v[180:183], v[64:79]
    ds_read_b64_tr_b16 v[112:113], v124 offset:6144
    ds_read_b64_tr_b16 v[114:115], v124 offset:7168
    s_waitcnt lgkmcnt(8)
    buffer_load_dwordx4 v[224:227], v1, s[72:75], s88 offen offset:0 sc1
    v_mfma_f32_32x32x16_bf16 v[80:95], v[96:99], v[180:183], v[80:95]
    ds_read_b32 v27, v24 offset:1152
    ds_read_b64_tr_b16 v[96:97], v125 offset:6144
    ds_read_b64_tr_b16 v[98:99], v125 offset:7168
    s_waitcnt lgkmcnt(9)
    s_waitcnt vmcnt(12)
    v_mfma_f32_32x32x16_bf16 v[48:63], v[100:103], v[184:187], v[48:63]
    ds_read_b64_tr_b16 v[100:101], v126 offset:6144
    ds_read_b64_tr_b16 v[102:103], v126 offset:7168
    s_waitcnt lgkmcnt(9)
    s_waitcnt lgkmcnt(4)
    v_cmp_gt_u32 vcc, 38, v27
    v_mfma_f32_32x32x16_bf16 v[64:79], v[104:107], v[184:187], v[64:79]
    s_cbranch_vccnz Lst92
Lbk93:
    ds_read_b64_tr_b16 v[104:105], v124 offset:16384
    ds_read_b64_tr_b16 v[106:107], v124 offset:17408
    v_mfma_f32_32x32x16_bf16 v[80:95], v[108:111], v[184:187], v[80:95]
    ds_read_b64_tr_b16 v[108:109], v124 offset:18432
    ds_read_b64_tr_b16 v[110:111], v124 offset:19456
    buffer_load_dwordx4 v[228:231], v1, s[72:75], s88 offen offset:1024 sc1
    s_waitcnt vmcnt(12)
    v_mfma_f32_32x32x16_bf16 v[48:63], v[112:115], v[188:191], v[48:63]
    ds_read_b64_tr_b16 v[112:113], v124 offset:20480
    ds_read_b64_tr_b16 v[114:115], v124 offset:21504
    s_waitcnt lgkmcnt(8)
    buffer_load_dwordx4 v[232:235], v1, s[72:75], s88 offen offset:2048 sc1
    v_mfma_f32_32x32x16_bf16 v[64:79], v[96:99], v[188:191], v[64:79]
    ds_read_b64_tr_b16 v[96:97], v124 offset:22528
    ds_read_b64_tr_b16 v[98:99], v124 offset:23552
    s_waitcnt lgkmcnt(8)
    buffer_load_dwordx4 v[236:239], v1, s[72:75], s88 offen offset:3072 sc1
    v_mfma_f32_32x32x16_bf16 v[80:95], v[100:103], v[188:191], v[80:95]
    ds_read_b64_tr_b16 v[100:101], v124 offset:32768
    ds_read_b64_tr_b16 v[102:103], v124 offset:33792
    s_waitcnt lgkmcnt(8)
    v_lshrrev_b32 v29, 4, v0
    v_lshl_add_u32 v29, v29, 8, v24
    v_lshrrev_b32 v8, 2, v0
    s_waitcnt vmcnt(11)
    v_mfma_f32_32x32x16_bf16 v[48:63], v[104:107], v[192:195], v[48:63]
    ds_read_b64_tr_b16 v[104:105], v124 offset:34816
    ds_read_b64_tr_b16 v[106:107], v124 offset:35840
    s_waitcnt lgkmcnt(8)
    v_and_b32 v9, 3, v0
    v_lshlrev_b32 v10, 10, v8
    v_lshl_add_u32 v10, v9, 4, v10
    s_waitcnt vmcnt(10)
    v_mfma_f32_32x32x16_bf16 v[48:63], v[108:111], v[196:199], v[48:63]
    ds_read_b64_tr_b16 v[108:109], v124 offset:36864
    ds_read_b64_tr_b16 v[110:111], v124 offset:37888
    s_waitcnt lgkmcnt(8)
    s_mul_i32 s6, s3, 6144
    s_add_u32 s6, s6, 16384
    v_lshl_add_u32 v4, v9, 2, v8
    s_waitcnt vmcnt(9)
    v_mfma_f32_32x32x16_bf16 v[48:63], v[112:115], v[200:203], v[48:63]
    ds_read_b64_tr_b16 v[112:113], v124 offset:38912
    ds_read_b64_tr_b16 v[114:115], v124 offset:39936
    s_waitcnt lgkmcnt(8)
    v_lshlrev_b32 v4, 4, v4
    v_lshl_add_u32 v4, v9, 9, v4
    v_xor_b32 v5, 256, v4
    s_waitcnt vmcnt(8)
    v_mfma_f32_32x32x16_bf16 v[48:63], v[96:99], v[204:207], v[48:63]
    v_add_u32 v124, 4294885376, v124
    ds_read_b64_tr_b16 v[96:97], v124 offset:0
    ds_read_b64_tr_b16 v[98:99], v124 offset:1024
    s_waitcnt lgkmcnt(8)
    v_add_u32 v4, s6, v4
    v_add_u32 v5, s6, v5
    s_mul_i32 s6, s3, 4608
    s_waitcnt vmcnt(7)
    v_mfma_f32_32x32x16_bf16 v[48:63], v[100:103], v[208:211], v[48:63]
    ds_read_b64_tr_b16 v[100:101], v124 offset:2048
    ds_read_b64_tr_b16 v[102:103], v124 offset:3072
    s_waitcnt lgkmcnt(8)
    s_add_u32 s6, s6, 40960
    v_and_b32 v11, 31, v0
    v_mul_u32_u24 v6, 144, v11
    s_waitcnt vmcnt(6)
    v_mfma_f32_32x32x16_bf16 v[48:63], v[104:107], v[212:215], v[48:63]
    ds_read_b64_tr_b16 v[104:105], v124 offset:4096
    ds_read_b64_tr_b16 v[106:107], v124 offset:5120
    s_waitcnt lgkmcnt(8)
    v_lshl_add_u32 v6, v15, 4, v6
    v_add_u32 v6, s6, v6
    v_mul_u32_u24 v7, 144, v8
    s_waitcnt vmcnt(5)
    v_mfma_f32_32x32x16_bf16 v[48:63], v[108:111], v[216:219], v[48:63]
    ds_read_b64_tr_b16 v[108:109], v124 offset:6144
    ds_read_b64_tr_b16 v[110:111], v124 offset:7168
    s_waitcnt lgkmcnt(8)
    v_lshl_add_u32 v7, v9, 5, v7
    v_add_u32 v7, s6, v7
    s_waitcnt vmcnt(4)
    v_mfma_f32_32x32x16_bf16 v[48:63], v[112:115], v[220:223], v[48:63]
    ds_read_b64_tr_b16 v[112:113], v125 offset:16384
    ds_read_b64_tr_b16 v[114:115], v125 offset:17408
    s_waitcnt lgkmcnt(8)
    s_waitcnt vmcnt(3)
    v_mfma_f32_32x32x16_bf16 v[48:63], v[96:99], v[224:227], v[48:63]
    ds_read_b64_tr_b16 v[96:97], v125 offset:18432
    ds_read_b64_tr_b16 v[98:99], v125 offset:19456
    s_waitcnt lgkmcnt(8)
    s_waitcnt vmcnt(2)
    v_mfma_f32_32x32x16_bf16 v[48:63], v[100:103], v[228:231], v[48:63]
    ds_read_b64_tr_b16 v[100:101], v125 offset:20480
    ds_read_b64_tr_b16 v[102:103], v125 offset:21504
    s_waitcnt lgkmcnt(8)
    s_waitcnt vmcnt(1)
    v_mfma_f32_32x32x16_bf16 v[48:63], v[104:107], v[232:235], v[48:63]
    ds_read_b64_tr_b16 v[104:105], v125 offset:22528
    ds_read_b64_tr_b16 v[106:107], v125 offset:23552
    s_waitcnt lgkmcnt(8)
    s_waitcnt vmcnt(0)
    v_mfma_f32_32x32x16_bf16 v[48:63], v[108:111], v[236:239], v[48:63]
    ds_read_b64_tr_b16 v[108:109], v125 offset:32768
    ds_read_b64_tr_b16 v[110:111], v125 offset:33792
    s_waitcnt lgkmcnt(8)
    v_mfma_f32_32x32x16_bf16 v[64:79], v[112:115], v[192:195], v[64:79]
    ds_read_b64_tr_b16 v[112:113], v125 offset:34816
    ds_read_b64_tr_b16 v[114:115], v125 offset:35840
    s_waitcnt lgkmcnt(8)
    s_add_u32 s87, s53, s98
    v_mfma_f32_32x32x16_bf16 v[64:79], v[96:99], v[196:199], v[64:79]
    ds_read_b64_tr_b16 v[96:97], v125 offset:36864
    ds_read_b64_tr_b16 v[98:99], v125 offset:37888
    s_waitcnt lgkmcnt(8)
    v_cvt_pk_bf16_f32 v248, v48, v49
    v_cvt_pk_bf16_f32 v249, v50, v51
    v_cvt_pk_bf16_f32 v250, v52, v53
    v_cvt_pk_bf16_f32 v251, v54, v55
    v_cvt_pk_bf16_f32 v252, v56, v57
    v_mfma_f32_32x32x16_bf16 v[64:79], v[100:103], v[200:203], v[64:79]
    ds_read_b64_tr_b16 v[100:101], v125 offset:38912
    ds_read_b64_tr_b16 v[102:103], v125 offset:39936
    s_waitcnt lgkmcnt(8)
    v_permlane32_swap_b32 v248, v250
    v_permlane32_swap_b32 v249, v251
    buffer_store_dwordx4 v[248:251], v2, s[72:75], s87 offen offset:0 sc1
    v_mfma_f32_32x32x16_bf16 v[64:79], v[104:107], v[204:207], v[64:79]
    v_add_u32 v125, 4294885376, v125
    ds_read_b64_tr_b16 v[104:105], v125 offset:0
    ds_read_b64_tr_b16 v[106:107], v125 offset:1024
    s_waitcnt lgkmcnt(8)
    v_cvt_pk_bf16_f32 v253, v58, v59
    v_cvt_pk_bf16_f32 v254, v60, v61
    v_cvt_pk_bf16_f32 v255, v62, v63
    v_mfma_f32_32x32x16_bf16 v[64:79], v[108:111], v[208:211], v[64:79]
    ds_read_b64_tr_b16 v[108:109], v125 offset:2048
    ds_read_b64_tr_b16 v[110:111], v125 offset:3072
    s_waitcnt lgkmcnt(8)
    v_permlane32_swap_b32 v252, v254
    v_permlane32_swap_b32 v253, v255
    buffer_store_dwordx4 v[252:255], v3, s[72:75], s87 offen offset:1024 sc1
    v_mfma_f32_32x32x16_bf16 v[64:79], v[112:115], v[212:215], v[64:79]
    ds_read_b64_tr_b16 v[112:113], v125 offset:4096
    ds_read_b64_tr_b16 v[114:115], v125 offset:5120
    s_waitcnt lgkmcnt(8)
    v_mfma_f32_32x32x16_bf16 v[64:79], v[96:99], v[216:219], v[64:79]
    ds_read_b64_tr_b16 v[96:97], v125 offset:6144
    ds_read_b64_tr_b16 v[98:99], v125 offset:7168
    s_waitcnt lgkmcnt(8)
    v_mfma_f32_32x32x16_bf16 v[64:79], v[100:103], v[220:223], v[64:79]
    ds_read_b64_tr_b16 v[100:101], v126 offset:16384
    ds_read_b64_tr_b16 v[102:103], v126 offset:17408
    s_waitcnt lgkmcnt(8)
    v_mfma_f32_32x32x16_bf16 v[64:79], v[104:107], v[224:227], v[64:79]
    ds_read_b64_tr_b16 v[104:105], v126 offset:18432
    ds_read_b64_tr_b16 v[106:107], v126 offset:19456
    s_waitcnt lgkmcnt(8)
    v_mfma_f32_32x32x16_bf16 v[64:79], v[108:111], v[228:231], v[64:79]
    ds_read_b64_tr_b16 v[108:109], v126 offset:20480
    ds_read_b64_tr_b16 v[110:111], v126 offset:21504
    s_waitcnt lgkmcnt(8)
    v_mfma_f32_32x32x16_bf16 v[64:79], v[112:115], v[232:235], v[64:79]
    ds_read_b64_tr_b16 v[112:113], v126 offset:22528
    ds_read_b64_tr_b16 v[114:115], v126 offset:23552
    s_waitcnt lgkmcnt(8)
    v_mfma_f32_32x32x16_bf16 v[64:79], v[96:99], v[236:239], v[64:79]
    ds_read_b64_tr_b16 v[96:97], v126 offset:32768
    ds_read_b64_tr_b16 v[98:99], v126 offset:33792
    s_waitcnt lgkmcnt(8)
    v_mfma_f32_32x32x16_bf16 v[80:95], v[100:103], v[192:195], v[80:95]
    ds_read_b64_tr_b16 v[100:101], v126 offset:34816
    ds_read_b64_tr_b16 v[102:103], v126 offset:35840
    s_waitcnt lgkmcnt(8)
    s_add_u32 s87, s54, s98
    v_mfma_f32_32x32x16_bf16 v[80:95], v[104:107], v[196:199], v[80:95]
    ds_read_b64_tr_b16 v[104:105], v126 offset:36864
    ds_read_b64_tr_b16 v[106:107], v126 offset:37888
    s_waitcnt lgkmcnt(8)
    v_cvt_pk_bf16_f32 v248, v64, v65
    v_cvt_pk_bf16_f32 v249, v66, v67
    v_cvt_pk_bf16_f32 v250, v68, v69
    v_cvt_pk_bf16_f32 v251, v70, v71
    v_cvt_pk_bf16_f32 v252, v72, v73
    v_mfma_f32_32x32x16_bf16 v[80:95], v[108:111], v[200:203], v[80:95]
    ds_read_b64_tr_b16 v[108:109], v126 offset:38912
    ds_read_b64_tr_b16 v[110:111], v126 offset:39936
    s_waitcnt lgkmcnt(8)
    v_permlane32_swap_b32 v248, v250
    v_permlane32_swap_b32 v249, v251
    buffer_store_dwordx4 v[248:251], v2, s[72:75], s87 offen offset:0 sc1
    v_mfma_f32_32x32x16_bf16 v[80:95], v[112:115], v[204:207], v[80:95]
    v_add_u32 v126, 4294885376, v126
    ds_read_b64_tr_b16 v[112:113], v126 offset:0
    ds_read_b64_tr_b16 v[114:115], v126 offset:1024
    s_waitcnt lgkmcnt(8)
    v_cvt_pk_bf16_f32 v253, v74, v75
    v_cvt_pk_bf16_f32 v254, v76, v77
    v_cvt_pk_bf16_f32 v255, v78, v79
    v_mfma_f32_32x32x16_bf16 v[80:95], v[96:99], v[208:211], v[80:95]
    ds_read_b64_tr_b16 v[96:97], v126 offset:2048
    ds_read_b64_tr_b16 v[98:99], v126 offset:3072
    s_waitcnt lgkmcnt(8)
    v_permlane32_swap_b32 v252, v254
    v_permlane32_swap_b32 v253, v255
    buffer_store_dwordx4 v[252:255], v3, s[72:75], s87 offen offset:1024 sc1
    v_mfma_f32_32x32x16_bf16 v[80:95], v[100:103], v[212:215], v[80:95]
    ds_read_b64_tr_b16 v[100:101], v126 offset:4096
    ds_read_b64_tr_b16 v[102:103], v126 offset:5120
    s_waitcnt lgkmcnt(8)
    v_mfma_f32_32x32x16_bf16 v[80:95], v[104:107], v[216:219], v[80:95]
    ds_read_b64_tr_b16 v[104:105], v126 offset:6144
    ds_read_b64_tr_b16 v[106:107], v126 offset:7168
    s_waitcnt lgkmcnt(8)
    v_mfma_f32_32x32x16_bf16 v[80:95], v[108:111], v[220:223], v[80:95]
    ds_read_b64_tr_b16 v[108:109], v127 offset:0
    ds_read_b64_tr_b16 v[110:111], v127 offset:1024
    s_waitcnt lgkmcnt(8)
    v_mfma_f32_32x32x16_bf16 v[80:95], v[112:115], v[224:227], v[80:95]
    ds_read_b64_tr_b16 v[112:113], v127 offset:2048
    ds_read_b64_tr_b16 v[114:115], v127 offset:3072
    s_waitcnt lgkmcnt(8)
    v_mfma_f32_32x32x16_bf16 v[80:95], v[96:99], v[228:231], v[80:95]
    ds_read_b64_tr_b16 v[96:97], v127 offset:4096
    ds_read_b64_tr_b16 v[98:99], v127 offset:5120
    s_waitcnt lgkmcnt(8)
    v_mfma_f32_32x32x16_bf16 v[80:95], v[100:103], v[232:235], v[80:95]
    ds_read_b64_tr_b16 v[100:101], v127 offset:6144
    ds_read_b64_tr_b16 v[102:103], v127 offset:7168
    s_waitcnt lgkmcnt(8)
    s_waitcnt vmcnt(2)
    s_atomic_add s89, s[72:73], s84
    v_mfma_f32_32x32x16_bf16 v[80:95], v[104:107], v[236:239], v[80:95]
    ds_read_b64_tr_b16 v[104:105], v127 offset:16384
    ds_read_b64_tr_b16 v[106:107], v127 offset:17408
    s_waitcnt lgkmcnt(8)
    v_mfma_f32_32x32x16_bf16 v[48:63], v[108:111], v[32:35], 0
    ds_read_b64_tr_b16 v[108:109], v127 offset:18432
    ds_read_b64_tr_b16 v[110:111], v127 offset:19456
    s_waitcnt lgkmcnt(8)
    s_add_u32 s87, s55, s98
    v_mfma_f32_32x32x16_bf16 v[48:63], v[112:115], v[36:39], v[48:63]
    ds_read_b64_tr_b16 v[112:113], v127 offset:20480
    ds_read_b64_tr_b16 v[114:115], v127 offset:21504
    s_waitcnt lgkmcnt(8)
    v_cvt_pk_bf16_f32 v248, v80, v81
    v_cvt_pk_bf16_f32 v249, v82, v83
    v_cvt_pk_bf16_f32 v250, v84, v85
    v_cvt_pk_bf16_f32 v251, v86, v87
    v_cvt_pk_bf16_f32 v252, v88, v89
    v_mfma_f32_32x32x16_bf16 v[48:63], v[96:99], v[40:43], v[48:63]
    ds_read_b64_tr_b16 v[96:97], v127 offset:22528
    ds_read_b64_tr_b16 v[98:99], v127 offset:23552
    s_waitcnt lgkmcnt(8)
    v_permlane32_swap_b32 v248, v250
    v_permlane32_swap_b32 v249, v251
    buffer_store_dwordx4 v[248:251], v2, s[72:75], s87 offen offset:0 sc1
    v_mfma_f32_32x32x16_bf16 v[48:63], v[100:103], v[44:47], v[48:63]
    ds_read_b64_tr_b16 v[100:101], v127 offset:32768
    ds_read_b64_tr_b16 v[102:103], v127 offset:33792
    s_waitcnt lgkmcnt(8)
    v_cvt_pk_bf16_f32 v253, v90, v91
    v_cvt_pk_bf16_f32 v254, v92, v93
    v_cvt_pk_bf16_f32 v255, v94, v95
    v_mfma_f32_32x32x16_bf16 v[48:63], v[104:107], v[116:119], v[48:63]
    ds_read_b64_tr_b16 v[104:105], v127 offset:34816
    ds_read_b64_tr_b16 v[106:107], v127 offset:35840
    s_waitcnt lgkmcnt(8)
    v_permlane32_swap_b32 v252, v254
    v_permlane32_swap_b32 v253, v255
    buffer_store_dwordx4 v[252:255], v3, s[72:75], s87 offen offset:1024 sc1
    v_mfma_f32_32x32x16_bf16 v[48:63], v[108:111], v[120:123], v[48:63]
    ds_read_b64_tr_b16 v[108:109], v127 offset:36864
    ds_read_b64_tr_b16 v[110:111], v127 offset:37888
    s_waitcnt lgkmcnt(8)
    v_lshlrev_b32 v32, 16, v16
    v_and_b32 v33, 0xffff0000, v16
    v_mul_f32 v32, v32, v30
    v_mfma_f32_32x32x16_bf16 v[48:63], v[112:115], v[240:243], v[48:63]
    ds_read_b64_tr_b16 v[112:113], v127 offset:38912
    ds_read_b64_tr_b16 v[114:115], v127 offset:39936
    ds_add_u32 v25, v26
    s_waitcnt lgkmcnt(9)
    v_mfma_f32_32x32x16_bf16 v[48:63], v[96:99], v[244:247], v[48:63]
    ds_read_b64_tr_b16 v[96:97], v127 offset:49152
    ds_read_b64_tr_b16 v[98:99], v127 offset:50176
    s_waitcnt lgkmcnt(9)
    v_mul_f32 v33, v33, v30
    v_lshlrev_b32 v34, 16, v17
    v_and_b32 v35, 0xffff0000, v17
    v_mfma_f32_32x32x16_bf16 v[48:63], v[100:103], v[128:131], v[48:63]
    ds_read_b64_tr_b16 v[100:101], v127 offset:51200
    ds_read_b64_tr_b16 v[102:103], v127 offset:52224
    s_waitcnt lgkmcnt(9)
    v_mul_f32 v34, v34, v30
    v_mul_f32 v35, v35, v30
    v_lshlrev_b32 v36, 16, v18
    v_mfma_f32_32x32x16_bf16 v[48:63], v[104:107], v[132:135], v[48:63]
    ds_read_b64_tr_b16 v[104:105], v127 offset:53248
    ds_read_b64_tr_b16 v[106:107], v127 offset:54272
    s_waitcnt lgkmcnt(9)
    v_and_b32 v37, 0xffff0000, v18
    v_mul_f32 v36, v36, v30
    v_mul_f32 v37, v37, v30
    v_mfma_f32_32x32x16_bf16 v[48:63], v[108:111], v[136:139], v[48:63]
    ds_read_b64_tr_b16 v[108:109], v127 offset:55296
    ds_read_b64_tr_b16 v[110:111], v127 offset:56320
    s_waitcnt lgkmcnt(9)
    s_waitcnt vmcnt(2)
    s_atomic_add s89, s[72:73], s85
    v_lshlrev_b32 v38, 16, v19
    v_and_b32 v39, 0xffff0000, v19
    v_mul_f32 v38, v38, v30
    v_mfma_f32_32x32x16_bf16 v[48:63], v[112:115], v[140:143], v[48:63]
    v_add_u32 v127, 65536, v127
    ds_read_b64_tr_b16 v[112:113], v127 offset:49152
    ds_read_b64_tr_b16 v[114:115], v127 offset:50176
    s_waitcnt lgkmcnt(8)
    v_mul_f32 v39, v39, v30
    v_lshlrev_b32 v40, 16, v20
    v_and_b32 v41, 0xffff0000, v20
    v_mfma_f32_32x32x16_bf16 v[48:63], v[96:99], v[144:147], v[48:63]
    ds_read_b64_tr_b16 v[96:97], v127 offset:51200
    ds_read_b64_tr_b16 v[98:99], v127 offset:52224
    s_waitcnt lgkmcnt(8)
    v_mul_f32 v40, v40, v30
    v_mul_f32 v41, v41, v30
    v_lshlrev_b32 v42, 16, v21
    v_mfma_f32_32x32x16_bf16 v[48:63], v[100:103], v[148:151], v[48:63]
    ds_read_b64_tr_b16 v[100:101], v127 offset:53248
    ds_read_b64_tr_b16 v[102:103], v127 offset:54272
    s_waitcnt lgkmcnt(8)
    v_and_b32 v43, 0xffff0000, v21
    v_mul_f32 v42, v42, v30
    v_mul_f32 v43, v43, v30
    v_mfma_f32_32x32x16_bf16 v[48:63], v[104:107], v[152:155], v[48:63]
    ds_read_b64_tr_b16 v[104:105], v127 offset:55296
    ds_read_b64_tr_b16 v[106:107], v127 offset:56320
    s_waitcnt lgkmcnt(8)
    v_lshlrev_b32 v44, 16, v22
    v_and_b32 v45, 0xffff0000, v22
    v_mul_f32 v44, v44, v30
    v_mfma_f32_32x32x16_bf16 v[48:63], v[108:111], v[156:159], v[48:63]
    ds_read_b64_tr_b16 v[108:109], v127 offset:0
    ds_read_b64_tr_b16 v[110:111], v127 offset:1024
    s_waitcnt lgkmcnt(8)
    v_mul_f32 v45, v45, v30
    v_lshlrev_b32 v46, 16, v23
    v_and_b32 v47, 0xffff0000, v23
    v_mfma_f32_32x32x16_bf16 v[48:63], v[112:115], v[160:163], v[48:63]
    ds_read_b64_tr_b16 v[112:113], v127 offset:2048
    ds_read_b64_tr_b16 v[114:115], v127 offset:3072
    s_waitcnt lgkmcnt(8)
    v_mul_f32 v46, v46, v30
    v_mul_f32 v47, v47, v30
    v_mfma_f32_32x32x16_bf16 v[48:63], v[96:99], v[164:167], v[48:63]
    ds_read_b64_tr_b16 v[96:97], v127 offset:4096
    ds_read_b64_tr_b16 v[98:99], v127 offset:5120
    s_waitcnt lgkmcnt(8)
    v_mfma_f32_32x32x16_bf16 v[48:63], v[100:103], v[168:171], v[48:63]
    ds_read_b64_tr_b16 v[100:101], v127 offset:6144
    ds_read_b64_tr_b16 v[102:103], v127 offset:7168
    s_waitcnt lgkmcnt(8)
    v_mfma_f32_32x32x16_bf16 v[48:63], v[104:107], v[172:175], v[48:63]
    ds_read_b64_tr_b16 v[104:105], v127 offset:16384
    ds_read_b64_tr_b16 v[106:107], v127 offset:17408
    s_waitcnt lgkmcnt(8)
    v_mfma_f32_32x32x16_bf16 v[48:63], v[108:111], v[176:179], v[48:63]
    ds_read_b64_tr_b16 v[108:109], v127 offset:18432
    ds_read_b64_tr_b16 v[110:111], v127 offset:19456
    s_waitcnt lgkmcnt(8)
    s_waitcnt vmcnt(0)
    s_atomic_add s89, s[72:73], s86
    v_mfma_f32_32x32x16_bf16 v[48:63], v[112:115], v[180:183], v[48:63]
    ds_read_b64_tr_b16 v[112:113], v127 offset:20480
    ds_read_b64_tr_b16 v[114:115], v127 offset:21504
    s_waitcnt lgkmcnt(8)
    v_mfma_f32_32x32x16_bf16 v[48:63], v[96:99], v[184:187], v[48:63]
    ds_read_b64_tr_b16 v[96:97], v127 offset:22528
    ds_read_b64_tr_b16 v[98:99], v127 offset:23552
    s_waitcnt lgkmcnt(8)
    v_mfma_f32_32x32x16_bf16 v[48:63], v[100:103], v[188:191], v[48:63]
    ds_read_b64_tr_b16 v[100:101], v127 offset:32768
    ds_read_b64_tr_b16 v[102:103], v127 offset:33792
    s_waitcnt lgkmcnt(8)
    v_mfma_f32_32x32x16_bf16 v[48:63], v[104:107], v[192:195], v[48:63]
    ds_read_b64_tr_b16 v[104:105], v127 offset:34816
    ds_read_b64_tr_b16 v[106:107], v127 offset:35840
    s_waitcnt lgkmcnt(8)
    v_mfma_f32_32x32x16_bf16 v[48:63], v[108:111], v[196:199], v[48:63]
    ds_read_b64_tr_b16 v[108:109], v127 offset:36864
    ds_read_b64_tr_b16 v[110:111], v127 offset:37888
    s_waitcnt lgkmcnt(8)
    v_mfma_f32_32x32x16_bf16 v[48:63], v[112:115], v[200:203], v[48:63]
    ds_read_b64_tr_b16 v[112:113], v127 offset:38912
    ds_read_b64_tr_b16 v[114:115], v127 offset:39936
    s_waitcnt lgkmcnt(8)
    v_mfma_f32_32x32x16_bf16 v[48:63], v[96:99], v[204:207], v[48:63]
    v_add_u32 v127, 4294885376, v127
    ds_read_b64_tr_b16 v[96:97], v127 offset:0
    ds_read_b64_tr_b16 v[98:99], v127 offset:1024
    s_waitcnt lgkmcnt(8)
    v_mfma_f32_32x32x16_bf16 v[48:63], v[100:103], v[208:211], v[48:63]
    ds_read_b64_tr_b16 v[100:101], v127 offset:2048
    ds_read_b64_tr_b16 v[102:103], v127 offset:3072
    s_waitcnt lgkmcnt(8)
    v_mfma_f32_32x32x16_bf16 v[48:63], v[104:107], v[212:215], v[48:63]
    ds_read_b64_tr_b16 v[104:105], v127 offset:4096
    ds_read_b64_tr_b16 v[106:107], v127 offset:5120
    s_waitcnt lgkmcnt(8)
    v_mfma_f32_32x32x16_bf16 v[48:63], v[108:111], v[216:219], v[48:63]
    ds_read_b64_tr_b16 v[108:109], v127 offset:6144
    ds_read_b64_tr_b16 v[110:111], v127 offset:7168
    s_waitcnt lgkmcnt(8)
    v_mfma_f32_32x32x16_bf16 v[48:63], v[112:115], v[220:223], v[48:63]
    s_waitcnt lgkmcnt(6)
    v_mfma_f32_32x32x16_bf16 v[48:63], v[96:99], v[224:227], v[48:63]
    s_waitcnt lgkmcnt(4)
    v_mfma_f32_32x32x16_bf16 v[48:63], v[100:103], v[228:231], v[48:63]
    s_waitcnt lgkmcnt(2)
    v_mfma_f32_32x32x16_bf16 v[48:63], v[104:107], v[232:235], v[48:63]
    s_waitcnt lgkmcnt(0)
    v_mfma_f32_32x32x16_bf16 v[48:63], v[108:111], v[236:239], v[48:63]
    ds_read_b32 v27, v29 offset:0
    s_add_u32 s88, s95, 16384
    s_nop 9
    v_pk_add_f32 v[48:49], v[48:49], v[32:33]
    v_pk_add_f32 v[50:51], v[50:51], v[34:35]
    v_pk_add_f32 v[52:53], v[52:53], v[36:37]
    v_pk_add_f32 v[54:55], v[54:55], v[38:39]
    v_pk_add_f32 v[56:57], v[56:57], v[40:41]
    v_pk_add_f32 v[58:59], v[58:59], v[42:43]
    v_pk_add_f32 v[60:61], v[60:61], v[44:45]
    v_pk_add_f32 v[62:63], v[62:63], v[46:47]
    s_waitcnt lgkmcnt(0)
    v_cmp_gt_u32 vcc, 14, v27
    s_cbranch_vccnz Lst94
Lbk95:
    ds_write_b128 v6, v[48:51] offset:0
    ds_write_b128 v6, v[52:55] offset:32
    ds_write_b128 v6, v[56:59] offset:64
    ds_write_b128 v6, v[60:63] offset:96
    ds_read_b128 v[128:131], v7 offset:0
    ds_read_b128 v[132:135], v7 offset:16
    ds_read_b128 v[136:139], v7 offset:2304
    ds_read_b128 v[140:143], v7 offset:2320
    ds_read_b32 v31, v24 offset:1536
    s_waitcnt lgkmcnt(0)
    v_cmp_gt_u32 vcc, 9, v31
    s_cbranch_vccnz Lst96
Lbk97:
    ds_read_b128 v[144:147], v4 offset:0
    ds_read_b128 v[148:151], v5 offset:0
    ds_read_b128 v[152:155], v4 offset:2048
    ds_read_b128 v[156:159], v5 offset:2048
    s_waitcnt lgkmcnt(3)
    v_lshlrev_b32 v64, 16, v144
    v_and_b32 v65, 0xffff0000, v144
    v_lshlrev_b32 v66, 16, v145
    v_and_b32 v67, 0xffff0000, v145
    v_lshlrev_b32 v68, 16, v146
    v_and_b32 v69, 0xffff0000, v146
    v_lshlrev_b32 v70, 16, v147
    v_and_b32 v71, 0xffff0000, v147
    s_waitcnt lgkmcnt(2)
    v_lshlrev_b32 v72, 16, v148
    v_and_b32 v73, 0xffff0000, v148
    v_lshlrev_b32 v74, 16, v149
    v_and_b32 v75, 0xffff0000, v149
    v_lshlrev_b32 v76, 16, v150
    v_and_b32 v77, 0xffff0000, v150
    v_lshlrev_b32 v78, 16, v151
    v_and_b32 v79, 0xffff0000, v151
    v_pk_add_f32 v[128:129], v[128:129], v[64:65]
    v_pk_add_f32 v[130:131], v[130:131], v[66:67]
    v_pk_add_f32 v[132:133], v[132:133], v[68:69]
    v_pk_add_f32 v[134:135], v[134:135], v[70:71]
    v_pk_add_f32 v[136:137], v[136:137], v[72:73]
    v_pk_add_f32 v[138:139], v[138:139], v[74:75]
    v_pk_add_f32 v[140:141], v[140:141], v[76:77]
    v_pk_add_f32 v[142:143], v[142:143], v[78:79]
    s_waitcnt lgkmcnt(1)
    v_lshlrev_b32 v64, 16, v152
    v_and_b32 v65, 0xffff0000, v152
    v_lshlrev_b32 v66, 16, v153
    v_and_b32 v67, 0xffff0000, v153
    v_lshlrev_b32 v68, 16, v154
    v_and_b32 v69, 0xffff0000, v154
    v_lshlrev_b32 v70, 16, v155
    v_and_b32 v71, 0xffff0000, v155
    s_waitcnt lgkmcnt(0)
    v_lshlrev_b32 v72, 16, v156
    v_and_b32 v73, 0xffff0000, v156
    v_lshlrev_b32 v74, 16, v157
    v_and_b32 v75, 0xffff0000, v157
    v_lshlrev_b32 v76, 16, v158
    v_and_b32 v77, 0xffff0000, v158
    v_lshlrev_b32 v78, 16, v159
    v_and_b32 v79, 0xffff0000, v159
    v_pk_add_f32 v[128:129], v[128:129], v[64:65]
    v_pk_add_f32 v[130:131], v[130:131], v[66:67]
    v_pk_add_f32 v[132:133], v[132:133], v[68:69]
    v_pk_add_f32 v[134:135], v[134:135], v[70:71]
    v_pk_add_f32 v[136:137], v[136:137], v[72:73]
    v_pk_add_f32 v[138:139], v[138:139], v[74:75]
    v_pk_add_f32 v[140:141], v[140:141], v[76:77]
    v_pk_add_f32 v[142:143], v[142:143], v[78:79]
    ds_read_b32 v31, v24 offset:1536
    s_waitcnt lgkmcnt(0)
    v_cmp_gt_u32 vcc, 10, v31
    s_cbranch_vccnz Lst98
Lbk99:
    ds_read_b128 v[160:163], v4 offset:4096
    ds_read_b128 v[164:167], v5 offset:4096
    s_waitcnt lgkmcnt(1)
    v_lshlrev_b32 v64, 16, v160
    v_and_b32 v65, 0xffff0000, v160
    v_lshlrev_b32 v66, 16, v161
    v_and_b32 v67, 0xffff0000, v161
    v_lshlrev_b32 v68, 16, v162
    v_and_b32 v69, 0xffff0000, v162
    v_lshlrev_b32 v70, 16, v163
    v_and_b32 v71, 0xffff0000, v163
    v_pk_add_f32 v[128:129], v[128:129], v[64:65]
    v_pk_add_f32 v[130:131], v[130:131], v[66:67]
    v_pk_add_f32 v[132:133], v[132:133], v[68:69]
    v_pk_add_f32 v[134:135], v[134:135], v[70:71]
    v_cvt_pk_bf16_f32 v248, v128, v129
    v_cvt_pk_bf16_f32 v249, v130, v131
    v_cvt_pk_bf16_f32 v250, v132, v133
    v_cvt_pk_bf16_f32 v251, v134, v135
    buffer_store_dwordx4 v[248:251], v10, s[76:79], s95 offen sc1
    s_waitcnt lgkmcnt(0)
    v_lshlrev_b32 v72, 16, v164
    v_and_b32 v73, 0xffff0000, v164
    v_lshlrev_b32 v74, 16, v165
    v_and_b32 v75, 0xffff0000, v165
    v_lshlrev_b32 v76, 16, v166
    v_and_b32 v77, 0xffff0000, v166
    v_lshlrev_b32 v78, 16, v167
    v_and_b32 v79, 0xffff0000, v167
    v_pk_add_f32 v[136:137], v[136:137], v[72:73]
    v_pk_add_f32 v[138:139], v[138:139], v[74:75]
    v_pk_add_f32 v[140:141], v[140:141], v[76:77]
    v_pk_add_f32 v[142:143], v[142:143], v[78:79]
    v_cvt_pk_bf16_f32 v252, v136, v137
    v_cvt_pk_bf16_f32 v253, v138, v139
    v_cvt_pk_bf16_f32 v254, v140, v141
    v_cvt_pk_bf16_f32 v255, v142, v143
    buffer_store_dwordx4 v[252:255], v10, s[76:79], s88 offen sc1
    s_endpgm
Lst4:
    ds_read_b32 v31, v24 offset:1152
    s_waitcnt lgkmcnt(0)
    v_cmp_gt_u32 vcc, 1, v31
    s_cbranch_vccz Lbk5
    s_sub_u32 s101, s101, 1
    s_cbranch_scc0 Lst4
    s_mov_b32 s101, 0
    s_branch Lbk5
Lst6:
    ds_read_b32 v31, v24 offset:1152
    s_waitcnt lgkmcnt(0)
    v_cmp_gt_u32 vcc, 2, v31
    s_cbranch_vccz Lbk7
    s_sub_u32 s101, s101, 1
    s_cbranch_scc0 Lst6
    s_mov_b32 s101, 0
    s_branch Lbk7
Lst8:
    ds_read_b32 v31, v24 offset:1152
    s_waitcnt lgkmcnt(0)
    v_cmp_gt_u32 vcc, 3, v31
    s_cbranch_vccz Lbk9
    s_sub_u32 s101, s101, 1
    s_cbranch_scc0 Lst8
    s_mov_b32 s101, 0
    s_branch Lbk9
Lst10:
    ds_read_b32 v31, v24 offset:1152
    s_waitcnt lgkmcnt(0)
    v_cmp_gt_u32 vcc, 4, v31
    s_cbranch_vccz Lbk11
    s_sub_u32 s101, s101, 1
    s_cbranch_scc0 Lst10
    s_mov_b32 s101, 0
    s_branch Lbk11
Lst12:
    ds_read_b32 v31, v24 offset:1152
    s_waitcnt lgkmcnt(0)
    v_cmp_gt_u32 vcc, 5, v31
    s_cbranch_vccz Lbk13
    s_sub_u32 s101, s101, 1
    s_cbranch_scc0 Lst12
    s_mov_b32 s101, 0
    s_branch Lbk13
Lst14:
    ds_read_b32 v31, v24 offset:1152
    s_waitcnt lgkmcnt(0)
    v_cmp_gt_u32 vcc, 6, v31
    s_cbranch_vccz Lbk15
    s_sub_u32 s101, s101, 1
    s_cbranch_scc0 Lst14
    s_mov_b32 s101, 0
    s_branch Lbk15
Lst16:
    ds_read_b32 v31, v24 offset:1152
    s_waitcnt lgkmcnt(0)
    v_cmp_gt_u32 vcc, 7, v31
    s_cbranch_vccz Lbk17
    s_sub_u32 s101, s101, 1
    s_cbranch_scc0 Lst16
    s_mov_b32 s101, 0
    s_branch Lbk17
Lst18:
    ds_read_b32 v31, v24 offset:1152
    s_waitcnt lgkmcnt(0)
    v_cmp_gt_u32 vcc, 8, v31
    s_cbranch_vccz Lbk19
    s_sub_u32 s101, s101, 1
    s_cbranch_scc0 Lst18
    s_mov_b32 s101, 0
    s_branch Lbk19
Lst20:
    ds_read_b32 v31, v24 offset:1152
    s_waitcnt lgkmcnt(0)
    v_cmp_gt_u32 vcc, 10, v31
    s_cbranch_vccz Lbk21
    s_sub_u32 s101, s101, 1
    s_cbranch_scc0 Lst20
    s_mov_b32 s101, 0
    s_branch Lbk21
Lst22:
    ds_read_b32 v31, v24 offset:1152
    s_waitcnt lgkmcnt(0)
    v_cmp_gt_u32 vcc, 1, v31
    s_cbranch_vccz Lbk23
    s_sub_u32 s101, s101, 1
    s_cbranch_scc0 Lst22
    s_mov_b32 s101, 0
    s_branch Lbk23
Lst24:
    ds_read_b32 v31, v24 offset:1152
    s_waitcnt lgkmcnt(0)
    v_cmp_gt_u32 vcc, 2, v31
    s_cbranch_vccz Lbk25
    s_sub_u32 s101, s101, 1
    s_cbranch_scc0 Lst24
    s_mov_b32 s101, 0
    s_branch Lbk25
Lst26:
    ds_read_b32 v31, v24 offset:1152
    s_waitcnt lgkmcnt(0)
    v_cmp_gt_u32 vcc, 3, v31
    s_cbranch_vccz Lbk27
    s_sub_u32 s101, s101, 1
    s_cbranch_scc0 Lst26
    s_mov_b32 s101, 0
    s_branch Lbk27
Lst28:
    ds_read_b32 v31, v24 offset:1152
    s_waitcnt lgkmcnt(0)
    v_cmp_gt_u32 vcc, 4, v31
    s_cbranch_vccz Lbk29
    s_sub_u32 s101, s101, 1
    s_cbranch_scc0 Lst28
    s_mov_b32 s101, 0
    s_branch Lbk29
Lst30:
    ds_read_b32 v31, v24 offset:1152
    s_waitcnt lgkmcnt(0)
    v_cmp_gt_u32 vcc, 5, v31
    s_cbranch_vccz Lbk31
    s_sub_u32 s101, s101, 1
    s_cbranch_scc0 Lst30
    s_mov_b32 s101, 0
    s_branch Lbk31
Lst32:
    ds_read_b32 v31, v24 offset:1152
    s_waitcnt lgkmcnt(0)
    v_cmp_gt_u32 vcc, 6, v31
    s_cbranch_vccz Lbk33
    s_sub_u32 s101, s101, 1
    s_cbranch_scc0 Lst32
    s_mov_b32 s101, 0
    s_branch Lbk33
Lst34:
    ds_read_b32 v31, v24 offset:1152
    s_waitcnt lgkmcnt(0)
    v_cmp_gt_u32 vcc, 7, v31
    s_cbranch_vccz Lbk35
    s_sub_u32 s101, s101, 1
    s_cbranch_scc0 Lst34
    s_mov_b32 s101, 0
    s_branch Lbk35
Lst36:
    ds_read_b32 v31, v24 offset:1152
    s_waitcnt lgkmcnt(0)
    v_cmp_gt_u32 vcc, 8, v31
    s_cbranch_vccz Lbk37
    s_sub_u32 s101, s101, 1
    s_cbranch_scc0 Lst36
    s_mov_b32 s101, 0
    s_branch Lbk37
Lst38:
    ds_read_b32 v31, v24 offset:1152
    s_waitcnt lgkmcnt(0)
    v_cmp_gt_u32 vcc, 10, v31
    s_cbranch_vccz Lbk39
    s_sub_u32 s101, s101, 1
    s_cbranch_scc0 Lst38
    s_mov_b32 s101, 0
    s_branch Lbk39
Lst40:
    ds_read_b32 v31, v29 offset:0
    s_waitcnt lgkmcnt(0)
    v_cmp_gt_u32 vcc, 2, v31
    s_cbranch_vccz Lbk41
    s_sub_u32 s101, s101, 1
    s_cbranch_scc0 Lst40
    s_mov_b32 s101, 0
    s_branch Lbk41
Lst42:
    ds_read_b32 v31, v24 offset:1152
    s_waitcnt lgkmcnt(0)
    v_cmp_gt_u32 vcc, 12, v31
    s_cbranch_vccz Lbk43
    s_sub_u32 s101, s101, 1
    s_cbranch_scc0 Lst42
    s_mov_b32 s101, 0
    s_branch Lbk43
Lst44:
    ds_read_b32 v31, v24 offset:1152
    s_waitcnt lgkmcnt(0)
    v_cmp_gt_u32 vcc, 14, v31
    s_cbranch_vccz Lbk45
    s_sub_u32 s101, s101, 1
    s_cbranch_scc0 Lst44
    s_mov_b32 s101, 0
    s_branch Lbk45
Lst46:
    ds_read_b32 v31, v24 offset:1152
    s_waitcnt lgkmcnt(0)
    v_cmp_gt_u32 vcc, 16, v31
    s_cbranch_vccz Lbk47
    s_sub_u32 s101, s101, 1
    s_cbranch_scc0 Lst46
    s_mov_b32 s101, 0
    s_branch Lbk47
Lst48:
    ds_read_b32 v31, v24 offset:1152
    s_waitcnt lgkmcnt(0)
    v_cmp_gt_u32 vcc, 18, v31
    s_cbranch_vccz Lbk49
    s_sub_u32 s101, s101, 1
    s_cbranch_scc0 Lst48
    s_mov_b32 s101, 0
    s_branch Lbk49
Lst50:
    ds_read_b32 v31, v24 offset:1152
    s_waitcnt lgkmcnt(0)
    v_cmp_gt_u32 vcc, 19, v31
    s_cbranch_vccz Lbk51
    s_sub_u32 s101, s101, 1
    s_cbranch_scc0 Lst50
    s_mov_b32 s101, 0
    s_branch Lbk51
Lst52:
    ds_read_b32 v31, v24 offset:1152
    s_waitcnt lgkmcnt(0)
    v_cmp_gt_u32 vcc, 20, v31
    s_cbranch_vccz Lbk53
    s_sub_u32 s101, s101, 1
    s_cbranch_scc0 Lst52
    s_mov_b32 s101, 0
    s_branch Lbk53
Lst54:
    ds_read_b32 v31, v24 offset:1536
    s_waitcnt lgkmcnt(0)
    v_cmp_gt_u32 vcc, 1, v31
    s_cbranch_vccz Lbk55
    s_sub_u32 s101, s101, 1
    s_cbranch_scc0 Lst54
    s_mov_b32 s101, 0
    s_branch Lbk55
Lst56:
    ds_read_b32 v31, v24 offset:1152
    s_waitcnt lgkmcnt(0)
    v_cmp_gt_u32 vcc, 22, v31
    s_cbranch_vccz Lbk57
    s_sub_u32 s101, s101, 1
    s_cbranch_scc0 Lst56
    s_mov_b32 s101, 0
    s_branch Lbk57
Lst58:
    ds_read_b32 v31, v24 offset:1152
    s_waitcnt lgkmcnt(0)
    v_cmp_gt_u32 vcc, 24, v31
    s_cbranch_vccz Lbk59
    s_sub_u32 s101, s101, 1
    s_cbranch_scc0 Lst58
    s_mov_b32 s101, 0
    s_branch Lbk59
Lst60:
    s_waitcnt vmcnt(0)
    ds_add_u32 v25, v26
    s_waitcnt lgkmcnt(0)
    v_mov_b32 v26, 0
Lst62:
    ds_read_b32 v31, v24 offset:1536
    s_waitcnt lgkmcnt(0)
    v_cmp_gt_u32 vcc, 2, v31
    s_cbranch_vccz Lbk61
    s_sub_u32 s101, s101, 1
    s_cbranch_scc0 Lst62
    s_mov_b32 s101, 0
    s_branch Lbk61
Lst66:
    ds_read_b32 v31, v24 offset:1536
    s_waitcnt lgkmcnt(0)
    v_cmp_gt_u32 vcc, 4, v31
    s_cbranch_vccz Lbk67
    s_sub_u32 s101, s101, 1
    s_cbranch_scc0 Lst66
    s_mov_b32 s101, 0
    s_branch Lbk67
Lst68:
    ds_read_b32 v31, v24 offset:1536
    s_waitcnt lgkmcnt(0)
    v_cmp_gt_u32 vcc, 5, v31
    s_cbranch_vccz Lbk69
    s_sub_u32 s101, s101, 1
    s_cbranch_scc0 Lst68
    s_mov_b32 s101, 0
    s_branch Lbk69
Lst70:
    ds_read_b32 v31, v24 offset:1152
    s_waitcnt lgkmcnt(0)
    v_cmp_gt_u32 vcc, 31, v31
    s_cbranch_vccz Lbk71
    s_sub_u32 s101, s101, 1
    s_cbranch_scc0 Lst70
    s_mov_b32 s101, 0
    s_branch Lbk71
Lst74:
    ds_read_b32 v31, v24 offset:1792
    s_waitcnt lgkmcnt(0)
    v_cmp_gt_u32 vcc, 2, v31
    s_cbranch_vccz Lbk75
    s_sub_u32 s101, s101, 1
    s_cbranch_scc0 Lst74
    s_mov_b32 s101, 0
    s_branch Lbk75
Lst76:
    ds_read_b32 v31, v24 offset:1152
    s_waitcnt lgkmcnt(0)
    v_cmp_gt_u32 vcc, 33, v31
    s_cbranch_vccz Lbk77
    s_sub_u32 s101, s101, 1
    s_cbranch_scc0 Lst76
    s_mov_b32 s101, 0
    s_branch Lbk77
Lst78:
    ds_read_b32 v31, v24 offset:1536
    s_waitcnt lgkmcnt(0)
    v_cmp_gt_u32 vcc, 6, v31
    s_cbranch_vccz Lbk79
    s_sub_u32 s101, s101, 1
    s_cbranch_scc0 Lst78
    s_mov_b32 s101, 0
    s_branch Lbk79
Lst80:
    ds_read_b32 v31, v24 offset:1152
    s_waitcnt lgkmcnt(0)
    v_cmp_gt_u32 vcc, 34, v31
    s_cbranch_vccz Lbk81
    s_sub_u32 s101, s101, 1
    s_cbranch_scc0 Lst80
    s_mov_b32 s101, 0
    s_branch Lbk81
Lst86:
    ds_read_b32 v31, v24 offset:1536
    s_waitcnt lgkmcnt(0)
    v_cmp_gt_u32 vcc, 7, v31
    s_cbranch_vccz Lbk87
    s_sub_u32 s101, s101, 1
    s_cbranch_scc0 Lst86
    s_mov_b32 s101, 0
    s_branch Lbk87
Lst88:
    ds_read_b32 v31, v24 offset:1152
    s_waitcnt lgkmcnt(0)
    v_cmp_gt_u32 vcc, 35, v31
    s_cbranch_vccz Lbk89
    s_sub_u32 s101, s101, 1
    s_cbranch_scc0 Lst88
    s_mov_b32 s101, 0
    s_branch Lbk89
Lst90:
    ds_read_b32 v31, v24 offset:1536
    s_waitcnt lgkmcnt(0)
    v_cmp_gt_u32 vcc, 8, v31
    s_cbranch_vccz Lbk91
    s_sub_u32 s101, s101, 1
    s_cbranch_scc0 Lst90
    s_mov_b32 s101, 0
    s_branch Lbk91
Lst92:
    ds_read_b32 v31, v24 offset:1152
    s_waitcnt lgkmcnt(0)
    v_cmp_gt_u32 vcc, 38, v31
    s_cbranch_vccz Lbk93
    s_sub_u32 s101, s101, 1
    s_cbranch_scc0 Lst92
    s_mov_b32 s101, 0
    s_branch Lbk93
Lst94:
    ds_read_b32 v31, v29 offset:0
    s_waitcnt lgkmcnt(0)
    v_cmp_gt_u32 vcc, 14, v31
    s_cbranch_vccz Lbk95
    s_sub_u32 s101, s101, 1
    s_cbranch_scc0 Lst94
    s_mov_b32 s101, 0
    s_branch Lbk95
Lst96:
    ds_read_b32 v31, v24 offset:1536
    s_waitcnt lgkmcnt(0)
    v_cmp_gt_u32 vcc, 9, v31
    s_cbranch_vccz Lbk97
    s_sub_u32 s101, s101, 1
    s_cbranch_scc0 Lst96
    s_mov_b32 s101, 0
    s_branch Lbk97
Lst98:
    ds_read_b32 v31, v24 offset:1536
    s_waitcnt lgkmcnt(0)
    v_cmp_gt_u32 vcc, 10, v31
    s_cbranch_vccz Lbk99
    s_sub_u32 s101, s101, 1
    s_cbranch_scc0 Lst98
    s_mov_b32 s101, 0
    s_branch Lbk99
Lsp72:
    s_nop 15
    s_waitcnt vmcnt(0) lgkmcnt(0)
    v_rcp_f32 v13, v40
    s_add_u32 s87, s0, 0
    v_mul_f32 v13, v13, v28
    v_mul_f32 v32, v32, v13
    v_mul_f32 v33, v33, v13
    v_mul_f32 v34, v34, v13
    v_mul_f32 v35, v35, v13
    v_mul_f32 v36, v36, v13
    v_mul_f32 v37, v37, v13
    v_mul_f32 v38, v38, v13
    v_mul_f32 v39, v39, v13
    v_cvt_pk_bf16_f32 v40, v32, v33
    v_cvt_pk_bf16_f32 v41, v34, v35
    v_cvt_pk_bf16_f32 v42, v36, v37
    v_cvt_pk_bf16_f32 v43, v38, v39
    buffer_store_dwordx4 v[40:43], v1, s[72:75], s87 offen sc1
    v_rcp_f32 v13, v56
    s_add_u32 s87, s0, 147456
    v_mul_f32 v13, v13, v29
    v_mul_f32 v48, v48, v13
    v_mul_f32 v49, v49, v13
    v_mul_f32 v50, v50, v13
    v_mul_f32 v51, v51, v13
    v_mul_f32 v52, v52, v13
    v_mul_f32 v53, v53, v13
    v_mul_f32 v54, v54, v13
    v_mul_f32 v55, v55, v13
    v_cvt_pk_bf16_f32 v56, v48, v49
    v_cvt_pk_bf16_f32 v57, v50, v51
    v_cvt_pk_bf16_f32 v58, v52, v53
    v_cvt_pk_bf16_f32 v59, v54, v55
    buffer_store_dwordx4 v[56:59], v1, s[72:75], s87 offen sc1
    buffer_load_dword v30, v30, s[72:75], s91 offen sc1
    v_xor_b32 v124, s49, v16
    v_xor_b32 v125, s50, v16
    v_xor_b32 v126, s51, v16
    v_xor_b32 v127, s52, v16
    s_waitcnt vmcnt(0)
    v_sub_f32 v30, 1.0, v30
    v_mov_b32 v27, 3
    ds_add_u32 v25, v27
Lwa82:
    ds_read_b32 v27, v24 offset:1536
    s_waitcnt lgkmcnt(0)
    v_cmp_gt_u32 vcc, 6, v27
    s_cbranch_vccz Lwd83
    s_sleep 1
    s_sub_u32 s101, s101, 1
    s_cbranch_scc0 Lwa82
    s_mov_b32 s101, 0
Lwd83:
    s_lshl_b32 s88, s40, 12
    s_add_u32 s88, s88, s92
    buffer_load_dwordx4 v[32:35], v1, s[72:75], s88 offen offset:0 sc1
    buffer_load_dwordx4 v[36:39], v1, s[72:75], s88 offen offset:1024 sc1
    buffer_load_dwordx4 v[40:43], v1, s[72:75], s88 offen offset:2048 sc1
    buffer_load_dwordx4 v[44:47], v1, s[72:75], s88 offen offset:3072 sc1
    s_lshl_b32 s88, s41, 12
    s_add_u32 s88, s88, s92
    buffer_load_dwordx4 v[116:119], v1, s[72:75], s88 offen offset:0 sc1
    buffer_load_dwordx4 v[120:123], v1, s[72:75], s88 offen offset:1024 sc1
    buffer_load_dwordx4 v[240:243], v1, s[72:75], s88 offen offset:2048 sc1
    buffer_load_dwordx4 v[244:247], v1, s[72:75], s88 offen offset:3072 sc1
    s_lshl_b32 s88, s42, 12
    s_add_u32 s88, s88, s92
    buffer_load_dwordx4 v[128:131], v1, s[72:75], s88 offen offset:0 sc1
    buffer_load_dwordx4 v[132:135], v1, s[72:75], s88 offen offset:1024 sc1
    buffer_load_dwordx4 v[136:139], v1, s[72:75], s88 offen offset:2048 sc1
    buffer_load_dwordx4 v[140:143], v1, s[72:75], s88 offen offset:3072 sc1
Lwa84:
    ds_read_b32 v27, v24 offset:1152
    s_waitcnt lgkmcnt(0)
    v_cmp_gt_u32 vcc, 34, v27
    s_cbranch_vccz Lwd85
    s_sleep 1
    s_sub_u32 s101, s101, 1
    s_cbranch_scc0 Lwa84
    s_mov_b32 s101, 0
Lwd85:
    ds_read_b64_tr_b16 v[96:97], v124 offset:0
    ds_read_b64_tr_b16 v[98:99], v124 offset:1024
    ds_read_b64_tr_b16 v[100:101], v125 offset:0
    ds_read_b64_tr_b16 v[102:103], v125 offset:1024
    ds_read_b64_tr_b16 v[104:105], v126 offset:0
    ds_read_b64_tr_b16 v[106:107], v126 offset:1024
    ds_read_b64_tr_b16 v[108:109], v124 offset:2048
    ds_read_b64_tr_b16 v[110:111], v124 offset:3072
    ds_read_b64_tr_b16 v[112:113], v125 offset:2048
    ds_read_b64_tr_b16 v[114:115], v125 offset:3072
    s_waitcnt vmcnt(0) lgkmcnt(0)
    s_branch Lsj73
Lsp108:
    s_waitcnt vmcnt(0)
    s_add_u32 m0, s91, 148356
    s_nop 0
    global_load_lds_dword v28, s[4:5] offset:124
Lwa116:
    ds_read_b32 v27, v24 offset:1536
    s_waitcnt lgkmcnt(0)
    v_cmp_gt_u32 vcc, 3, v27
    s_cbranch_vccz Lwd117
    s_sleep 1
    s_sub_u32 s101, s101, 1
    s_cbranch_scc0 Lwa116
    s_mov_b32 s101, 0
Lwd117:
    v_lshlrev_b32 v20, 7, v0
    s_lshr_b32 s6, s2, 1
    s_lshl_b32 s6, s6, 1
    s_add_u32 s6, s6, s84
    s_and_b32 s7, s2, 1
    s_lshl_b32 s7, s7, 8
    s_add_u32 s6, s6, s7
    s_lshl_b32 s90, s6, 10
    s_mul_i32 s86, s6, 3584
    s_mov_b64 exec, 0xfffffff
    buffer_load_dword v40, v20, s[64:67], s86 offen
    s_mov_b64 exec, 0xff
    buffer_load_dword v41, v20, s[60:63], s90 offen
    s_mov_b64 exec, -1
    s_waitcnt vmcnt(0)
Lwa118:
    ds_read_b32 v27, v29 offset:0
    s_waitcnt lgkmcnt(0)
    v_cmp_gt_u32 vcc, 10, v27
    s_cbranch_vccz Lwd119
    s_sleep 1
    s_sub_u32 s101, s101, 1
    s_cbranch_scc0 Lwa118
    s_mov_b32 s101, 0
Lwd119:
    s_branch Lsj109
Lrd64:
    s_cmp_lg_u32 s97, 0
    s_cbranch_scc1 Lrb65
    s_mov_b32 s97, 1
    s_nop 15
    s_waitcnt vmcnt(0) lgkmcnt(0)
    ds_sub_u32 v25, v26
    s_cmp_eq_u32 s38, 0
    s_cselect_b32 s82, 0x40000000, s80
    v_and_b32 v12, 31, v0
    v_lshlrev_b32 v13, 2, v15
    v_sub_u32 v12, v12, v13
    v_cmp_le_i32 s[40:41], 0, v12
    v_cmp_le_i32 s[42:43], 1, v12
    v_cmp_le_i32 s[44:45], 2, v12
    v_cmp_le_i32 s[46:47], 3, v12
    v_cmp_le_i32 s[48:49], 8, v12
    v_cmp_le_i32 s[50:51], 9, v12
    v_cmp_le_i32 s[52:53], 10, v12
    v_cmp_le_i32 s[54:55], 11, v12
    v_cmp_le_i32 s[56:57], 16, v12
    v_cmp_le_i32 s[58:59], 17, v12
    v_cmp_le_i32 s[60:61], 18, v12
    v_cmp_le_i32 s[62:63], 19, v12
    v_cmp_le_i32 s[64:65], 24, v12
    v_cmp_le_i32 s[66:67], 25, v12
    v_cmp_le_i32 s[68:69], 26, v12
    v_cmp_le_i32 s[70:71], 27, v12
    v_mov_b32 v120, 0xffff
    v_mov_b32 v121, 0xffff0000
    v_cndmask_b32 v184, 0, v120, s[40:41]
    v_cndmask_b32 v12, 0, v121, s[42:43]
    v_or_b32 v184, v184, v12
    v_cndmask_b32 v185, 0, v120, s[44:45]
    v_cndmask_b32 v12, 0, v121, s[46:47]
    v_or_b32 v185, v185, v12
    v_cndmask_b32 v186, 0, v120, s[48:49]
    v_cndmask_b32 v12, 0, v121, s[50:51]
    v_or_b32 v186, v186, v12
    v_cndmask_b32 v187, 0, v120, s[52:53]
    v_cndmask_b32 v12, 0, v121, s[54:55]
    v_or_b32 v187, v187, v12
    v_cndmask_b32 v188, 0, v120, s[56:57]
    v_cndmask_b32 v12, 0, v121, s[58:59]
    v_or_b32 v188, v188, v12
    v_cndmask_b32 v189, 0, v120, s[60:61]
    v_cndmask_b32 v12, 0, v121, s[62:63]
    v_or_b32 v189, v189, v12
    v_cndmask_b32 v190, 0, v120, s[64:65]
    v_cndmask_b32 v12, 0, v121, s[66:67]
    v_or_b32 v190, v190, v12
    v_cndmask_b32 v191, 0, v120, s[68:69]
    v_cndmask_b32 v12, 0, v121, s[70:71]
    v_or_b32 v191, v191, v12
    ds_read_b128 v[144:147], v2 offset:0
    ds_read_b128 v[148:151], v2 offset:1024
    ds_read_b128 v[152:155], v2 offset:2048
    ds_read_b128 v[156:159], v2 offset:3072
    ds_read_b128 v[160:163], v2 offset:4096
    ds_read_b128 v[164:167], v2 offset:5120
    ds_read_b128 v[168:171], v2 offset:6144
    ds_read_b128 v[172:175], v2 offset:7168
    ds_read_b128 v[176:179], v2 offset:8192
    ds_read_b128 v[180:183], v2 offset:9216
    ds_read_b128 v[100:103], v2 offset:1024
    ds_read_b128 v[96:99], v2 offset:2048
    s_waitcnt lgkmcnt(3)
    v_mfma_f32_32x32x16_bf16 v[192:207], v[176:179], v[8:11], 0
    v_mfma_f32_32x32x16_bf16 v[64:79], v[144:147], v[8:11], 0
    s_waitcnt lgkmcnt(2)
    v_mfma_f32_32x32x16_bf16 v[208:223], v[180:183], v[4:7], 0
    v_mfma_f32_32x32x16_bf16 v[80:95], v[148:151], v[4:7], 0
    s_nop 8
    v_cndmask_b32 v192, v64, v192, s[40:41]
    v_cndmask_b32 v193, v65, v193, s[42:43]
    v_cndmask_b32 v194, v66, v194, s[44:45]
    v_cndmask_b32 v195, v67, v195, s[46:47]
    v_cndmask_b32 v196, v68, v196, s[48:49]
    v_cndmask_b32 v197, v69, v197, s[50:51]
    v_cndmask_b32 v198, v70, v198, s[52:53]
    v_cndmask_b32 v199, v71, v199, s[54:55]
    v_cndmask_b32 v200, v72, v200, s[56:57]
    v_cndmask_b32 v201, v73, v201, s[58:59]
    v_cndmask_b32 v202, v74, v202, s[60:61]
    v_cndmask_b32 v203, v75, v203, s[62:63]
    v_cndmask_b32 v204, v76, v204, s[64:65]
    v_cndmask_b32 v205, v77, v205, s[66:67]
    v_cndmask_b32 v206, v78, v206, s[68:69]
    v_cndmask_b32 v207, v79, v207, s[70:71]
    v_max_f32 v12, v192, v193
    v_max3_f32 v12, v12, v194, v195
    v_max3_f32 v12, v12, v196, v197
    v_max3_f32 v12, v12, v198, v199
    v_max3_f32 v12, v12, v200, v201
    v_max3_f32 v12, v12, v202, v203
    v_max3_f32 v12, v12, v204, v205
    v_max3_f32 v12, v12, v206, v207
    v_cndmask_b32 v208, v80, v208, s[40:41]
    v_cndmask_b32 v209, v81, v209, s[42:43]
    v_cndmask_b32 v210, v82, v210, s[44:45]
    v_cndmask_b32 v211, v83, v211, s[46:47]
    v_cndmask_b32 v212, v84, v212, s[48:49]
    v_cndmask_b32 v213, v85, v213, s[50:51]
    v_cndmask_b32 v214, v86, v214, s[52:53]
    v_cndmask_b32 v215, v87, v215, s[54:55]
    v_cndmask_b32 v216, v88, v216, s[56:57]
    v_cndmask_b32 v217, v89, v217, s[58:59]
    v_cndmask_b32 v218, v90, v218, s[60:61]
    v_cndmask_b32 v219, v91, v219, s[62:63]
    v_cndmask_b32 v220, v92, v220, s[64:65]
    v_cndmask_b32 v221, v93, v221, s[66:67]
    v_cndmask_b32 v222, v94, v222, s[68:69]
    v_cndmask_b32 v223, v95, v223, s[70:71]
    v_max_f32 v13, v208, v209
    v_max3_f32 v13, v13, v210, v211
    v_max3_f32 v13, v13, v212, v213
    v_max3_f32 v13, v13, v214, v215
    v_max3_f32 v13, v13, v216, v217
    v_max3_f32 v13, v13, v218, v219
    v_max3_f32 v13, v13, v220, v221
    v_max3_f32 v13, v13, v222, v223
    v_mfma_f32_32x32x16_bf16 v[32:47], v[148:151], v[8:11], 0
    s_nop 11
    v_max3_f32 v12, v12, v32, v33
    v_max3_f32 v12, v12, v34, v35
    v_max3_f32 v12, v12, v36, v37
    v_max3_f32 v12, v12, v38, v39
    v_max3_f32 v12, v12, v40, v41
    v_max3_f32 v12, v12, v42, v43
    v_max3_f32 v12, v12, v44, v45
    v_max3_f32 v12, v12, v46, v47
    v_mfma_f32_32x32x16_bf16 v[48:63], v[152:155], v[4:7], 0
    s_nop 11
    v_max3_f32 v13, v13, v48, v49
    v_max3_f32 v13, v13, v50, v51
    v_max3_f32 v13, v13, v52, v53
    v_max3_f32 v13, v13, v54, v55
    v_max3_f32 v13, v13, v56, v57
    v_max3_f32 v13, v13, v58, v59
    v_max3_f32 v13, v13, v60, v61
    v_max3_f32 v13, v13, v62, v63
    v_mfma_f32_32x32x16_bf16 v[64:79], v[152:155], v[8:11], 0
    s_nop 11
    v_max3_f32 v12, v12, v64, v65
    v_max3_f32 v12, v12, v66, v67
    v_max3_f32 v12, v12, v68, v69
    v_max3_f32 v12, v12, v70, v71
    v_max3_f32 v12, v12, v72, v73
    v_max3_f32 v12, v12, v74, v75
    v_max3_f32 v12, v12, v76, v77
    v_max3_f32 v12, v12, v78, v79
    v_mfma_f32_32x32x16_bf16 v[80:95], v[156:159], v[4:7], 0
    s_nop 11
    v_max3_f32 v13, v13, v80, v81
    v_max3_f32 v13, v13, v82, v83
    v_max3_f32 v13, v13, v84, v85
    v_max3_f32 v13, v13, v86, v87
    v_max3_f32 v13, v13, v88, v89
    v_max3_f32 v13, v13, v90, v91
    v_max3_f32 v13, v13, v92, v93
    v_max3_f32 v13, v13, v94, v95
    v_mfma_f32_32x32x16_bf16 v[32:47], v[156:159], v[8:11], 0
    s_nop 11
    v_max3_f32 v12, v12, v32, v33
    v_max3_f32 v12, v12, v34, v35
    v_max3_f32 v12, v12, v36, v37
    v_max3_f32 v12, v12, v38, v39
    v_max3_f32 v12, v12, v40, v41
    v_max3_f32 v12, v12, v42, v43
    v_max3_f32 v12, v12, v44, v45
    v_max3_f32 v12, v12, v46, v47
    v_mfma_f32_32x32x16_bf16 v[48:63], v[160:163], v[4:7], 0
    s_nop 11
    v_max3_f32 v13, v13, v48, v49
    v_max3_f32 v13, v13, v50, v51
    v_max3_f32 v13, v13, v52, v53
    v_max3_f32 v13, v13, v54, v55
    v_max3_f32 v13, v13, v56, v57
    v_max3_f32 v13, v13, v58, v59
    v_max3_f32 v13, v13, v60, v61
    v_max3_f32 v13, v13, v62, v63
    v_mfma_f32_32x32x16_bf16 v[64:79], v[160:163], v[8:11], 0
    s_nop 11
    v_max3_f32 v12, v12, v64, v65
    v_max3_f32 v12, v12, v66, v67
    v_max3_f32 v12, v12, v68, v69
    v_max3_f32 v12, v12, v70, v71
    v_max3_f32 v12, v12, v72, v73
    v_max3_f32 v12, v12, v74, v75
    v_max3_f32 v12, v12, v76, v77
    v_max3_f32 v12, v12, v78, v79
    v_mfma_f32_32x32x16_bf16 v[80:95], v[164:167], v[4:7], 0
    s_nop 11
    v_max3_f32 v13, v13, v80, v81
    v_max3_f32 v13, v13, v82, v83
    v_max3_f32 v13, v13, v84, v85
    v_max3_f32 v13, v13, v86, v87
    v_max3_f32 v13, v13, v88, v89
    v_max3_f32 v13, v13, v90, v91
    v_max3_f32 v13, v13, v92, v93
    v_max3_f32 v13, v13, v94, v95
    v_mfma_f32_32x32x16_bf16 v[32:47], v[164:167], v[8:11], 0
    s_nop 11
    v_max3_f32 v12, v12, v32, v33
    v_max3_f32 v12, v12, v34, v35
    v_max3_f32 v12, v12, v36, v37
    v_max3_f32 v12, v12, v38, v39
    v_max3_f32 v12, v12, v40, v41
    v_max3_f32 v12, v12, v42, v43
    v_max3_f32 v12, v12, v44, v45
    v_max3_f32 v12, v12, v46, v47
    v_mfma_f32_32x32x16_bf16 v[48:63], v[168:171], v[4:7], 0
    s_nop 11
    v_max3_f32 v13, v13, v48, v49
    v_max3_f32 v13, v13, v50, v51
    v_max3_f32 v13, v13, v52, v53
    v_max3_f32 v13, v13, v54, v55
    v_max3_f32 v13, v13, v56, v57
    v_max3_f32 v13, v13, v58, v59
    v_max3_f32 v13, v13, v60, v61
    v_max3_f32 v13, v13, v62, v63
    v_mfma_f32_32x32x16_bf16 v[64:79], v[168:171], v[8:11], 0
    s_nop 11
    v_max3_f32 v12, v12, v64, v65
    v_max3_f32 v12, v12, v66, v67
    v_max3_f32 v12, v12, v68, v69
    v_max3_f32 v12, v12, v70, v71
    v_max3_f32 v12, v12, v72, v73
    v_max3_f32 v12, v12, v74, v75
    v_max3_f32 v12, v12, v76, v77
    v_max3_f32 v12, v12, v78, v79
    v_mfma_f32_32x32x16_bf16 v[80:95], v[172:175], v[4:7], 0
    s_nop 11
    v_max3_f32 v13, v13, v80, v81
    v_max3_f32 v13, v13, v82, v83
    v_max3_f32 v13, v13, v84, v85
    v_max3_f32 v13, v13, v86, v87
    v_max3_f32 v13, v13, v88, v89
    v_max3_f32 v13, v13, v90, v91
    v_max3_f32 v13, v13, v92, v93
    v_max3_f32 v13, v13, v94, v95
    v_mfma_f32_32x32x16_bf16 v[32:47], v[172:175], v[8:11], 0
    s_nop 11
    v_max3_f32 v12, v12, v32, v33
    v_max3_f32 v12, v12, v34, v35
    v_max3_f32 v12, v12, v36, v37
    v_max3_f32 v12, v12, v38, v39
    v_max3_f32 v12, v12, v40, v41
    v_max3_f32 v12, v12, v42, v43
    v_max3_f32 v12, v12, v44, v45
    v_max3_f32 v12, v12, v46, v47
    v_mfma_f32_32x32x16_bf16 v[48:63], v[176:179], v[4:7], 0
    s_nop 11
    v_max3_f32 v13, v13, v48, v49
    v_max3_f32 v13, v13, v50, v51
    v_max3_f32 v13, v13, v52, v53
    v_max3_f32 v13, v13, v54, v55
    v_max3_f32 v13, v13, v56, v57
    v_max3_f32 v13, v13, v58, v59
    v_max3_f32 v13, v13, v60, v61
    v_max3_f32 v13, v13, v62, v63
    s_waitcnt lgkmcnt(0)
    s_nop 3
    s_branch Lp263
Lend:
    s_endpgm
.p2align 8
Ltab:
    .long 0
    .long 1
    .long 2
    .long 3
    .long 4
    .long 5
    .long 6
    .long 7
    .long 8
    .long 9
    .long 10
    .long 11
    .long 12
    .long 13
    .long 14
    .long 15
    .long 16
    .long 17
    .long 18
    .long 19
    .long 20
    .long 21
    .long 22
    .long 23
    .long 24
    .long 25
    .long 26
    .long 27
    .long 28
    .long 29
    .long 30
    .long 31
    .long 32
    .long 33
    .long 34
    .long 35
    .long 36
    .long 37
    .long 38
    .long 39
    .long 40
    .long 41
    .long 42
    .long 43
    .long 44
    .long 45
    .long 46
    .long 47
    .long 48
    .long 49
    .long 50
    .long 51
    .long 52
    .long 53
    .long 54
    .long 55
    .long 56
    .long 57
    .long 58
    .long 59
    .long 60
    .long 61
    .long 62
    .long 63
    .long 0, 1, 28, 2, 4, 6, 3, 5, 7, 16448, 24576, 24640, 16384, 6144, 14336, 22528
    .long 2, 3, 28, 4, 6, 0, 5, 7, 1, 16448, 24576, 24640, 16384, 6144, 14336, 22528
    .long 4, 5, 28, 6, 0, 2, 7, 1, 3, 16448, 24576, 24640, 16384, 6144, 14336, 22528
    .long 6, 7, 28, 0, 2, 4, 1, 3, 5, 16448, 24576, 24640, 16384, 6144, 14336, 22528
    .long 8, 9, 29, 30, 31, 10, 12, 11, 13, 24576, 24640, 16384, 16448, 12288, 20480, 4096
    .long 10, 11, 29, 30, 31, 12, 8, 13, 9, 24576, 24640, 16384, 16448, 12288, 20480, 4096
    .long 12, 13, 29, 30, 31, 8, 10, 9, 11, 24576, 24640, 16384, 16448, 12288, 20480, 4096
    .long 29, 30, 31, 8, 10, 12, 9, 11, 13, 24576, 24640, 16384, 16448, 12288, 20480, 4096
    .long 14, 15, 32, 16, 18, 20, 17, 19, 21, 24640, 16384, 16448, 24576, 18432, 2048, 10240
    .long 16, 17, 32, 18, 20, 14, 19, 21, 15, 24640, 16384, 16448, 24576, 18432, 2048, 10240
    .long 18, 19, 32, 20, 14, 16, 21, 15, 17, 24640, 16384, 16448, 24576, 18432, 2048, 10240
    .long 20, 21, 32, 14, 16, 18, 15, 17, 19, 24640, 16384, 16448, 24576, 18432, 2048, 10240
    .long 22, 23, 33, 34, 35, 24, 26, 25, 27, 16384, 16448, 24576, 24640, 0, 8192, 16384
    .long 24, 25, 33, 34, 35, 26, 22, 27, 23, 16384, 16448, 24576, 24640, 0, 8192, 16384
    .long 26, 27, 33, 34, 35, 22, 24, 23, 25, 16384, 16448, 24576, 24640, 0, 8192, 16384
    .long 33, 34, 35, 22, 24, 26, 23, 25, 27, 16384, 16448, 24576, 24640, 0, 8192, 16384
.section .rodata,"a"
.p2align 6
.amdhsa_kernel gated_mix__sliding_block__mixer_s_mlp__prompt_kernel
  .amdhsa_next_free_vgpr 256
  .amdhsa_next_free_sgpr 102
  .amdhsa_accum_offset 256
  .amdhsa_group_segment_fixed_size 0
  .amdhsa_kernarg_size 96
  .amdhsa_user_sgpr_count 2
  .amdhsa_user_sgpr_kernarg_segment_ptr 1
  .amdhsa_system_sgpr_workgroup_id_x 1
.end_amdhsa_kernel
```
